```python
import torch

def _softmax(x, axis=-1):
    return torch.softmax(x, dim=axis)
def _gelu(x):
    return torch.nn.functional.gelu(x, approximate="tanh")
def _silu(x):
    return torch.nn.functional.silu(x)
def _sigmoid(x):
    return torch.sigmoid(x)
def _layernorm(x, axis=-1, eps=1e-5):
    m = x.mean(dim=axis, keepdim=True)
    v = x.var(dim=axis, keepdim=True, unbiased=False)
    return (x - m) / torch.sqrt(v + eps)
def _scatter_add(tgt, idx, src, axis=0):
    return tgt.clone().index_add_(axis, idx, src)
def _segment_sum(src, seg, n):
    out = torch.zeros((n,) + src.shape[1:], dtype=src.dtype)
    return out.index_add_(0, seg, src)
def _pad(x, pw):
    flat = tuple(v for pair in reversed(pw) for v in pair)
    return torch.nn.functional.pad(x, flat)

kernel_name = 'gated_mix__ssm_conv_h3__dense_activation_silu__prompt'

def setup_inputs():

    _w = (lambda a: (lambda t: t.to(torch.bfloat16) if t.is_floating_point() else t)(torch.as_tensor(a)))
    def _A_setup():
        B, S, D = 1, 2048, 640
        ks = 4
        return {
            "q": _w((lambda *s: torch.randn(*s, dtype=torch.bfloat16) * 0.05)(B, S, D)),
            "k": _w((lambda *s: torch.randn(*s, dtype=torch.bfloat16) * 0.2)(B, S, D)),
            "v": _w((lambda *s: torch.randn(*s, dtype=torch.bfloat16) * 0.2)(B, S, D)),
            "shift_k": _w((lambda *s: torch.randn(*s, dtype=torch.bfloat16) * 0.2)(D, ks) * 0.5),
            "ssm_k": _w((lambda *s: torch.randn(*s, dtype=torch.bfloat16) * 0.4)(D, S) * (1.0 / S ** 0.5)),
            "ssm_D": _w((lambda *s: torch.randn(*s, dtype=torch.bfloat16) * 0.2)(D)),
        }
    _A_in = _A_setup()

    def _B_setup():
        B, S, D, F = 1, 2048, 640, 1536
        return {
            "x": _w((lambda *s: torch.randn(*s, dtype=torch.bfloat16) * 0.05)(B, S, D)),
            "w1": _w((lambda *s: torch.randn(*s, dtype=torch.bfloat16) * 3.2)(D, F) * (D ** -0.5)),
            "w2": _w((lambda *s: torch.randn(*s, dtype=torch.bfloat16) * 0.05)(F, D) * (F ** -0.5)),
        }
    _B_in = _B_setup()

    return {
        "A_q": _A_in["q"],
        "A_k": _A_in["k"],
        "A_v": _A_in["v"],
        "A_shift_k": _A_in["shift_k"],
        "A_ssm_k": _A_in["ssm_k"],
        "A_ssm_D": _A_in["ssm_D"],
        "B_x": _B_in["x"],
        "B_w1": _B_in["w1"],
        "B_w2": _B_in["w2"],
        "gate_w": _w((lambda *s: torch.randn(*s, dtype=torch.bfloat16) * 0.05)(640) * 16.0),
    }

def reference(A_q, A_k, A_v, A_shift_k, A_ssm_k, A_ssm_D, B_x, B_w1, B_w2, gate_w):
    def _A_ref(q, k, v, shift_k, ssm_k, ssm_D):
        B, S, D = q.shape
        ks = shift_k.shape[-1]
        k_pad = _pad(k, ((0, 0), (ks - 1, 0), (0, 0)))
        k_shift = torch.zeros_like(k)
        for t in range(ks):
            k_shift = k_shift + k_pad[:, t:t + S, :] * shift_k[:, ks - 1 - t][None, None, :]
        kv = k_shift * v
        L = 2 * S
        kv_pad = _pad(kv, ((0, 0), (0, S), (0, 0)))
        kf_pad = _pad(ssm_k, ((0, 0), (0, S)))
        kv_f = (lambda x, axes=(-2,-1): torch.fft.rfft2(x.float(), dim=axes))(kv_pad[:, None, :, :], axes=(1, 2))
        kf_f = (lambda x, axes=(-2,-1): torch.fft.rfft2(x.float(), dim=axes))(kf_pad[:, None, :], axes=(1, 2))
        kf_f = (lambda x, *d: x.permute(*d))(kf_f, 1, 2, 0)
        y_f = kv_f * kf_f[None, :, :, :]
        y = (lambda x, s, axes=(-2,-1): torch.fft.irfft2(x, s=s, dim=axes).to(torch.bfloat16))(y_f, (1, L), axes=(1, 2))[:, 0, :S, :]
        y = y + kv * ssm_D[None, None, :]
        return q * y

    def _B_ref(x, w1, w2):
        h = torch.einsum("bsd,df->bsf", x, w1)
        h = _silu(h)
        out = torch.einsum("bsf,fd->bsd", h, w2)
        return out

    x = A_q
    g = _sigmoid((x * gate_w).sum(-1, keepdims=True))
    a = _A_ref(x, A_k, A_v, A_shift_k, A_ssm_k, A_ssm_D)
    b = _B_ref(x, B_w1, B_w2)
    return g * a + (1 - g) * b
```

```asm
; @launch grid=(256,1,1) block=(256,1,1) lds=163712
.amdgcn_target "amdgcn-amd-amdhsa--gfx950"
.text
.p2align 12
.fill 128, 4, 0xbf800000
.globl gated_mix__ssm_conv_h3__dense_activation_silu__prompt_kernel
.p2align 8
.type gated_mix__ssm_conv_h3__dense_activation_silu__prompt_kernel,@function
gated_mix__ssm_conv_h3__dense_activation_silu__prompt_kernel:
  s_cmp_ge_u32 s2, 256
  s_cbranch_scc1 L_end
  s_load_dwordx2 s[12:13], s[0:1], 8
  s_load_dwordx2 s[16:17], s[0:1], 16
  s_load_dwordx2 s[8:9], s[0:1], 0
  s_load_dwordx2 s[28:29], s[0:1], 56
  s_load_dwordx2 s[20:21], s[0:1], 24
  s_load_dwordx2 s[36:37], s[0:1], 72
  s_load_dwordx2 s[44:45], s[0:1], 96
  s_load_dwordx2 s[32:33], s[0:1], 64
  s_load_dwordx2 s[24:25], s[0:1], 32
  s_load_dwordx2 s[88:89], s[0:1], 40
  s_load_dwordx2 s[40:41], s[0:1], 80
  v_lshrrev_b32 v1, 6, v0
  v_and_b32 v0, 63, v0
  v_readfirstlane_b32 s6, v1
  v_lshlrev_b32 v1, 4, v0
  s_lshr_b32 s3, s2, 3
  s_and_b32 s7, s2, 7
  s_lshr_b32 s4, s7, 1
  s_lshl_b32 s4, s4, 3
  s_lshr_b32 s5, s3, 2
  s_add_u32 s4, s4, s5
  s_and_b32 s5, s7, 1
  s_lshl_b32 s5, s5, 2
  s_and_b32 s3, s3, 3
  s_add_u32 s5, s5, s3
  v_mul_u32_u24 v16, 205, v0
  v_lshrrev_b32 v16, 11, v16
  v_mul_u32_u24 v17, 10080, v16
  s_mul_i32 s7, s4, 81920
  s_mul_i32 s3, s5, 160
  s_add_u32 s7, s7, s3
  s_and_b32 s74, s6, 1
  s_mul_i32 s75, s74, 5120
  s_add_u32 s75, s75, s7
  s_sub_u32 s75, s75, 5120
  v_add3_u32 v18, v17, v1, s75
  v_cmp_gt_u32 vcc, 30, v0
  v_mov_b32 v16, 0xffff8d00
  v_mov_b32 v17, 61440
  v_cndmask_b32 v16, v16, v17, vcc
  v_add_u32 v20, 32000, v18
  v_add_u32 v19, v16, v18
  s_mul_i32 s80, s6, 5760
  s_add_u32 s80, s80, 65536
  s_mov_b32 s14, 2621440
  s_mov_b32 s15, 0x00020000
  s_mov_b32 s39, 0x00020000
  s_lshl_b32 s81, s6, 10
  s_mul_i32 s82, s5, 640
  s_cmp_eq_u32 s6, 3
  s_cselect_b32 s81, 0, s81
  s_cselect_b32 s82, s82, 0
  s_movk_i32 s38, 1280
  s_cselect_b32 s38, 5120, s38
  s_cselect_b32 s83, 0xffff0c80, s81
  s_cselect_b32 s84, 0xff, 0
  s_add_u32 s83, s83, 150912
  v_add_u32 v21, s81, v1
  v_subrev_u32 v22, 1280, v21
  v_min_u32 v21, v21, v22
  s_cmp_lt_u32 s6, 2
  s_cselect_b32 s84, -1, s84
  s_getpc_b64 s[90:91]
L_pc:
  s_lshr_b32 s74, s2, 3
  s_lshl_b32 s74, s74, 2
  s_add_u32 s74, s74, s6
  s_mul_i32 s74, s74, 10
  v_add_u32 v24, s74, v0
  v_lshlrev_b32 v24, 6, v24
  v_min_u32 v24, L_end-L_pc, v24
  v_mov_b32 v25, s91
  v_add_co_u32 v24, vcc, s90, v24
  s_nop 1
  v_addc_co_u32 v25, vcc, 0, v25, vcc
  s_mov_b64 exec, 1023
  global_load_dword a240, v[24:25], off
  s_mov_b64 exec, -1
  s_cmp_lt_u32 s6, 2
  s_mov_b32 exec_hi, 0x0fffffff
  s_waitcnt lgkmcnt(0)
  s_cselect_b32 s12, s12, s16
  s_cselect_b32 s13, s13, s17
  s_add_u32 m0, s80, 0
  s_nop 0
  buffer_load_dwordx4 v18, s[12:15], 0 offen offset:0 lds
  s_add_u32 m0, s80, 960
  s_nop 0
  buffer_load_dwordx4 v19, s[12:15], 0 offen offset:0 lds
  s_add_u32 m0, s80, 1920
  s_nop 0
  buffer_load_dwordx4 v20, s[12:15], 0 offen offset:0 lds
  s_add_u32 m0, s80, 320
  s_nop 0
  buffer_load_dwordx4 v18, s[12:15], 0 offen offset:2560 lds
  s_add_u32 m0, s80, 1280
  s_nop 0
  buffer_load_dwordx4 v19, s[12:15], 0 offen offset:2560 lds
  s_add_u32 m0, s80, 2240
  s_nop 0
  buffer_load_dwordx4 v20, s[12:15], 0 offen offset:2560 lds
  s_cmp_eq_u32 s6, 3
  s_cselect_b32 s36, s20, s36
  s_cselect_b32 s37, s21, s37
  s_mov_b32 m0, s83
  s_mov_b32 exec_hi, s84
  buffer_load_dwordx4 v21, s[36:39], s82 offen lds
  s_mov_b32 exec_hi, -1
  s_mov_b32 s10, 2621440
  s_mov_b32 s11, 0x00020000
  s_mov_b32 s30, 1966080
  s_mov_b32 s31, 0x00020000
  v_lshrrev_b32 v26, 3, v0
  v_and_b32 v27, 7, v0
  v_xor_b32 v27, v27, v26
  v_lshrrev_b32 v28, 2, v26
  v_lshlrev_b32 v28, 1, v28
  v_and_b32 v29, 1, v26
  v_or_b32 v28, v28, v29
  v_and_b32 v29, 2, v26
  v_lshl_add_u32 v28, v29, 4, v28
  v_mul_u32_u24 v28, 1280, v28
  v_lshl_add_u32 v28, v27, 4, v28
  s_mul_i32 s74, s4, 81920
  s_mul_i32 s75, s6, 10240
  s_add_u32 s74, s74, s75
  v_add_u32 v230, s74, v28
  v_add_u32 v231, 4096, v230
  s_mul_i32 s66, s6, 6144
  s_lshl_b32 s67, s6, 11
  s_add_u32 s67, s67, 24576
  s_add_u32 s74, s4, s5
  s_and_b32 s74, s74, 1
  s_lshl_b32 s74, s74, 1
  s_mul_i32 s74, s74, 5
  s_lshr_b32 s74, s74, 1
  s_lshl_b32 s64, s74, 7
  s_mul_i32 s65, s74, 196608
  s_add_u32 s78, s64, 150912
  s_add_u32 m0, s67, 0
  s_nop 0
  buffer_load_dwordx4 v230, s[8:11], s64 offen offset:0 lds
  buffer_load_dwordx4 v231, s[8:11], s64 offen offset:1024 lds
  s_add_u32 s64, s64, 128
  s_cmp_eq_u32 s64, 1280
  s_cselect_b32 s64, 0, s64
  s_mul_i32 s74, s6, 49152
  s_mul_i32 s75, s5, 384
  s_add_u32 s74, s74, s75
  s_mov_b32 s75, 24576
  s_mov_b32 s76, -24
  s_movk_i32 s77, 3072
  v_mov_b32 v30, s74
  v_mul_u32_u24 v27, 2731, v0
  v_lshrrev_b32 v27, 16, v27
  v_mad_i32_i24 v28, v27, s76, v0
  v_and_b32 v29, 2, v27
  v_xor_b32 v28, v28, v29
  v_mad_u32_u24 v27, v27, s77, v30
  v_lshl_add_u32 v224, v28, 4, v27
  v_subrev_u32 v30, 1024, v30
  v_add_u32 v26, 64, v0
  v_mul_u32_u24 v27, 2731, v26
  v_lshrrev_b32 v27, 16, v27
  v_mad_i32_i24 v28, v27, s76, v26
  v_and_b32 v29, 2, v27
  v_xor_b32 v28, v28, v29
  v_mad_u32_u24 v27, v27, s77, v30
  v_lshl_add_u32 v225, v28, 4, v27
  v_subrev_u32 v30, 1024, v30
  v_add_u32 v26, 128, v0
  v_mul_u32_u24 v27, 2731, v26
  v_lshrrev_b32 v27, 16, v27
  v_mad_i32_i24 v28, v27, s76, v26
  v_and_b32 v29, 2, v27
  v_xor_b32 v28, v28, v29
  v_mad_u32_u24 v27, v27, s77, v30
  v_lshl_add_u32 v226, v28, 4, v27
  v_xad_u32 v227, v224, 64, s75
  v_xad_u32 v228, v225, 64, s75
  v_xad_u32 v229, v226, 64, s75
  v_lshrrev_b32 v26, 4, v0
  v_lshlrev_b32 v26, 4, v26
  v_add_u32 v252, s78, v26
  s_mov_b32 s26, 2621440
  s_mov_b32 s27, 0x00020000
  s_mov_b32 s34, 1966080
  s_mov_b32 s35, 0x00020000
  s_mov_b32 s42, 2621440
  s_mov_b32 s43, 0x00020000
  s_mov_b32 s46, 22175744
  s_mov_b32 s47, 0x00020000
  s_lshl_b32 s91, s6, 5
  s_add_u32 s91, s91, s4
  s_cmp_lt_u32 s91, 80
  s_cselect_b64 s[62:63], -1, 0
  s_cselect_b32 s91, s91, 0
  s_mul_i32 s70, s5, 80
  s_add_u32 s70, s70, s91
  s_lshl_b32 s96, s70, 1
  s_and_b32 s96, s96, -4
  s_lshl_b32 s70, s70, 12
  s_lshl_b32 s86, s5, 7
  s_add_u32 s86, s86, 16138240
  s_lshl_b32 s87, s4, 7
  s_add_u32 s87, s87, 16139264
  s_add_u32 m0, s66, 0
  s_nop 0
  buffer_load_dwordx4 v224, s[28:31], s65 offen offset:0 lds
  s_add_u32 s94, s24, s70
  s_addc_u32 s95, s25, 0
  s_load_dwordx2 s[94:95], s[94:95], 0
  s_load_dword s96, s[88:89], s96
  s_load_dword s60, s[44:45], s86
  s_load_dword s61, s[44:45], s87
  s_mul_i32 s69, s6, 17536
  s_add_u32 s69, s69, 98304
  v_lshrrev_b32 v26, 4, v0
  v_lshrrev_b32 v27, 2, v0
  v_and_b32 v27, 3, v27
  v_lshl_add_u32 v28, v26, 3, v27
  v_mul_u32_u24 v28, 384, v28
  v_and_b32 v29, 3, v0
  v_lshl_add_u32 v28, v29, 3, v28
  v_lshrrev_b32 v29, 1, v27
  v_and_b32 v30, 1, v26
  v_lshl_add_u32 v29, v30, 1, v29
  s_and_b32 s74, s6, 1
  s_mul_i32 s74, s74, 6
  s_add_u32 s75, s74, 0
  v_xor_b32 v30, s75, v29
  v_lshl_add_u32 v232, v30, 5, v28
  s_add_u32 s75, s74, 1
  v_xor_b32 v30, s75, v29
  v_lshl_add_u32 v233, v30, 5, v28
  s_add_u32 s75, s74, 2
  v_xor_b32 v30, s75, v29
  v_lshl_add_u32 v234, v30, 5, v28
  buffer_load_dwordx4 v225, s[28:31], s65 offen offset:1024 lds
  s_add_u32 s75, s74, 3
  v_xor_b32 v30, s75, v29
  v_lshl_add_u32 v235, v30, 5, v28
  s_add_u32 s75, s74, 4
  v_xor_b32 v30, s75, v29
  v_lshl_add_u32 v236, v30, 5, v28
  s_add_u32 s75, s74, 5
  v_xor_b32 v30, s75, v29
  v_lshl_add_u32 v237, v30, 5, v28
  v_and_b32 v27, 15, v0
  v_and_b32 v28, 7, v0
  v_xor_b32 v28, v28, v26
  v_lshlrev_b32 v27, 7, v27
  v_add_u32 v27, s67, v27
  v_lshl_add_u32 v238, v28, 4, v27
  v_xor_b32 v239, 2048, v238
  v_xor_b32 v240, 64, v238
  v_xor_b32 v241, 64, v239
  v_and_b32 v27, 7, v0
  v_mul_u32_u24 v58, 160, v27
  v_lshrrev_b32 v26, 3, v0
  v_lshl_add_u32 v58, v26, 3, v58
  s_mul_i32 s74, s6, 40
  s_add_u32 s75, s74, 65536
  v_add_u32 v58, s75, v58
  buffer_load_dwordx4 v226, s[28:31], s65 offen offset:2048 lds
  s_lshl_b32 s74, s74, 2
  s_add_u32 s74, s74, 88576
  v_lshlrev_b32 v59, 5, v26
  v_add_u32 v59, s74, v59
  v_lshlrev_b32 v196, 14, v26
  v_xor_b32 v27, 7, v27
  v_lshl_add_u32 v196, v27, 4, v196
  s_mul_i32 s83, s5, 327680
  s_mul_i32 s74, s6, 81920
  s_add_u32 s83, s83, s74
  s_xor_b32 s74, s4, 31
  s_lshl_b32 s74, s74, 7
  s_add_u32 s83, s83, s74
  s_lshl_b32 s74, s6, 6
  s_add_u32 s74, s74, 0
  v_add_u32 v26, s74, v0
  v_mul_u32_u24 v27, 6554, v26
  v_lshrrev_b32 v27, 16, v27
  v_mul_u32_u24 v27, 1120, v27
  v_lshl_add_u32 v212, v26, 4, v27
  s_lshl_b32 s74, s6, 6
  s_add_u32 s74, s74, 256
  v_add_u32 v26, s74, v0
  v_mul_u32_u24 v27, 6554, v26
  v_lshrrev_b32 v27, 16, v27
  v_mul_u32_u24 v27, 1120, v27
  v_lshl_add_u32 v213, v26, 4, v27
  s_add_u32 m0, s66, 3072
  s_nop 0
  buffer_load_dwordx4 v227, s[28:31], s65 offen offset:0 lds
  s_lshl_b32 s74, s6, 6
  s_add_u32 s74, s74, 512
  v_add_u32 v26, s74, v0
  v_mul_u32_u24 v27, 6554, v26
  v_lshrrev_b32 v27, 16, v27
  v_mul_u32_u24 v27, 1120, v27
  v_lshl_add_u32 v214, v26, 4, v27
  s_sub_u32 s81, s7, 655360
  s_lshl_b32 s82, s6, 10
  s_add_u32 s82, s82, 153472
  v_add_u32 v242, 65536, v232
  v_add_u32 v243, 65536, v233
  v_add_u32 v244, 65536, v234
  v_add_u32 v245, 65536, v235
  v_add_u32 v246, 65536, v236
  v_add_u32 v247, 65536, v237
  v_add_u32 v248, 65536, v238
  v_add_u32 v249, 65536, v239
  v_add_u32 v250, 65536, v240
  v_add_u32 v251, 65536, v241
  v_lshrrev_b32 v136, 2, v0
  v_mul_u32_u24 v136, 160, v136
  v_and_b32 v137, 3, v0
  v_lshl_add_u32 v136, v137, 3, v136
  s_add_u32 s76, s6, 0
  s_mul_i32 s77, s76, 205
  s_lshr_b32 s77, s77, 10
  s_mul_i32 s77, s77, 4960
  buffer_load_dwordx4 v228, s[28:31], s65 offen offset:1024 lds
  s_lshl_b32 s76, s76, 5
  s_add_u32 s76, s76, s77
  s_add_u32 s76, s76, 153472
  v_add_u32 v197, s76, v136
  s_add_u32 s76, s6, 4
  s_mul_i32 s77, s76, 205
  s_lshr_b32 s77, s77, 10
  s_mul_i32 s77, s77, 4960
  s_lshl_b32 s76, s76, 5
  s_add_u32 s76, s76, s77
  s_add_u32 s76, s76, 153472
  v_add_u32 v198, s76, v136
  s_add_u32 s76, s6, 8
  s_mul_i32 s77, s76, 205
  s_lshr_b32 s77, s77, 10
  s_mul_i32 s77, s77, 4960
  s_lshl_b32 s76, s76, 5
  s_add_u32 s76, s76, s77
  s_add_u32 s76, s76, 153472
  v_add_u32 v199, s76, v136
  s_mul_i32 s84, s5, 240
  s_mul_i32 s76, s4, 10
  s_add_u32 s84, s84, s76
  s_add_u32 s84, s84, s6
  s_lshl_b32 s84, s84, 10
  s_add_u32 s84, s84, 5160960
  buffer_load_dwordx4 v229, s[28:31], s65 offen offset:2048 lds
  s_add_u32 s65, s65, 196608
  s_cmp_eq_u32 s65, 1966080
  s_cselect_b32 s65, 0, s65
  s_lshl_b32 s85, s5, 5
  s_add_u32 s85, s85, s4
  s_lshl_b32 s85, s85, 8
  s_add_u32 s85, s85, 16146432
  s_lshr_b32 s68, s4, 4
  s_lshl_b32 s68, s68, 2
  s_add_u32 s68, s68, s6
  v_lshrrev_b32 v136, 3, v0
  v_and_b32 v136, 3, v136
  v_and_b32 v137, 7, v0
  s_lshl_b32 s76, s5, 2
  s_add_u32 s76, s76, s6
  s_lshl_b32 s76, s76, 11
  s_add_u32 s76, s76, 16146432
  v_mov_b32 v2, s76
  v_lshl_add_u32 v2, v137, 8, v2
  s_lshr_b32 s78, s4, 4
  s_lshl_b32 s78, s78, 2
  s_add_u32 s78, s78, s6
  s_lshl_b32 s78, s78, 3
  s_mov_b32 s76, 0x6121c26
  s_mov_b32 s77, 0x6121e27
  s_lshr_b64 s[76:77], s[76:77], s78
  s_and_b32 s48, s76, 63
  s_mov_b32 s76, 0x121c26
  s_mov_b32 s77, 0x3001e27
  s_lshr_b64 s[76:77], s[76:77], s78
  s_add_u32 m0, s67, 32768
  s_nop 0
  buffer_load_dwordx4 v230, s[8:11], s64 offen offset:0 lds
  s_and_b32 s71, s76, 63
  s_mul_i32 s76, s48, 43
  s_lshr_b32 s76, s76, 8
  s_add_u32 s76, s76, s5
  s_lshl_b32 s76, s76, 2
  v_add_u32 v138, s76, v0
  v_and_b32 v138, 31, v138
  s_lshl_b32 s76, s4, 13
  s_add_u32 s76, s76, 16408576
  v_mov_b32 v3, s76
  v_lshl_add_u32 v3, v138, 8, v3
  v_lshlrev_b32 v137, 8, v137
  s_mul_i32 s76, s5, 6
  s_add_u32 s48, s48, s76
  s_add_u32 s71, s71, s76
  s_sub_u32 s77, s48, 48
  s_min_u32 s48, s48, s77
  s_sub_u32 s77, s71, 48
  s_min_u32 s71, s71, s77
  s_mul_i32 s72, s5, 245760
  s_add_u32 s72, s72, 5242880
  s_add_u32 s73, s72, 245760
  s_mul_i32 s71, s71, 5120
  s_add_u32 s71, s71, s72
  s_mul_i32 s58, s4, 196608
  s_add_u32 s58, s58, 7208960
  s_add_u32 s59, s58, 196608
  buffer_load_dwordx4 v231, s[8:11], s64 offen offset:1024 lds
  s_add_u32 s64, s64, 128
  s_cmp_eq_u32 s64, 1280
  s_cselect_b32 s64, 0, s64
  s_lshl_b32 s48, s48, 12
  s_add_u32 s48, s48, s58
  v_and_b32 v136, 1, v0
  v_mul_u32_u24 v136, 4576, v136
  v_and_b32 v137, 14, v0
  v_lshl_add_u32 v136, v137, 5, v136
  v_lshrrev_b32 v137, 4, v0
  v_lshlrev_b32 v138, 4, v137
  v_sub_u32 v136, v138, v136
  s_add_u32 s76, s69, 5024
  v_add_u32 v10, s76, v136
  v_and_b32 v136, 15, v0
  v_lshlrev_b32 v136, 2, v136
  v_add_u32 v136, v136, v138
  s_add_u32 s76, s69, 13376
  v_add_u32 v11, s76, v136
  s_mul_i32 s76, s4, 48
  s_mul_i32 s77, s5, 6
  s_add_u32 s76, s76, s77
  s_and_b32 s77, s6, 1
  s_mul_i32 s77, s77, 3
  s_add_u32 s76, s76, s77
  s_lshl_b32 s76, s76, 2
  s_add_u32 s76, s76, s6
  s_lshl_b32 s97, s76, 10
  s_add_u32 s97, s97, 7208960
  s_xor_b32 s98, s97, 1024
  s_add_u32 m0, s66, 32768
  s_nop 0
  buffer_load_dwordx4 v224, s[28:31], s65 offen offset:0 lds
  buffer_load_dwordx4 v225, s[28:31], s65 offen offset:1024 lds
  buffer_load_dwordx4 v226, s[28:31], s65 offen offset:2048 lds
  s_branch L_jp1
.p2align 12
L_jp1:
  s_waitcnt vmcnt(13)
  s_barrier
  ds_read_b128 v[124:127], v59
  ds_read_b128 v[128:131], v59 offset:16
  ds_read_b64 v[18:19], v58 offset:1440
  ds_read_b64 v[20:21], v58 offset:2880
  ds_read_b64 v[22:23], v58 offset:4320
  ds_read_b64 v[24:25], v58 offset:5760
  ds_read_b64 v[26:27], v58 offset:7200
  ds_read_b64 v[28:29], v58 offset:8640
  ds_read_b64 v[30:31], v58 offset:10080
  ds_read_b64 v[32:33], v58 offset:160
  ds_read_b64 v[34:35], v58 offset:1600
  ds_read_b64 v[36:37], v58 offset:3040
  ds_read_b64 v[38:39], v58 offset:4480
  ds_read_b64 v[42:43], v58 offset:17280
  ds_read_b64 v[44:45], v58 offset:18720
  ds_read_b64 v[46:47], v58 offset:20160
  ds_read_b64 v[48:49], v58 offset:21600
  ds_read_b64 v[50:51], v58 offset:11680
  ds_read_b64 v[52:53], v58 offset:13120
  ds_read_b64 v[54:55], v58 offset:14560
  ds_read_b64 v[56:57], v58 offset:16000
  s_waitcnt lgkmcnt(0)
  v_lshlrev_b32 v60, 16, v124
  s_cmp_lt_u32 s4, 8
  s_cbranch_scc1 L_now2a
  s_add_u32 m0, s82, 0
  s_nop 0
  buffer_load_dwordx4 v212, s[32:35], s81 offen lds
  s_add_u32 m0, s82, 4096
  s_nop 0
  buffer_load_dwordx4 v213, s[32:35], s81 offen lds
  s_cmp_ge_u32 s6, 2
  s_cbranch_scc1 L_now2a
  s_add_u32 m0, s82, 8192
  s_nop 0
  buffer_load_dwordx4 v214, s[32:35], s81 offen lds
L_now2a:
  v_and_b32 v64, 0xffff0000, v124
  v_lshlrev_b32 v68, 16, v125
  v_and_b32 v72, 0xffff0000, v125
  v_lshlrev_b32 v61, 16, v126
  v_and_b32 v65, 0xffff0000, v126
  v_lshlrev_b32 v69, 16, v127
  v_and_b32 v73, 0xffff0000, v127
  v_lshlrev_b32 v62, 16, v128
  v_and_b32 v66, 0xffff0000, v128
  v_lshlrev_b32 v70, 16, v129
  v_and_b32 v74, 0xffff0000, v129
  v_lshlrev_b32 v63, 16, v130
  v_and_b32 v67, 0xffff0000, v130
  v_lshlrev_b32 v71, 16, v131
  v_and_b32 v75, 0xffff0000, v131
  v_lshlrev_b32 v80, 16, v18
  v_and_b32 v81, 0xffff0000, v18
  v_lshlrev_b32 v84, 16, v20
  v_and_b32 v85, 0xffff0000, v20
  v_lshlrev_b32 v88, 16, v22
  v_and_b32 v89, 0xffff0000, v22
  v_lshlrev_b32 v92, 16, v24
  v_and_b32 v93, 0xffff0000, v24
  v_lshlrev_b32 v96, 16, v26
  v_and_b32 v97, 0xffff0000, v26
  v_lshlrev_b32 v100, 16, v28
  v_and_b32 v101, 0xffff0000, v28
  v_lshlrev_b32 v104, 16, v30
  s_add_u32 m0, s66, 35840
  s_nop 0
  buffer_load_dwordx4 v227, s[28:31], s65 offen offset:0 lds
  v_and_b32 v105, 0xffff0000, v30
  v_lshlrev_b32 v108, 16, v32
  v_and_b32 v109, 0xffff0000, v32
  v_lshlrev_b32 v112, 16, v34
  v_and_b32 v113, 0xffff0000, v34
  v_lshlrev_b32 v116, 16, v36
  v_and_b32 v117, 0xffff0000, v36
  v_lshlrev_b32 v120, 16, v38
  v_and_b32 v121, 0xffff0000, v38
  v_pk_mul_f32 v[148:149], v[92:93], v[60:61]
  v_pk_fma_f32 v[148:149], v[88:89], v[64:65], v[148:149]
  v_pk_fma_f32 v[148:149], v[84:85], v[68:69], v[148:149]
  v_pk_fma_f32 v[148:149], v[80:81], v[72:73], v[148:149]
  v_lshlrev_b32 v58, 16, v42
  v_and_b32 v59, 0xffff0000, v42
  v_pk_mul_f32 v[148:149], v[148:149], v[58:59]
  v_pk_mul_f32 v[152:153], v[96:97], v[60:61]
  v_pk_fma_f32 v[152:153], v[92:93], v[64:65], v[152:153]
  v_pk_fma_f32 v[152:153], v[88:89], v[68:69], v[152:153]
  v_pk_fma_f32 v[152:153], v[84:85], v[72:73], v[152:153]
  v_lshlrev_b32 v58, 16, v44
  v_and_b32 v59, 0xffff0000, v44
  v_pk_mul_f32 v[152:153], v[152:153], v[58:59]
  v_pk_mul_f32 v[156:157], v[100:101], v[60:61]
  v_pk_fma_f32 v[156:157], v[96:97], v[64:65], v[156:157]
  v_pk_fma_f32 v[156:157], v[92:93], v[68:69], v[156:157]
  v_pk_fma_f32 v[156:157], v[88:89], v[72:73], v[156:157]
  v_lshlrev_b32 v58, 16, v46
  v_and_b32 v59, 0xffff0000, v46
  buffer_load_dwordx4 v228, s[28:31], s65 offen offset:1024 lds
  v_pk_mul_f32 v[156:157], v[156:157], v[58:59]
  v_pk_mul_f32 v[160:161], v[104:105], v[60:61]
  v_pk_fma_f32 v[160:161], v[100:101], v[64:65], v[160:161]
  v_pk_fma_f32 v[160:161], v[96:97], v[68:69], v[160:161]
  v_pk_fma_f32 v[160:161], v[92:93], v[72:73], v[160:161]
  v_lshlrev_b32 v58, 16, v48
  v_and_b32 v59, 0xffff0000, v48
  v_pk_mul_f32 v[160:161], v[160:161], v[58:59]
  v_pk_mul_f32 v[164:165], v[108:109], v[60:61]
  v_pk_fma_f32 v[164:165], v[104:105], v[64:65], v[164:165]
  v_pk_fma_f32 v[164:165], v[100:101], v[68:69], v[164:165]
  v_pk_fma_f32 v[164:165], v[96:97], v[72:73], v[164:165]
  v_lshlrev_b32 v58, 16, v50
  v_and_b32 v59, 0xffff0000, v50
  v_pk_mul_f32 v[164:165], v[164:165], v[58:59]
  v_pk_mul_f32 v[168:169], v[112:113], v[60:61]
  v_pk_fma_f32 v[168:169], v[108:109], v[64:65], v[168:169]
  v_pk_fma_f32 v[168:169], v[104:105], v[68:69], v[168:169]
  v_pk_fma_f32 v[168:169], v[100:101], v[72:73], v[168:169]
  v_lshlrev_b32 v58, 16, v52
  v_and_b32 v59, 0xffff0000, v52
  v_pk_mul_f32 v[168:169], v[168:169], v[58:59]
  v_pk_mul_f32 v[172:173], v[116:117], v[60:61]
  v_pk_fma_f32 v[172:173], v[112:113], v[64:65], v[172:173]
  v_pk_fma_f32 v[172:173], v[108:109], v[68:69], v[172:173]
  v_pk_fma_f32 v[172:173], v[104:105], v[72:73], v[172:173]
  v_lshlrev_b32 v58, 16, v54
  v_and_b32 v59, 0xffff0000, v54
  v_pk_mul_f32 v[172:173], v[172:173], v[58:59]
  buffer_load_dwordx4 v229, s[28:31], s65 offen offset:2048 lds
  s_add_u32 s65, s65, 196608
  s_cmp_eq_u32 s65, 1966080
  s_cselect_b32 s65, 0, s65
  v_pk_mul_f32 v[176:177], v[120:121], v[60:61]
  v_pk_fma_f32 v[176:177], v[116:117], v[64:65], v[176:177]
  v_pk_fma_f32 v[176:177], v[112:113], v[68:69], v[176:177]
  v_pk_fma_f32 v[176:177], v[108:109], v[72:73], v[176:177]
  v_lshlrev_b32 v58, 16, v56
  v_and_b32 v59, 0xffff0000, v56
  v_pk_mul_f32 v[176:177], v[176:177], v[58:59]
  v_lshlrev_b32 v82, 16, v19
  v_and_b32 v83, 0xffff0000, v19
  v_lshlrev_b32 v86, 16, v21
  v_and_b32 v87, 0xffff0000, v21
  v_lshlrev_b32 v90, 16, v23
  v_and_b32 v91, 0xffff0000, v23
  v_lshlrev_b32 v94, 16, v25
  v_and_b32 v95, 0xffff0000, v25
  v_lshlrev_b32 v98, 16, v27
  v_and_b32 v99, 0xffff0000, v27
  v_lshlrev_b32 v102, 16, v29
  v_and_b32 v103, 0xffff0000, v29
  v_lshlrev_b32 v106, 16, v31
  v_and_b32 v107, 0xffff0000, v31
  v_lshlrev_b32 v110, 16, v33
  v_and_b32 v111, 0xffff0000, v33
  v_lshlrev_b32 v114, 16, v35
  v_and_b32 v115, 0xffff0000, v35
  v_lshlrev_b32 v118, 16, v37
  v_and_b32 v119, 0xffff0000, v37
  v_lshlrev_b32 v122, 16, v39
  s_add_u32 m0, s67, 65536
  s_nop 0
  buffer_load_dwordx4 v230, s[8:11], s64 offen offset:0 lds
  v_and_b32 v123, 0xffff0000, v39
  v_pk_mul_f32 v[150:151], v[94:95], v[62:63]
  v_pk_fma_f32 v[150:151], v[90:91], v[66:67], v[150:151]
  v_pk_fma_f32 v[150:151], v[86:87], v[70:71], v[150:151]
  v_pk_fma_f32 v[150:151], v[82:83], v[74:75], v[150:151]
  v_lshlrev_b32 v58, 16, v43
  v_and_b32 v59, 0xffff0000, v43
  v_pk_mul_f32 v[150:151], v[150:151], v[58:59]
  v_pk_mul_f32 v[154:155], v[98:99], v[62:63]
  v_pk_fma_f32 v[154:155], v[94:95], v[66:67], v[154:155]
  v_pk_fma_f32 v[154:155], v[90:91], v[70:71], v[154:155]
  v_pk_fma_f32 v[154:155], v[86:87], v[74:75], v[154:155]
  v_lshlrev_b32 v58, 16, v45
  v_and_b32 v59, 0xffff0000, v45
  v_pk_mul_f32 v[154:155], v[154:155], v[58:59]
  v_pk_mul_f32 v[158:159], v[102:103], v[62:63]
  v_pk_fma_f32 v[158:159], v[98:99], v[66:67], v[158:159]
  v_pk_fma_f32 v[158:159], v[94:95], v[70:71], v[158:159]
  v_pk_fma_f32 v[158:159], v[90:91], v[74:75], v[158:159]
  v_lshlrev_b32 v58, 16, v47
  v_and_b32 v59, 0xffff0000, v47
  v_pk_mul_f32 v[158:159], v[158:159], v[58:59]
  v_pk_mul_f32 v[162:163], v[106:107], v[62:63]
  v_pk_fma_f32 v[162:163], v[102:103], v[66:67], v[162:163]
  v_pk_fma_f32 v[162:163], v[98:99], v[70:71], v[162:163]
  v_pk_fma_f32 v[162:163], v[94:95], v[74:75], v[162:163]
  v_lshlrev_b32 v58, 16, v49
  v_and_b32 v59, 0xffff0000, v49
  v_pk_mul_f32 v[162:163], v[162:163], v[58:59]
  buffer_load_dwordx4 v231, s[8:11], s64 offen offset:1024 lds
  s_add_u32 s64, s64, 128
  s_cmp_eq_u32 s64, 1280
  s_cselect_b32 s64, 0, s64
  v_pk_mul_f32 v[166:167], v[110:111], v[62:63]
  v_pk_fma_f32 v[166:167], v[106:107], v[66:67], v[166:167]
  v_pk_fma_f32 v[166:167], v[102:103], v[70:71], v[166:167]
  v_pk_fma_f32 v[166:167], v[98:99], v[74:75], v[166:167]
  v_lshlrev_b32 v58, 16, v51
  v_and_b32 v59, 0xffff0000, v51
  v_pk_mul_f32 v[166:167], v[166:167], v[58:59]
  v_pk_mul_f32 v[170:171], v[114:115], v[62:63]
  v_pk_fma_f32 v[170:171], v[110:111], v[66:67], v[170:171]
  v_pk_fma_f32 v[170:171], v[106:107], v[70:71], v[170:171]
  v_pk_fma_f32 v[170:171], v[102:103], v[74:75], v[170:171]
  v_lshlrev_b32 v58, 16, v53
  v_and_b32 v59, 0xffff0000, v53
  v_pk_mul_f32 v[170:171], v[170:171], v[58:59]
  v_pk_mul_f32 v[174:175], v[118:119], v[62:63]
  v_pk_fma_f32 v[174:175], v[114:115], v[66:67], v[174:175]
  v_pk_fma_f32 v[174:175], v[110:111], v[70:71], v[174:175]
  v_pk_fma_f32 v[174:175], v[106:107], v[74:75], v[174:175]
  v_lshlrev_b32 v58, 16, v55
  v_and_b32 v59, 0xffff0000, v55
  v_pk_mul_f32 v[174:175], v[174:175], v[58:59]
  v_pk_mul_f32 v[178:179], v[122:123], v[62:63]
  v_pk_fma_f32 v[178:179], v[118:119], v[66:67], v[178:179]
  v_pk_fma_f32 v[178:179], v[114:115], v[70:71], v[178:179]
  v_pk_fma_f32 v[178:179], v[110:111], v[74:75], v[178:179]
  v_lshlrev_b32 v58, 16, v57
  v_and_b32 v59, 0xffff0000, v57
  v_pk_mul_f32 v[178:179], v[178:179], v[58:59]
  v_cvt_pk_bf16_f32 v180, v176, v172
  v_cvt_pk_bf16_f32 v181, v168, v164
  v_cvt_pk_bf16_f32 v182, v160, v156
  v_cvt_pk_bf16_f32 v183, v152, v148
  s_mov_b32 exec_hi, 0xff
  buffer_store_dwordx4 v[180:183], v196, s[44:47], s83 offen sc1
  s_mov_b32 exec_hi, -1
  s_add_u32 s83, s83, 4096
  v_cvt_pk_bf16_f32 v184, v177, v173
  v_cvt_pk_bf16_f32 v185, v169, v165
  v_cvt_pk_bf16_f32 v186, v161, v157
  v_cvt_pk_bf16_f32 v187, v153, v149
  s_mov_b32 exec_hi, 0xff
  buffer_store_dwordx4 v[184:187], v196, s[44:47], s83 offen sc1
  s_mov_b32 exec_hi, -1
  s_add_u32 s83, s83, 4096
  v_cvt_pk_bf16_f32 v188, v178, v174
  v_cvt_pk_bf16_f32 v189, v170, v166
  v_cvt_pk_bf16_f32 v190, v162, v158
  v_cvt_pk_bf16_f32 v191, v154, v150
  s_mov_b32 exec_hi, 0xff
  buffer_store_dwordx4 v[188:191], v196, s[44:47], s83 offen sc1
  s_mov_b32 exec_hi, -1
  s_add_u32 s83, s83, 4096
  v_cvt_pk_bf16_f32 v192, v179, v175
  v_cvt_pk_bf16_f32 v193, v171, v167
  v_cvt_pk_bf16_f32 v194, v163, v159
  v_cvt_pk_bf16_f32 v195, v155, v151
  s_mov_b32 exec_hi, 0xff
  buffer_store_dwordx4 v[192:195], v196, s[44:47], s83 offen sc1
  s_mov_b32 exec_hi, -1
  s_add_u32 s83, s83, 4096
  s_waitcnt vmcnt(14)
  s_barrier
  ds_read_b128 v[112:115], v238 offset:0
  ds_read_b128 v[116:119], v239 offset:0
  ds_read_b64_tr_b16 v[64:65], v232 offset:0
  ds_read_b64_tr_b16 v[66:67], v232 offset:1536
  ds_read_b64_tr_b16 v[68:69], v233 offset:0
  ds_read_b64_tr_b16 v[70:71], v233 offset:1536
  ds_read_b64_tr_b16 v[72:73], v234 offset:0
  ds_read_b64_tr_b16 v[74:75], v234 offset:1536
  ds_read_b64_tr_b16 v[76:77], v235 offset:0
  ds_read_b64_tr_b16 v[78:79], v235 offset:1536
  ds_read_b64_tr_b16 v[80:81], v236 offset:0
  ds_read_b64_tr_b16 v[82:83], v236 offset:1536
  ds_read_b64_tr_b16 v[84:85], v237 offset:0
  ds_read_b64_tr_b16 v[86:87], v237 offset:1536
  ds_read_b128 v[128:131], v252 offset:0
  s_add_u32 m0, s66, 65536
  s_nop 0
  buffer_load_dwordx4 v224, s[28:31], s65 offen offset:0 lds
  buffer_load_dwordx4 v225, s[28:31], s65 offen offset:1024 lds
  buffer_load_dwordx4 v226, s[28:31], s65 offen offset:2048 lds
  s_add_u32 m0, s66, 68608
  s_nop 0
  buffer_load_dwordx4 v227, s[28:31], s65 offen offset:0 lds
  s_waitcnt lgkmcnt(0)
  buffer_load_dwordx4 v228, s[28:31], s65 offen offset:1024 lds
  v_mfma_f32_16x16x32_bf16 v[16:19], v[64:67], v[112:115], 0
  ds_read_b128 v[120:123], v240 offset:0
  ds_read_b128 v[124:127], v241 offset:0
  v_mfma_f32_16x16x32_bf16 v[40:43], v[64:67], v[116:119], 0
  ds_read_b64_tr_b16 v[88:89], v232 offset:12288
  ds_read_b64_tr_b16 v[90:91], v232 offset:13824
  v_mfma_f32_16x16x32_bf16 v[20:23], v[68:71], v[112:115], 0
  ds_read_b64_tr_b16 v[92:93], v233 offset:12288
  ds_read_b64_tr_b16 v[94:95], v233 offset:13824
  v_mfma_f32_16x16x32_bf16 v[44:47], v[68:71], v[116:119], 0
  ds_read_b64_tr_b16 v[96:97], v234 offset:12288
  ds_read_b64_tr_b16 v[98:99], v234 offset:13824
  v_mfma_f32_16x16x32_bf16 v[24:27], v[72:75], v[112:115], 0
  ds_read_b64_tr_b16 v[100:101], v235 offset:12288
  ds_read_b64_tr_b16 v[102:103], v235 offset:13824
  v_mfma_f32_16x16x32_bf16 v[48:51], v[72:75], v[116:119], 0
  ds_read_b64_tr_b16 v[104:105], v236 offset:12288
  ds_read_b64_tr_b16 v[106:107], v236 offset:13824
  buffer_load_dwordx4 v229, s[28:31], s65 offen offset:2048 lds
  s_add_u32 s65, s65, 196608
  s_cmp_eq_u32 s65, 1966080
  s_cselect_b32 s65, 0, s65
  v_mfma_f32_16x16x32_bf16 v[28:31], v[76:79], v[112:115], 0
  ds_read_b64_tr_b16 v[108:109], v237 offset:12288
  ds_read_b64_tr_b16 v[110:111], v237 offset:13824
  v_mfma_f32_16x16x32_bf16 v[52:55], v[76:79], v[116:119], 0
  ds_read_b128 v[132:135], v252 offset:64
  v_mfma_f32_16x16x32_bf16 v[32:35], v[80:83], v[112:115], 0
  v_mfma_f32_16x16x32_bf16 v[56:59], v[80:83], v[116:119], 0
  v_mfma_f32_16x16x32_bf16 v[36:39], v[84:87], v[112:115], 0
  v_mfma_f32_16x16x32_bf16 v[60:63], v[84:87], v[116:119], 0
  v_mfma_f32_16x16x32_bf16 v[12:15], v[128:131], v[112:115], 0
  s_waitcnt lgkmcnt(0)
  s_mov_b64 exec, 0
  s_cmp_eq_u32 s68, 0
  s_cbranch_scc1 L_st2
  s_cmp_eq_u32 s68, 1
  s_cbranch_scc1 L_st9
  s_cmp_eq_u32 s68, 2
  s_cbranch_scc1 L_st3
  s_cmp_eq_u32 s68, 3
  s_cbranch_scc1 L_st8
  s_cmp_eq_u32 s68, 4
  s_cbranch_scc1 L_st11
  s_cmp_eq_u32 s68, 5
  s_cbranch_scc1 L_st6
  s_cmp_eq_u32 s68, 6
  s_cbranch_scc1 L_st12
  s_cmp_eq_u32 s68, 7
  s_cbranch_scc1 L_st5
L_hb2:
  s_mov_b64 exec, -1
  s_waitcnt vmcnt(12)
  s_barrier
  s_add_u32 m0, s67, 0
  s_nop 0
  buffer_load_dwordx4 v230, s[8:11], s64 offen offset:0 lds
  v_mfma_f32_16x16x32_bf16 v[16:19], v[88:91], v[120:123], v[16:19]
  ds_read_b128 v[112:115], v238 offset:32768
  ds_read_b128 v[116:119], v239 offset:32768
  ds_read_b64_tr_b16 v[200:201], v197
  ds_read_b64_tr_b16 v[202:203], v197 offset:2560
  v_mfma_f32_16x16x32_bf16 v[40:43], v[88:91], v[124:127], v[40:43]
  ds_read_b64_tr_b16 v[64:65], v232 offset:32768
  ds_read_b64_tr_b16 v[66:67], v232 offset:34304
  v_mfma_f32_16x16x32_bf16 v[20:23], v[92:95], v[120:123], v[20:23]
  ds_read_b64_tr_b16 v[68:69], v233 offset:32768
  ds_read_b64_tr_b16 v[70:71], v233 offset:34304
  buffer_load_dwordx4 v231, s[8:11], s64 offen offset:1024 lds
  s_add_u32 s64, s64, 128
  s_cmp_eq_u32 s64, 1280
  s_cselect_b32 s64, 0, s64
  v_mfma_f32_16x16x32_bf16 v[44:47], v[92:95], v[124:127], v[44:47]
  ds_read_b64_tr_b16 v[72:73], v234 offset:32768
  ds_read_b64_tr_b16 v[74:75], v234 offset:34304
  ds_read_b64_tr_b16 v[204:205], v198
  ds_read_b64_tr_b16 v[206:207], v198 offset:2560
  v_mfma_f32_16x16x32_bf16 v[24:27], v[96:99], v[120:123], v[24:27]
  ds_read_b64_tr_b16 v[76:77], v235 offset:32768
  ds_read_b64_tr_b16 v[78:79], v235 offset:34304
  v_mfma_f32_16x16x32_bf16 v[48:51], v[96:99], v[124:127], v[48:51]
  ds_read_b64_tr_b16 v[80:81], v236 offset:32768
  ds_read_b64_tr_b16 v[82:83], v236 offset:34304
  s_add_u32 m0, s66, 0
  s_nop 0
  buffer_load_dwordx4 v224, s[28:31], s65 offen offset:0 lds
  v_mfma_f32_16x16x32_bf16 v[28:31], v[100:103], v[120:123], v[28:31]
  ds_read_b64_tr_b16 v[84:85], v237 offset:32768
  ds_read_b64_tr_b16 v[86:87], v237 offset:34304
  v_mfma_f32_16x16x32_bf16 v[52:55], v[100:103], v[124:127], v[52:55]
  ds_read_b128 v[128:131], v252 offset:128
  buffer_load_dwordx4 v225, s[28:31], s65 offen offset:1024 lds
  v_mfma_f32_16x16x32_bf16 v[32:35], v[104:107], v[120:123], v[32:35]
  ds_read_b64_tr_b16 v[208:209], v199
  ds_read_b64_tr_b16 v[210:211], v199 offset:2560
  v_mfma_f32_16x16x32_bf16 v[56:59], v[104:107], v[124:127], v[56:59]
  v_mfma_f32_16x16x32_bf16 v[36:39], v[108:111], v[120:123], v[36:39]
  buffer_load_dwordx4 v226, s[28:31], s65 offen offset:2048 lds
  v_mfma_f32_16x16x32_bf16 v[60:63], v[108:111], v[124:127], v[60:63]
  v_mfma_f32_16x16x32_bf16 v[12:15], v[132:135], v[120:123], v[12:15]
  s_waitcnt lgkmcnt(0)
  s_add_u32 m0, s66, 3072
  s_nop 0
  buffer_load_dwordx4 v227, s[28:31], s65 offen offset:0 lds
  v_mfma_f32_16x16x32_bf16 v[16:19], v[64:67], v[112:115], v[16:19]
  ds_read_b128 v[120:123], v240 offset:32768
  ds_read_b128 v[124:127], v241 offset:32768
  v_mfma_f32_16x16x32_bf16 v[40:43], v[64:67], v[116:119], v[40:43]
  ds_read_b64_tr_b16 v[88:89], v232 offset:45056
  ds_read_b64_tr_b16 v[90:91], v232 offset:46592
  v_mfma_f32_16x16x32_bf16 v[20:23], v[68:71], v[112:115], v[20:23]
  ds_read_b64_tr_b16 v[92:93], v233 offset:45056
  ds_read_b64_tr_b16 v[94:95], v233 offset:46592
  buffer_load_dwordx4 v228, s[28:31], s65 offen offset:1024 lds
  v_mfma_f32_16x16x32_bf16 v[44:47], v[68:71], v[116:119], v[44:47]
  ds_read_b64_tr_b16 v[96:97], v234 offset:45056
  ds_read_b64_tr_b16 v[98:99], v234 offset:46592
  v_mfma_f32_16x16x32_bf16 v[24:27], v[72:75], v[112:115], v[24:27]
  ds_read_b64_tr_b16 v[100:101], v235 offset:45056
  ds_read_b64_tr_b16 v[102:103], v235 offset:46592
  v_mfma_f32_16x16x32_bf16 v[48:51], v[72:75], v[116:119], v[48:51]
  ds_read_b64_tr_b16 v[104:105], v236 offset:45056
  ds_read_b64_tr_b16 v[106:107], v236 offset:46592
  buffer_load_dwordx4 v229, s[28:31], s65 offen offset:2048 lds
  s_add_u32 s65, s65, 196608
  s_cmp_eq_u32 s65, 1966080
  s_cselect_b32 s65, 0, s65
  v_mfma_f32_16x16x32_bf16 v[28:31], v[76:79], v[112:115], v[28:31]
  ds_read_b64_tr_b16 v[108:109], v237 offset:45056
  ds_read_b64_tr_b16 v[110:111], v237 offset:46592
  v_mfma_f32_16x16x32_bf16 v[52:55], v[76:79], v[116:119], v[52:55]
  ds_read_b128 v[132:135], v252 offset:192
  v_mfma_f32_16x16x32_bf16 v[32:35], v[80:83], v[112:115], v[32:35]
  s_cmp_lt_u32 s4, 8
  s_cbranch_scc1 L_now2c
  buffer_store_dwordx4 v[200:203], v1, s[44:47], s84 offen sc1
  s_add_u32 s84, s84, 4096
  buffer_store_dwordx4 v[204:207], v1, s[44:47], s84 offen sc1
  s_add_u32 s84, s84, 4096
  s_cmp_ge_u32 s6, 2
  s_cbranch_scc1 L_now2c
  buffer_store_dwordx4 v[208:211], v1, s[44:47], s84 offen sc1
  s_add_u32 s84, s84, 4096
L_now2c:
  v_mfma_f32_16x16x32_bf16 v[56:59], v[80:83], v[116:119], v[56:59]
  v_mfma_f32_16x16x32_bf16 v[36:39], v[84:87], v[112:115], v[36:39]
  v_mfma_f32_16x16x32_bf16 v[60:63], v[84:87], v[116:119], v[60:63]
  v_mfma_f32_16x16x32_bf16 v[12:15], v[128:131], v[112:115], v[12:15]
  s_waitcnt lgkmcnt(0)
  s_waitcnt vmcnt(8)
  s_barrier
  s_add_u32 m0, s67, 32768
  s_nop 0
  buffer_load_dwordx4 v230, s[8:11], s64 offen offset:0 lds
  v_mfma_f32_16x16x32_bf16 v[16:19], v[88:91], v[120:123], v[16:19]
  ds_read_b128 v[112:115], v248 offset:0
  ds_read_b128 v[116:119], v249 offset:0
  v_mov_b32 v216, 0
  v_mov_b32 v217, 0
  v_mov_b32 v218, 0
  v_mov_b32 v219, 0
  v_mfma_f32_16x16x32_bf16 v[40:43], v[88:91], v[124:127], v[40:43]
  ds_read_b64_tr_b16 v[64:65], v242 offset:0
  ds_read_b64_tr_b16 v[66:67], v242 offset:1536
  buffer_load_dwordx4 v231, s[8:11], s64 offen offset:1024 lds
  s_add_u32 s64, s64, 128
  s_cmp_eq_u32 s64, 1280
  s_cselect_b32 s64, 0, s64
  v_mfma_f32_16x16x32_bf16 v[20:23], v[92:95], v[120:123], v[20:23]
  ds_read_b64_tr_b16 v[68:69], v243 offset:0
  ds_read_b64_tr_b16 v[70:71], v243 offset:1536
  v_lshrrev_b32 v220, 5, v0
  v_mul_u32_u24 v220, 4576, v220
  v_and_b32 v221, 31, v0
  v_mfma_f32_16x16x32_bf16 v[44:47], v[92:95], v[124:127], v[44:47]
  ds_read_b64_tr_b16 v[72:73], v244 offset:0
  ds_read_b64_tr_b16 v[74:75], v244 offset:1536
  v_mfma_f32_16x16x32_bf16 v[24:27], v[96:99], v[120:123], v[24:27]
  ds_read_b64_tr_b16 v[76:77], v245 offset:0
  ds_read_b64_tr_b16 v[78:79], v245 offset:1536
  s_add_u32 m0, s66, 32768
  s_nop 0
  buffer_load_dwordx4 v224, s[28:31], s65 offen offset:0 lds
  v_mfma_f32_16x16x32_bf16 v[48:51], v[96:99], v[124:127], v[48:51]
  ds_read_b64_tr_b16 v[80:81], v246 offset:0
  ds_read_b64_tr_b16 v[82:83], v246 offset:1536
  v_lshl_add_u32 v220, v221, 4, v220
  v_add_u32 v220, s69, v220
  s_and_b32 exec_lo, s62, 0x0fffffff
  s_and_b32 exec_hi, s62, 0x0fffffff
  ds_write_b128 v220, v[216:219] offset:4096
  s_mov_b64 exec, -1
  v_mfma_f32_16x16x32_bf16 v[28:31], v[100:103], v[120:123], v[28:31]
  ds_read_b64_tr_b16 v[84:85], v247 offset:0
  ds_read_b64_tr_b16 v[86:87], v247 offset:1536
  buffer_load_dwordx4 v225, s[28:31], s65 offen offset:1024 lds
  v_mfma_f32_16x16x32_bf16 v[52:55], v[100:103], v[124:127], v[52:55]
  ds_read_b128 v[128:131], v252 offset:256
  v_mfma_f32_16x16x32_bf16 v[32:35], v[104:107], v[120:123], v[32:35]
  s_bitcmp1_b32 s70, 12
  s_cselect_b32 s80, 0, 16
  s_lshl_b32 s96, s96, s80
  s_and_b32 s96, s96, 0xffff0000
  v_mfma_f32_16x16x32_bf16 v[56:59], v[104:107], v[124:127], v[56:59]
  buffer_load_dwordx4 v226, s[28:31], s65 offen offset:2048 lds
  v_mfma_f32_16x16x32_bf16 v[36:39], v[108:111], v[120:123], v[36:39]
  s_lshl_b32 s80, s94, 16
  v_mov_b32 v220, s80
  v_add_f32 v220, s96, v220
  s_and_b32 s80, s94, 0xffff0000
  v_mov_b32 v221, s80
  v_mfma_f32_16x16x32_bf16 v[60:63], v[108:111], v[124:127], v[60:63]
  v_mfma_f32_16x16x32_bf16 v[12:15], v[132:135], v[120:123], v[12:15]
  s_waitcnt lgkmcnt(0)
  v_cvt_pk_bf16_f32 v220, v220, v221
  v_mov_b32 v222, 0
  v_readfirstlane_b32 s80, v220
  v_mfma_f32_16x16x32_bf16 v[16:19], v[64:67], v[112:115], v[16:19]
  ds_read_b128 v[120:123], v250 offset:0
  ds_read_b128 v[124:127], v251 offset:0
  s_add_u32 m0, s66, 35840
  s_nop 0
  buffer_load_dwordx4 v227, s[28:31], s65 offen offset:0 lds
  v_mfma_f32_16x16x32_bf16 v[40:43], v[64:67], v[116:119], v[40:43]
  ds_read_b64_tr_b16 v[88:89], v242 offset:12288
  ds_read_b64_tr_b16 v[90:91], v242 offset:13824
  v_mfma_f32_16x16x32_bf16 v[20:23], v[68:71], v[112:115], v[20:23]
  ds_read_b64_tr_b16 v[92:93], v243 offset:12288
  ds_read_b64_tr_b16 v[94:95], v243 offset:13824
  v_lshrrev_b32 v220, 4, v0
  v_mul_u32_u24 v220, 4224, v220
  v_and_b32 v221, 15, v0
  v_lshl_add_u32 v220, v221, 2, v220
  v_mfma_f32_16x16x32_bf16 v[44:47], v[68:71], v[116:119], v[44:47]
  ds_read_b64_tr_b16 v[96:97], v244 offset:12288
  ds_read_b64_tr_b16 v[98:99], v244 offset:13824
  buffer_load_dwordx4 v228, s[28:31], s65 offen offset:1024 lds
  v_mfma_f32_16x16x32_bf16 v[24:27], v[72:75], v[112:115], v[24:27]
  ds_read_b64_tr_b16 v[100:101], v245 offset:12288
  ds_read_b64_tr_b16 v[102:103], v245 offset:13824
  v_mfma_f32_16x16x32_bf16 v[48:51], v[72:75], v[116:119], v[48:51]
  ds_read_b64_tr_b16 v[104:105], v246 offset:12288
  ds_read_b64_tr_b16 v[106:107], v246 offset:13824
  v_writelane_b32 v222, s80, 14
  v_writelane_b32 v222, s95, 15
  v_writelane_b32 v222, s80, 31
  v_mfma_f32_16x16x32_bf16 v[28:31], v[76:79], v[112:115], v[28:31]
  ds_read_b64_tr_b16 v[108:109], v247 offset:12288
  ds_read_b64_tr_b16 v[110:111], v247 offset:13824
  v_mfma_f32_16x16x32_bf16 v[52:55], v[76:79], v[116:119], v[52:55]
  ds_read_b128 v[132:135], v252 offset:320
  s_add_u32 s80, s69, 9152
  v_add_u32 v220, s80, v220
  s_mov_b32 exec_lo, s62
  s_mov_b32 exec_hi, 0
  ds_write_b32 v220, v222
  s_mov_b64 exec, -1
  v_mfma_f32_16x16x32_bf16 v[32:35], v[80:83], v[112:115], v[32:35]
  buffer_load_dwordx4 v229, s[28:31], s65 offen offset:2048 lds
  s_add_u32 s65, s65, 196608
  s_cmp_eq_u32 s65, 1966080
  s_cselect_b32 s65, 0, s65
  v_mfma_f32_16x16x32_bf16 v[56:59], v[80:83], v[116:119], v[56:59]
  v_mfma_f32_16x16x32_bf16 v[36:39], v[84:87], v[112:115], v[36:39]
  s_add_u32 s60, s60, 0x9e3779b9
  s_add_u32 s61, s61, 0x9e3779b9
  v_mov_b32 v6, s60
  v_mov_b32 v7, s61
  v_mfma_f32_16x16x32_bf16 v[60:63], v[84:87], v[116:119], v[60:63]
  v_mfma_f32_16x16x32_bf16 v[12:15], v[128:131], v[112:115], v[12:15]
  s_waitcnt lgkmcnt(0)
  s_waitcnt vmcnt(8)
  s_barrier
  s_cmp_eq_u32 s6, 3
  s_cselect_b64 exec, 1, 0
  buffer_store_dword v6, off, s[44:47], s85 sc1
  s_mov_b64 exec, -1
  s_add_u32 m0, s67, 65536
  s_nop 0
  buffer_load_dwordx4 v230, s[8:11], s64 offen offset:0 lds
  v_mfma_f32_16x16x32_bf16 v[16:19], v[88:91], v[120:123], v[16:19]
  ds_read_b128 v[112:115], v238 offset:0
  ds_read_b128 v[116:119], v239 offset:0
  v_mfma_f32_16x16x32_bf16 v[40:43], v[88:91], v[124:127], v[40:43]
  ds_read_b64_tr_b16 v[64:65], v232 offset:0
  ds_read_b64_tr_b16 v[66:67], v232 offset:1536
  buffer_load_dwordx4 v231, s[8:11], s64 offen offset:1024 lds
  s_add_u32 s64, s64, 128
  s_cmp_eq_u32 s64, 1280
  s_cselect_b32 s64, 0, s64
  v_mfma_f32_16x16x32_bf16 v[20:23], v[92:95], v[120:123], v[20:23]
  ds_read_b64_tr_b16 v[68:69], v233 offset:0
  ds_read_b64_tr_b16 v[70:71], v233 offset:1536
  v_mfma_f32_16x16x32_bf16 v[44:47], v[92:95], v[124:127], v[44:47]
  ds_read_b64_tr_b16 v[72:73], v234 offset:0
  ds_read_b64_tr_b16 v[74:75], v234 offset:1536
  v_mfma_f32_16x16x32_bf16 v[24:27], v[96:99], v[120:123], v[24:27]
  ds_read_b64_tr_b16 v[76:77], v235 offset:0
  ds_read_b64_tr_b16 v[78:79], v235 offset:1536
  s_add_u32 m0, s66, 65536
  s_nop 0
  buffer_load_dwordx4 v224, s[28:31], s65 offen offset:0 lds
  v_mfma_f32_16x16x32_bf16 v[48:51], v[96:99], v[124:127], v[48:51]
  ds_read_b64_tr_b16 v[80:81], v236 offset:0
  ds_read_b64_tr_b16 v[82:83], v236 offset:1536
L_st0:
  s_cbranch_execz L_hb2
  v_mfma_f32_16x16x32_bf16 v[28:31], v[100:103], v[120:123], v[28:31]
  ds_read_b64_tr_b16 v[84:85], v237 offset:0
  ds_read_b64_tr_b16 v[86:87], v237 offset:1536
  buffer_load_dwordx4 v225, s[28:31], s65 offen offset:1024 lds
  v_mfma_f32_16x16x32_bf16 v[52:55], v[100:103], v[124:127], v[52:55]
  ds_read_b128 v[128:131], v252 offset:384
  v_mfma_f32_16x16x32_bf16 v[32:35], v[104:107], v[120:123], v[32:35]
  v_mfma_f32_16x16x32_bf16 v[56:59], v[104:107], v[124:127], v[56:59]
  buffer_load_dwordx4 v226, s[28:31], s65 offen offset:2048 lds
  v_mfma_f32_16x16x32_bf16 v[36:39], v[108:111], v[120:123], v[36:39]
  v_mfma_f32_16x16x32_bf16 v[60:63], v[108:111], v[124:127], v[60:63]
  v_mfma_f32_16x16x32_bf16 v[12:15], v[132:135], v[120:123], v[12:15]
  s_waitcnt lgkmcnt(0)
  s_add_u32 m0, s66, 68608
  s_nop 0
  buffer_load_dwordx4 v227, s[28:31], s65 offen offset:0 lds
  v_mfma_f32_16x16x32_bf16 v[16:19], v[64:67], v[112:115], v[16:19]
  ds_read_b128 v[120:123], v240 offset:0
  ds_read_b128 v[124:127], v241 offset:0
  v_mfma_f32_16x16x32_bf16 v[40:43], v[64:67], v[116:119], v[40:43]
  ds_read_b64_tr_b16 v[88:89], v232 offset:12288
  ds_read_b64_tr_b16 v[90:91], v232 offset:13824
  v_mfma_f32_16x16x32_bf16 v[20:23], v[68:71], v[112:115], v[20:23]
  ds_read_b64_tr_b16 v[92:93], v233 offset:12288
  ds_read_b64_tr_b16 v[94:95], v233 offset:13824
  v_mfma_f32_16x16x32_bf16 v[44:47], v[68:71], v[116:119], v[44:47]
  ds_read_b64_tr_b16 v[96:97], v234 offset:12288
  ds_read_b64_tr_b16 v[98:99], v234 offset:13824
  buffer_load_dwordx4 v228, s[28:31], s65 offen offset:1024 lds
  v_mfma_f32_16x16x32_bf16 v[24:27], v[72:75], v[112:115], v[24:27]
  ds_read_b64_tr_b16 v[100:101], v235 offset:12288
  ds_read_b64_tr_b16 v[102:103], v235 offset:13824
  v_mfma_f32_16x16x32_bf16 v[48:51], v[72:75], v[116:119], v[48:51]
  ds_read_b64_tr_b16 v[104:105], v236 offset:12288
  ds_read_b64_tr_b16 v[106:107], v236 offset:13824
  v_mfma_f32_16x16x32_bf16 v[28:31], v[76:79], v[112:115], v[28:31]
  ds_read_b64_tr_b16 v[108:109], v237 offset:12288
  ds_read_b64_tr_b16 v[110:111], v237 offset:13824
  v_mfma_f32_16x16x32_bf16 v[52:55], v[76:79], v[116:119], v[52:55]
  ds_read_b128 v[132:135], v252 offset:448
  buffer_load_dwordx4 v229, s[28:31], s65 offen offset:2048 lds
  s_add_u32 s65, s65, 196608
  s_cmp_eq_u32 s65, 1966080
  s_cselect_b32 s65, 0, s65
  v_mfma_f32_16x16x32_bf16 v[32:35], v[80:83], v[112:115], v[32:35]
  v_mfma_f32_16x16x32_bf16 v[56:59], v[80:83], v[116:119], v[56:59]
  v_mfma_f32_16x16x32_bf16 v[36:39], v[84:87], v[112:115], v[36:39]
  v_mfma_f32_16x16x32_bf16 v[60:63], v[84:87], v[116:119], v[60:63]
  v_mfma_f32_16x16x32_bf16 v[12:15], v[128:131], v[112:115], v[12:15]
  s_waitcnt lgkmcnt(0)
  s_waitcnt vmcnt(9)
  s_barrier
  s_add_u32 m0, s67, 0
  s_nop 0
  buffer_load_dwordx4 v230, s[8:11], s64 offen offset:0 lds
  v_mfma_f32_16x16x32_bf16 v[16:19], v[88:91], v[120:123], v[16:19]
  ds_read_b128 v[112:115], v238 offset:32768
  ds_read_b128 v[116:119], v239 offset:32768
  v_mfma_f32_16x16x32_bf16 v[40:43], v[88:91], v[124:127], v[40:43]
  ds_read_b64_tr_b16 v[64:65], v232 offset:32768
  ds_read_b64_tr_b16 v[66:67], v232 offset:34304
  buffer_load_dwordx4 v231, s[8:11], s64 offen offset:1024 lds
  s_add_u32 s64, s64, 128
  s_cmp_eq_u32 s64, 1280
  s_cselect_b32 s64, 0, s64
  v_mfma_f32_16x16x32_bf16 v[20:23], v[92:95], v[120:123], v[20:23]
  ds_read_b64_tr_b16 v[68:69], v233 offset:32768
  ds_read_b64_tr_b16 v[70:71], v233 offset:34304
  v_mfma_f32_16x16x32_bf16 v[44:47], v[92:95], v[124:127], v[44:47]
  ds_read_b64_tr_b16 v[72:73], v234 offset:32768
  ds_read_b64_tr_b16 v[74:75], v234 offset:34304
  v_mfma_f32_16x16x32_bf16 v[24:27], v[96:99], v[120:123], v[24:27]
  ds_read_b64_tr_b16 v[76:77], v235 offset:32768
  ds_read_b64_tr_b16 v[78:79], v235 offset:34304
  s_add_u32 m0, s66, 0
  s_nop 0
  buffer_load_dwordx4 v224, s[28:31], s65 offen offset:0 lds
  v_mfma_f32_16x16x32_bf16 v[48:51], v[96:99], v[124:127], v[48:51]
  ds_read_b64_tr_b16 v[80:81], v236 offset:32768
  ds_read_b64_tr_b16 v[82:83], v236 offset:34304
  v_mfma_f32_16x16x32_bf16 v[28:31], v[100:103], v[120:123], v[28:31]
  ds_read_b64_tr_b16 v[84:85], v237 offset:32768
  ds_read_b64_tr_b16 v[86:87], v237 offset:34304
  buffer_load_dwordx4 v225, s[28:31], s65 offen offset:1024 lds
  v_mfma_f32_16x16x32_bf16 v[52:55], v[100:103], v[124:127], v[52:55]
  ds_read_b128 v[128:131], v252 offset:512
  v_mfma_f32_16x16x32_bf16 v[32:35], v[104:107], v[120:123], v[32:35]
  v_mfma_f32_16x16x32_bf16 v[56:59], v[104:107], v[124:127], v[56:59]
  buffer_load_dwordx4 v226, s[28:31], s65 offen offset:2048 lds
  v_mfma_f32_16x16x32_bf16 v[36:39], v[108:111], v[120:123], v[36:39]
  v_mfma_f32_16x16x32_bf16 v[60:63], v[108:111], v[124:127], v[60:63]
  v_mfma_f32_16x16x32_bf16 v[12:15], v[132:135], v[120:123], v[12:15]
  s_waitcnt lgkmcnt(0)
  s_add_u32 m0, s66, 3072
  s_nop 0
  buffer_load_dwordx4 v227, s[28:31], s65 offen offset:0 lds
  v_mfma_f32_16x16x32_bf16 v[16:19], v[64:67], v[112:115], v[16:19]
  ds_read_b128 v[120:123], v240 offset:32768
  ds_read_b128 v[124:127], v241 offset:32768
  v_mfma_f32_16x16x32_bf16 v[40:43], v[64:67], v[116:119], v[40:43]
  ds_read_b64_tr_b16 v[88:89], v232 offset:45056
  ds_read_b64_tr_b16 v[90:91], v232 offset:46592
  v_mfma_f32_16x16x32_bf16 v[20:23], v[68:71], v[112:115], v[20:23]
  ds_read_b64_tr_b16 v[92:93], v233 offset:45056
  ds_read_b64_tr_b16 v[94:95], v233 offset:46592
  v_mfma_f32_16x16x32_bf16 v[44:47], v[68:71], v[116:119], v[44:47]
  ds_read_b64_tr_b16 v[96:97], v234 offset:45056
  ds_read_b64_tr_b16 v[98:99], v234 offset:46592
  buffer_load_dwordx4 v228, s[28:31], s65 offen offset:1024 lds
  v_mfma_f32_16x16x32_bf16 v[24:27], v[72:75], v[112:115], v[24:27]
  ds_read_b64_tr_b16 v[100:101], v235 offset:45056
  ds_read_b64_tr_b16 v[102:103], v235 offset:46592
  v_mfma_f32_16x16x32_bf16 v[48:51], v[72:75], v[116:119], v[48:51]
  ds_read_b64_tr_b16 v[104:105], v236 offset:45056
  ds_read_b64_tr_b16 v[106:107], v236 offset:46592
  v_mfma_f32_16x16x32_bf16 v[28:31], v[76:79], v[112:115], v[28:31]
  ds_read_b64_tr_b16 v[108:109], v237 offset:45056
  ds_read_b64_tr_b16 v[110:111], v237 offset:46592
  v_mfma_f32_16x16x32_bf16 v[52:55], v[76:79], v[116:119], v[52:55]
  ds_read_b128 v[132:135], v252 offset:576
  buffer_load_dwordx4 v229, s[28:31], s65 offen offset:2048 lds
  s_add_u32 s65, s65, 196608
  s_cmp_eq_u32 s65, 1966080
  s_cselect_b32 s65, 0, s65
  v_mfma_f32_16x16x32_bf16 v[32:35], v[80:83], v[112:115], v[32:35]
  v_mfma_f32_16x16x32_bf16 v[56:59], v[80:83], v[116:119], v[56:59]
  v_mfma_f32_16x16x32_bf16 v[36:39], v[84:87], v[112:115], v[36:39]
  v_mfma_f32_16x16x32_bf16 v[60:63], v[84:87], v[116:119], v[60:63]
  v_mfma_f32_16x16x32_bf16 v[12:15], v[128:131], v[112:115], v[12:15]
  s_waitcnt lgkmcnt(0)
  s_waitcnt vmcnt(8)
  s_barrier
  s_add_u32 m0, s67, 32768
  s_nop 0
  buffer_load_dwordx4 v230, s[8:11], s64 offen offset:0 lds
  v_mfma_f32_16x16x32_bf16 v[16:19], v[88:91], v[120:123], v[16:19]
  ds_read_b128 v[112:115], v248 offset:0
  ds_read_b128 v[116:119], v249 offset:0
  v_mfma_f32_16x16x32_bf16 v[40:43], v[88:91], v[124:127], v[40:43]
  ds_read_b64_tr_b16 v[64:65], v242 offset:0
  ds_read_b64_tr_b16 v[66:67], v242 offset:1536
  buffer_load_dwordx4 v231, s[8:11], s64 offen offset:1024 lds
  s_add_u32 s64, s64, 128
  s_cmp_eq_u32 s64, 1280
  s_cselect_b32 s64, 0, s64
  v_mfma_f32_16x16x32_bf16 v[20:23], v[92:95], v[120:123], v[20:23]
  ds_read_b64_tr_b16 v[68:69], v243 offset:0
  ds_read_b64_tr_b16 v[70:71], v243 offset:1536
  v_mfma_f32_16x16x32_bf16 v[44:47], v[92:95], v[124:127], v[44:47]
  ds_read_b64_tr_b16 v[72:73], v244 offset:0
  ds_read_b64_tr_b16 v[74:75], v244 offset:1536
  v_mfma_f32_16x16x32_bf16 v[24:27], v[96:99], v[120:123], v[24:27]
  ds_read_b64_tr_b16 v[76:77], v245 offset:0
  ds_read_b64_tr_b16 v[78:79], v245 offset:1536
  s_add_u32 m0, s66, 32768
  s_nop 0
  buffer_load_dwordx4 v224, s[28:31], s65 offen offset:0 lds
  v_mfma_f32_16x16x32_bf16 v[48:51], v[96:99], v[124:127], v[48:51]
  ds_read_b64_tr_b16 v[80:81], v246 offset:0
  ds_read_b64_tr_b16 v[82:83], v246 offset:1536
  v_mfma_f32_16x16x32_bf16 v[28:31], v[100:103], v[120:123], v[28:31]
  ds_read_b64_tr_b16 v[84:85], v247 offset:0
  ds_read_b64_tr_b16 v[86:87], v247 offset:1536
  buffer_load_dwordx4 v225, s[28:31], s65 offen offset:1024 lds
  v_mfma_f32_16x16x32_bf16 v[52:55], v[100:103], v[124:127], v[52:55]
  ds_read_b128 v[128:131], v252 offset:640
  v_mfma_f32_16x16x32_bf16 v[32:35], v[104:107], v[120:123], v[32:35]
  v_mfma_f32_16x16x32_bf16 v[56:59], v[104:107], v[124:127], v[56:59]
  buffer_load_dwordx4 v226, s[28:31], s65 offen offset:2048 lds
  v_mfma_f32_16x16x32_bf16 v[36:39], v[108:111], v[120:123], v[36:39]
  v_mfma_f32_16x16x32_bf16 v[60:63], v[108:111], v[124:127], v[60:63]
  v_mfma_f32_16x16x32_bf16 v[12:15], v[132:135], v[120:123], v[12:15]
  s_waitcnt lgkmcnt(0)
  s_add_u32 m0, s66, 35840
  s_nop 0
  buffer_load_dwordx4 v227, s[28:31], s65 offen offset:0 lds
  v_mfma_f32_16x16x32_bf16 v[16:19], v[64:67], v[112:115], v[16:19]
  ds_read_b128 v[120:123], v250 offset:0
  ds_read_b128 v[124:127], v251 offset:0
  v_mfma_f32_16x16x32_bf16 v[40:43], v[64:67], v[116:119], v[40:43]
  ds_read_b64_tr_b16 v[88:89], v242 offset:12288
  ds_read_b64_tr_b16 v[90:91], v242 offset:13824
  v_mfma_f32_16x16x32_bf16 v[20:23], v[68:71], v[112:115], v[20:23]
  ds_read_b64_tr_b16 v[92:93], v243 offset:12288
  ds_read_b64_tr_b16 v[94:95], v243 offset:13824
  v_mfma_f32_16x16x32_bf16 v[44:47], v[68:71], v[116:119], v[44:47]
  ds_read_b64_tr_b16 v[96:97], v244 offset:12288
  ds_read_b64_tr_b16 v[98:99], v244 offset:13824
  buffer_load_dwordx4 v228, s[28:31], s65 offen offset:1024 lds
  v_mfma_f32_16x16x32_bf16 v[24:27], v[72:75], v[112:115], v[24:27]
  ds_read_b64_tr_b16 v[100:101], v245 offset:12288
  ds_read_b64_tr_b16 v[102:103], v245 offset:13824
  v_mfma_f32_16x16x32_bf16 v[48:51], v[72:75], v[116:119], v[48:51]
  ds_read_b64_tr_b16 v[104:105], v246 offset:12288
  ds_read_b64_tr_b16 v[106:107], v246 offset:13824
  v_mfma_f32_16x16x32_bf16 v[28:31], v[76:79], v[112:115], v[28:31]
  ds_read_b64_tr_b16 v[108:109], v247 offset:12288
  ds_read_b64_tr_b16 v[110:111], v247 offset:13824
  v_mfma_f32_16x16x32_bf16 v[52:55], v[76:79], v[116:119], v[52:55]
  ds_read_b128 v[132:135], v252 offset:704
  buffer_load_dwordx4 v229, s[28:31], s65 offen offset:2048 lds
  s_add_u32 s65, s65, 196608
  s_cmp_eq_u32 s65, 1966080
  s_cselect_b32 s65, 0, s65
  v_mfma_f32_16x16x32_bf16 v[32:35], v[80:83], v[112:115], v[32:35]
  v_mfma_f32_16x16x32_bf16 v[56:59], v[80:83], v[116:119], v[56:59]
  v_mfma_f32_16x16x32_bf16 v[36:39], v[84:87], v[112:115], v[36:39]
  v_mfma_f32_16x16x32_bf16 v[60:63], v[84:87], v[116:119], v[60:63]
  v_mfma_f32_16x16x32_bf16 v[12:15], v[128:131], v[112:115], v[12:15]
  s_waitcnt lgkmcnt(0)
  s_waitcnt vmcnt(8)
  s_barrier
  s_add_u32 m0, s67, 65536
  s_nop 0
  buffer_load_dwordx4 v230, s[8:11], s64 offen offset:0 lds
  v_mfma_f32_16x16x32_bf16 v[16:19], v[88:91], v[120:123], v[16:19]
  ds_read_b128 v[112:115], v238 offset:0
  ds_read_b128 v[116:119], v239 offset:0
  v_mfma_f32_16x16x32_bf16 v[40:43], v[88:91], v[124:127], v[40:43]
  ds_read_b64_tr_b16 v[64:65], v232 offset:0
  ds_read_b64_tr_b16 v[66:67], v232 offset:1536
  buffer_load_dwordx4 v231, s[8:11], s64 offen offset:1024 lds
  s_add_u32 s64, s64, 128
  s_cmp_eq_u32 s64, 1280
  s_cselect_b32 s64, 0, s64
  v_mfma_f32_16x16x32_bf16 v[20:23], v[92:95], v[120:123], v[20:23]
  ds_read_b64_tr_b16 v[68:69], v233 offset:0
  ds_read_b64_tr_b16 v[70:71], v233 offset:1536
  v_mfma_f32_16x16x32_bf16 v[44:47], v[92:95], v[124:127], v[44:47]
  ds_read_b64_tr_b16 v[72:73], v234 offset:0
  ds_read_b64_tr_b16 v[74:75], v234 offset:1536
  v_mfma_f32_16x16x32_bf16 v[24:27], v[96:99], v[120:123], v[24:27]
  ds_read_b64_tr_b16 v[76:77], v235 offset:0
  ds_read_b64_tr_b16 v[78:79], v235 offset:1536
  s_add_u32 m0, s66, 65536
  s_nop 0
  buffer_load_dwordx4 v224, s[28:31], s65 offen offset:0 lds
  v_mfma_f32_16x16x32_bf16 v[48:51], v[96:99], v[124:127], v[48:51]
  ds_read_b64_tr_b16 v[80:81], v236 offset:0
  ds_read_b64_tr_b16 v[82:83], v236 offset:1536
  v_mfma_f32_16x16x32_bf16 v[28:31], v[100:103], v[120:123], v[28:31]
  ds_read_b64_tr_b16 v[84:85], v237 offset:0
  ds_read_b64_tr_b16 v[86:87], v237 offset:1536
  buffer_load_dwordx4 v225, s[28:31], s65 offen offset:1024 lds
  v_mfma_f32_16x16x32_bf16 v[52:55], v[100:103], v[124:127], v[52:55]
  ds_read_b128 v[128:131], v252 offset:768
  v_mfma_f32_16x16x32_bf16 v[32:35], v[104:107], v[120:123], v[32:35]
  v_mfma_f32_16x16x32_bf16 v[56:59], v[104:107], v[124:127], v[56:59]
  buffer_load_dwordx4 v226, s[28:31], s65 offen offset:2048 lds
  v_mfma_f32_16x16x32_bf16 v[36:39], v[108:111], v[120:123], v[36:39]
  v_mfma_f32_16x16x32_bf16 v[60:63], v[108:111], v[124:127], v[60:63]
  v_mfma_f32_16x16x32_bf16 v[12:15], v[132:135], v[120:123], v[12:15]
  s_waitcnt lgkmcnt(0)
  s_add_u32 m0, s66, 68608
  s_nop 0
  buffer_load_dwordx4 v227, s[28:31], s65 offen offset:0 lds
  v_mfma_f32_16x16x32_bf16 v[16:19], v[64:67], v[112:115], v[16:19]
  ds_read_b128 v[120:123], v240 offset:0
  ds_read_b128 v[124:127], v241 offset:0
  v_mfma_f32_16x16x32_bf16 v[40:43], v[64:67], v[116:119], v[40:43]
  ds_read_b64_tr_b16 v[88:89], v232 offset:12288
  ds_read_b64_tr_b16 v[90:91], v232 offset:13824
  v_mfma_f32_16x16x32_bf16 v[20:23], v[68:71], v[112:115], v[20:23]
  ds_read_b64_tr_b16 v[92:93], v233 offset:12288
  ds_read_b64_tr_b16 v[94:95], v233 offset:13824
  buffer_load_dwordx4 v228, s[28:31], s65 offen offset:1024 lds
  v_mfma_f32_16x16x32_bf16 v[44:47], v[68:71], v[116:119], v[44:47]
  ds_read_b64_tr_b16 v[96:97], v234 offset:12288
  ds_read_b64_tr_b16 v[98:99], v234 offset:13824
  v_mfma_f32_16x16x32_bf16 v[24:27], v[72:75], v[112:115], v[24:27]
  ds_read_b64_tr_b16 v[100:101], v235 offset:12288
  ds_read_b64_tr_b16 v[102:103], v235 offset:13824
  v_mfma_f32_16x16x32_bf16 v[48:51], v[72:75], v[116:119], v[48:51]
  ds_read_b64_tr_b16 v[104:105], v236 offset:12288
  ds_read_b64_tr_b16 v[106:107], v236 offset:13824
  buffer_load_dwordx4 v229, s[28:31], s65 offen offset:2048 lds
  s_add_u32 s65, s65, 196608
  s_cmp_eq_u32 s65, 1966080
  s_cselect_b32 s65, 0, s65
  v_mfma_f32_16x16x32_bf16 v[28:31], v[76:79], v[112:115], v[28:31]
  ds_read_b64_tr_b16 v[108:109], v237 offset:12288
  ds_read_b64_tr_b16 v[110:111], v237 offset:13824
  v_mfma_f32_16x16x32_bf16 v[52:55], v[76:79], v[116:119], v[52:55]
  ds_read_b128 v[132:135], v252 offset:832
  v_mfma_f32_16x16x32_bf16 v[32:35], v[80:83], v[112:115], v[32:35]
  v_mov_b32 v5, v6
  s_mov_b32 exec_lo, 0xff
  s_mov_b32 exec_hi, 0
  buffer_load_dword v5, v2, s[44:47], 0 offen sc1
  s_mov_b64 exec, -1
  v_mfma_f32_16x16x32_bf16 v[56:59], v[80:83], v[116:119], v[56:59]
  v_mfma_f32_16x16x32_bf16 v[36:39], v[84:87], v[112:115], v[36:39]
  v_mfma_f32_16x16x32_bf16 v[60:63], v[84:87], v[116:119], v[60:63]
  v_mfma_f32_16x16x32_bf16 v[12:15], v[128:131], v[112:115], v[12:15]
  s_waitcnt lgkmcnt(0)
  s_waitcnt vmcnt(9)
  s_barrier
  s_add_u32 m0, s67, 0
  s_nop 0
  buffer_load_dwordx4 v230, s[8:11], s64 offen offset:0 lds
  v_mfma_f32_16x16x32_bf16 v[16:19], v[88:91], v[120:123], v[16:19]
  ds_read_b128 v[112:115], v238 offset:32768
  ds_read_b128 v[116:119], v239 offset:32768
  v_mfma_f32_16x16x32_bf16 v[40:43], v[88:91], v[124:127], v[40:43]
  ds_read_b64_tr_b16 v[64:65], v232 offset:32768
  ds_read_b64_tr_b16 v[66:67], v232 offset:34304
  buffer_load_dwordx4 v231, s[8:11], s64 offen offset:1024 lds
  s_add_u32 s64, s64, 128
  s_cmp_eq_u32 s64, 1280
  s_cselect_b32 s64, 0, s64
  v_mfma_f32_16x16x32_bf16 v[20:23], v[92:95], v[120:123], v[20:23]
  ds_read_b64_tr_b16 v[68:69], v233 offset:32768
  ds_read_b64_tr_b16 v[70:71], v233 offset:34304
  v_mfma_f32_16x16x32_bf16 v[44:47], v[92:95], v[124:127], v[44:47]
  ds_read_b64_tr_b16 v[72:73], v234 offset:32768
  ds_read_b64_tr_b16 v[74:75], v234 offset:34304
  v_mfma_f32_16x16x32_bf16 v[24:27], v[96:99], v[120:123], v[24:27]
  ds_read_b64_tr_b16 v[76:77], v235 offset:32768
  ds_read_b64_tr_b16 v[78:79], v235 offset:34304
  s_add_u32 m0, s66, 0
  s_nop 0
  buffer_load_dwordx4 v224, s[28:31], s65 offen offset:0 lds
  v_mfma_f32_16x16x32_bf16 v[48:51], v[96:99], v[124:127], v[48:51]
  ds_read_b64_tr_b16 v[80:81], v236 offset:32768
  ds_read_b64_tr_b16 v[82:83], v236 offset:34304
  v_mfma_f32_16x16x32_bf16 v[28:31], v[100:103], v[120:123], v[28:31]
  ds_read_b64_tr_b16 v[84:85], v237 offset:32768
  ds_read_b64_tr_b16 v[86:87], v237 offset:34304
  buffer_load_dwordx4 v225, s[28:31], s65 offen offset:1024 lds
  v_mfma_f32_16x16x32_bf16 v[52:55], v[100:103], v[124:127], v[52:55]
  ds_read_b128 v[128:131], v252 offset:896
  v_mfma_f32_16x16x32_bf16 v[32:35], v[104:107], v[120:123], v[32:35]
  v_mfma_f32_16x16x32_bf16 v[56:59], v[104:107], v[124:127], v[56:59]
  buffer_load_dwordx4 v226, s[28:31], s65 offen offset:2048 lds
  v_mfma_f32_16x16x32_bf16 v[36:39], v[108:111], v[120:123], v[36:39]
  v_mfma_f32_16x16x32_bf16 v[60:63], v[108:111], v[124:127], v[60:63]
  v_mfma_f32_16x16x32_bf16 v[12:15], v[132:135], v[120:123], v[12:15]
  s_waitcnt lgkmcnt(0)
  s_add_u32 m0, s66, 3072
  s_nop 0
  buffer_load_dwordx4 v227, s[28:31], s65 offen offset:0 lds
  v_mfma_f32_16x16x32_bf16 v[16:19], v[64:67], v[112:115], v[16:19]
  ds_read_b128 v[120:123], v240 offset:32768
  ds_read_b128 v[124:127], v241 offset:32768
  v_mfma_f32_16x16x32_bf16 v[40:43], v[64:67], v[116:119], v[40:43]
  ds_read_b64_tr_b16 v[88:89], v232 offset:45056
  ds_read_b64_tr_b16 v[90:91], v232 offset:46592
  v_mfma_f32_16x16x32_bf16 v[20:23], v[68:71], v[112:115], v[20:23]
  ds_read_b64_tr_b16 v[92:93], v233 offset:45056
  ds_read_b64_tr_b16 v[94:95], v233 offset:46592
  v_mfma_f32_16x16x32_bf16 v[44:47], v[68:71], v[116:119], v[44:47]
  ds_read_b64_tr_b16 v[96:97], v234 offset:45056
  ds_read_b64_tr_b16 v[98:99], v234 offset:46592
  buffer_load_dwordx4 v228, s[28:31], s65 offen offset:1024 lds
  v_mfma_f32_16x16x32_bf16 v[24:27], v[72:75], v[112:115], v[24:27]
  ds_read_b64_tr_b16 v[100:101], v235 offset:45056
  ds_read_b64_tr_b16 v[102:103], v235 offset:46592
  v_mfma_f32_16x16x32_bf16 v[48:51], v[72:75], v[116:119], v[48:51]
  ds_read_b64_tr_b16 v[104:105], v236 offset:45056
  ds_read_b64_tr_b16 v[106:107], v236 offset:46592
  v_mfma_f32_16x16x32_bf16 v[28:31], v[76:79], v[112:115], v[28:31]
  ds_read_b64_tr_b16 v[108:109], v237 offset:45056
  ds_read_b64_tr_b16 v[110:111], v237 offset:46592
  v_mfma_f32_16x16x32_bf16 v[52:55], v[76:79], v[116:119], v[52:55]
  ds_read_b128 v[132:135], v252 offset:960
  buffer_load_dwordx4 v229, s[28:31], s65 offen offset:2048 lds
  s_add_u32 s65, s65, 196608
  s_cmp_eq_u32 s65, 1966080
  s_cselect_b32 s65, 0, s65
  v_mfma_f32_16x16x32_bf16 v[32:35], v[80:83], v[112:115], v[32:35]
  v_mfma_f32_16x16x32_bf16 v[56:59], v[80:83], v[116:119], v[56:59]
  v_mfma_f32_16x16x32_bf16 v[36:39], v[84:87], v[112:115], v[36:39]
  v_mfma_f32_16x16x32_bf16 v[60:63], v[84:87], v[116:119], v[60:63]
  v_mfma_f32_16x16x32_bf16 v[12:15], v[128:131], v[112:115], v[12:15]
  s_waitcnt lgkmcnt(0)
  s_lshr_b32 s74, s4, 4
  s_and_b32 s75, s62, 2
  s_or_b32 s74, s74, s75
  s_cmp_eq_u32 s74, 1
  s_cbranch_scc1 L_i2
  s_cmp_eq_u32 s74, 0
  s_cbranch_scc1 L_i3
  s_cmp_eq_u32 s74, 3
  s_cbranch_scc1 L_b2
L_b3:
  s_waitcnt vmcnt(8)
  v_cmp_ne_u32 vcc, s60, v5
  s_cbranch_vccnz L_spin_Ab3
L_ret_Ab3:
  s_barrier
  s_add_u32 s84, s70, 2
  s_add_u32 m0, s69, 0
  s_nop 0
  buffer_load_dwordx4 v1, s[44:47], s70 offen offset:0 sc1 lds
  v_mfma_f32_16x16x32_bf16 v[16:19], v[88:91], v[120:123], v[16:19]
  ds_read_b128 v[112:115], v248 offset:0
  ds_read_b128 v[116:119], v249 offset:0
  v_mfma_f32_16x16x32_bf16 v[40:43], v[88:91], v[124:127], v[40:43]
  ds_read_b64_tr_b16 v[64:65], v242 offset:0
  ds_read_b64_tr_b16 v[66:67], v242 offset:1536
  v_mfma_f32_16x16x32_bf16 v[20:23], v[92:95], v[120:123], v[20:23]
  ds_read_b64_tr_b16 v[68:69], v243 offset:0
  ds_read_b64_tr_b16 v[70:71], v243 offset:1536
  v_mfma_f32_16x16x32_bf16 v[44:47], v[92:95], v[124:127], v[44:47]
  ds_read_b64_tr_b16 v[72:73], v244 offset:0
  ds_read_b64_tr_b16 v[74:75], v244 offset:1536
  buffer_load_dwordx4 v1, s[44:47], s70 offen offset:1024 sc1 lds
  v_mfma_f32_16x16x32_bf16 v[24:27], v[96:99], v[120:123], v[24:27]
  ds_read_b64_tr_b16 v[76:77], v245 offset:0
  ds_read_b64_tr_b16 v[78:79], v245 offset:1536
  v_mfma_f32_16x16x32_bf16 v[48:51], v[96:99], v[124:127], v[48:51]
  ds_read_b64_tr_b16 v[80:81], v246 offset:0
  ds_read_b64_tr_b16 v[82:83], v246 offset:1536
  v_mfma_f32_16x16x32_bf16 v[28:31], v[100:103], v[120:123], v[28:31]
  ds_read_b64_tr_b16 v[84:85], v247 offset:0
  ds_read_b64_tr_b16 v[86:87], v247 offset:1536
  v_mfma_f32_16x16x32_bf16 v[52:55], v[100:103], v[124:127], v[52:55]
  ds_read_b128 v[128:131], v252 offset:1024
  buffer_load_dwordx4 v1, s[44:47], s70 offen offset:2048 sc1 lds
  v_mfma_f32_16x16x32_bf16 v[32:35], v[104:107], v[120:123], v[32:35]
  v_mfma_f32_16x16x32_bf16 v[56:59], v[104:107], v[124:127], v[56:59]
  v_mfma_f32_16x16x32_bf16 v[36:39], v[108:111], v[120:123], v[36:39]
  v_mfma_f32_16x16x32_bf16 v[60:63], v[108:111], v[124:127], v[60:63]
  v_mfma_f32_16x16x32_bf16 v[12:15], v[132:135], v[120:123], v[12:15]
  s_waitcnt lgkmcnt(0)
  buffer_load_dwordx4 v1, s[44:47], s70 offen offset:3072 sc1 lds
  v_mfma_f32_16x16x32_bf16 v[16:19], v[64:67], v[112:115], v[16:19]
  ds_read_b128 v[120:123], v250 offset:0
  ds_read_b128 v[124:127], v251 offset:0
  v_mfma_f32_16x16x32_bf16 v[40:43], v[64:67], v[116:119], v[40:43]
  ds_read_b64_tr_b16 v[88:89], v242 offset:12288
  ds_read_b64_tr_b16 v[90:91], v242 offset:13824
  v_mfma_f32_16x16x32_bf16 v[20:23], v[68:71], v[112:115], v[20:23]
  ds_read_b64_tr_b16 v[92:93], v243 offset:12288
  ds_read_b64_tr_b16 v[94:95], v243 offset:13824
  v_mfma_f32_16x16x32_bf16 v[44:47], v[68:71], v[116:119], v[44:47]
  ds_read_b64_tr_b16 v[96:97], v244 offset:12288
  ds_read_b64_tr_b16 v[98:99], v244 offset:13824
  s_add_u32 m0, s69, 13440
  s_add_u32 s74, s70, 4
  s_mov_b64 exec, s[62:63]
  buffer_load_dwordx4 v1, s[24:27], s74 offen offset:0 lds
  buffer_load_dwordx4 v1, s[24:27], s74 offen offset:1024 lds
  s_mov_b64 exec, -1
  v_mfma_f32_16x16x32_bf16 v[24:27], v[72:75], v[112:115], v[24:27]
  ds_read_b64_tr_b16 v[100:101], v245 offset:12288
  ds_read_b64_tr_b16 v[102:103], v245 offset:13824
  v_mfma_f32_16x16x32_bf16 v[48:51], v[72:75], v[116:119], v[48:51]
  ds_read_b64_tr_b16 v[104:105], v246 offset:12288
  ds_read_b64_tr_b16 v[106:107], v246 offset:13824
  v_mfma_f32_16x16x32_bf16 v[28:31], v[76:79], v[112:115], v[28:31]
  ds_read_b64_tr_b16 v[108:109], v247 offset:12288
  ds_read_b64_tr_b16 v[110:111], v247 offset:13824
  v_mfma_f32_16x16x32_bf16 v[52:55], v[76:79], v[116:119], v[52:55]
  ds_read_b128 v[132:135], v252 offset:1088
  s_add_u32 m0, s69, 13440
  s_add_u32 s74, s70, 4
  s_mov_b64 exec, s[62:63]
  buffer_load_dwordx4 v1, s[24:27], s74 offen offset:2048 lds
  buffer_load_dwordx4 v1, s[24:27], s74 offen offset:3072 lds
  s_mov_b64 exec, -1
  v_mfma_f32_16x16x32_bf16 v[32:35], v[80:83], v[112:115], v[32:35]
  v_mfma_f32_16x16x32_bf16 v[56:59], v[80:83], v[116:119], v[56:59]
  v_mfma_f32_16x16x32_bf16 v[36:39], v[84:87], v[112:115], v[36:39]
  v_mfma_f32_16x16x32_bf16 v[60:63], v[84:87], v[116:119], v[60:63]
  v_mfma_f32_16x16x32_bf16 v[12:15], v[128:131], v[112:115], v[12:15]
  s_waitcnt lgkmcnt(0)
  s_waitcnt vmcnt(8)
  s_barrier
  buffer_load_dwordx4 a[0:3], v1, s[44:47], s71 offen offset:0 sc1
  v_mfma_f32_16x16x32_bf16 v[16:19], v[88:91], v[120:123], v[16:19]
  ds_read_b128 v[112:115], v238 offset:0
  ds_read_b128 v[116:119], v239 offset:0
  v_mfma_f32_16x16x32_bf16 v[40:43], v[88:91], v[124:127], v[40:43]
  ds_read_b64_tr_b16 v[64:65], v232 offset:0
  ds_read_b64_tr_b16 v[66:67], v232 offset:1536
  buffer_load_dwordx4 a[4:7], v1, s[44:47], s71 offen offset:1024 sc1
  v_mfma_f32_16x16x32_bf16 v[20:23], v[92:95], v[120:123], v[20:23]
  ds_read_b64_tr_b16 v[68:69], v233 offset:0
  ds_read_b64_tr_b16 v[70:71], v233 offset:1536
  v_mfma_f32_16x16x32_bf16 v[44:47], v[92:95], v[124:127], v[44:47]
  ds_read_b64_tr_b16 v[72:73], v234 offset:0
  ds_read_b64_tr_b16 v[74:75], v234 offset:1536
  v_mfma_f32_16x16x32_bf16 v[24:27], v[96:99], v[120:123], v[24:27]
  ds_read_b64_tr_b16 v[76:77], v235 offset:0
  ds_read_b64_tr_b16 v[78:79], v235 offset:1536
  buffer_load_dwordx4 a[8:11], v1, s[44:47], s71 offen offset:2048 sc1
  v_mfma_f32_16x16x32_bf16 v[48:51], v[96:99], v[124:127], v[48:51]
  ds_read_b64_tr_b16 v[80:81], v236 offset:0
  ds_read_b64_tr_b16 v[82:83], v236 offset:1536
  v_mfma_f32_16x16x32_bf16 v[28:31], v[100:103], v[120:123], v[28:31]
  ds_read_b64_tr_b16 v[84:85], v237 offset:0
  ds_read_b64_tr_b16 v[86:87], v237 offset:1536
  buffer_load_dwordx4 a[12:15], v1, s[44:47], s71 offen offset:3072 sc1
  v_mfma_f32_16x16x32_bf16 v[52:55], v[100:103], v[124:127], v[52:55]
  ds_read_b128 v[128:131], v252 offset:1152
  v_mfma_f32_16x16x32_bf16 v[32:35], v[104:107], v[120:123], v[32:35]
  v_mfma_f32_16x16x32_bf16 v[56:59], v[104:107], v[124:127], v[56:59]
  s_add_u32 s74, s71, 4096
  s_add_u32 s71, s71, 5120
  buffer_load_dwordx4 a[16:19], v1, s[44:47], s74 offen sc1
  s_cmp_ge_u32 s71, s73
  s_cselect_b32 s74, 245760, 0
  s_sub_u32 s71, s71, s74
  v_mfma_f32_16x16x32_bf16 v[36:39], v[108:111], v[120:123], v[36:39]
  v_mfma_f32_16x16x32_bf16 v[60:63], v[108:111], v[124:127], v[60:63]
  v_mfma_f32_16x16x32_bf16 v[12:15], v[132:135], v[120:123], v[12:15]
  s_waitcnt lgkmcnt(0)
  buffer_load_dwordx4 a[20:23], v1, s[44:47], s71 offen offset:0 sc1
  v_mfma_f32_16x16x32_bf16 v[16:19], v[64:67], v[112:115], v[16:19]
  ds_read_b128 v[120:123], v240 offset:0
  ds_read_b128 v[124:127], v241 offset:0
  v_mfma_f32_16x16x32_bf16 v[40:43], v[64:67], v[116:119], v[40:43]
  ds_read_b64_tr_b16 v[88:89], v232 offset:12288
  ds_read_b64_tr_b16 v[90:91], v232 offset:13824
  buffer_load_dwordx4 a[24:27], v1, s[44:47], s71 offen offset:1024 sc1
  v_mfma_f32_16x16x32_bf16 v[20:23], v[68:71], v[112:115], v[20:23]
  ds_read_b64_tr_b16 v[92:93], v233 offset:12288
  ds_read_b64_tr_b16 v[94:95], v233 offset:13824
  v_mfma_f32_16x16x32_bf16 v[44:47], v[68:71], v[116:119], v[44:47]
  ds_read_b64_tr_b16 v[96:97], v234 offset:12288
  ds_read_b64_tr_b16 v[98:99], v234 offset:13824
  v_mfma_f32_16x16x32_bf16 v[24:27], v[72:75], v[112:115], v[24:27]
  ds_read_b64_tr_b16 v[100:101], v235 offset:12288
  ds_read_b64_tr_b16 v[102:103], v235 offset:13824
  buffer_load_dwordx4 a[28:31], v1, s[44:47], s71 offen offset:2048 sc1
  v_mfma_f32_16x16x32_bf16 v[48:51], v[72:75], v[116:119], v[48:51]
  ds_read_b64_tr_b16 v[104:105], v236 offset:12288
  ds_read_b64_tr_b16 v[106:107], v236 offset:13824
  v_mfma_f32_16x16x32_bf16 v[28:31], v[76:79], v[112:115], v[28:31]
  ds_read_b64_tr_b16 v[108:109], v237 offset:12288
  ds_read_b64_tr_b16 v[110:111], v237 offset:13824
  buffer_load_dwordx4 a[32:35], v1, s[44:47], s71 offen offset:3072 sc1
  v_mfma_f32_16x16x32_bf16 v[52:55], v[76:79], v[116:119], v[52:55]
  ds_read_b128 v[132:135], v252 offset:1216
  v_mfma_f32_16x16x32_bf16 v[32:35], v[80:83], v[112:115], v[32:35]
  v_mfma_f32_16x16x32_bf16 v[56:59], v[80:83], v[116:119], v[56:59]
  s_add_u32 s74, s71, 4096
  s_add_u32 s71, s71, 5120
  buffer_load_dwordx4 a[36:39], v1, s[44:47], s74 offen sc1
  s_cmp_ge_u32 s71, s73
  s_cselect_b32 s74, 245760, 0
  s_sub_u32 s71, s71, s74
  v_mfma_f32_16x16x32_bf16 v[36:39], v[84:87], v[112:115], v[36:39]
  v_mfma_f32_16x16x32_bf16 v[60:63], v[84:87], v[116:119], v[60:63]
  v_mfma_f32_16x16x32_bf16 v[12:15], v[128:131], v[112:115], v[12:15]
  s_waitcnt lgkmcnt(0)
  s_barrier
  v_mul_u32_u24 v136, 205, v0
  v_lshrrev_b32 v136, 11, v136
  v_mul_u32_u24 v137, 10, v136
  v_mfma_f32_16x16x32_bf16 v[16:19], v[88:91], v[120:123], v[16:19]
  v_sub_u32 v137, v0, v137
  v_mul_u32_u24 v136, 1280, v136
  v_lshl_add_u32 v136, v137, 4, v136
L_st1:
  s_cbranch_execz L_hb2
  v_mfma_f32_16x16x32_bf16 v[40:43], v[88:91], v[124:127], v[40:43]
  s_mul_i32 s80, s4, 81920
  s_mul_i32 s81, s5, 160
  s_add_u32 s80, s80, s81
  s_mul_i32 s81, s6, 10240
  s_add_u32 s80, s80, s81
  v_mfma_f32_16x16x32_bf16 v[20:23], v[92:95], v[120:123], v[20:23]
  v_add_u32 v2, s80, v136
  s_mul_i32 s87, s6, 1280
  s_add_u32 s87, s87, 153472
  v_mfma_f32_16x16x32_bf16 v[44:47], v[92:95], v[124:127], v[44:47]
  s_mov_b32 exec_lo, -1
  s_mov_b32 exec_hi, 0xff
  s_add_u32 m0, s87, 0
  s_mov_b32 s82, 0
  buffer_load_dwordx4 v2, s[8:11], s82 offen lds
  s_mov_b64 exec, -1
  v_mfma_f32_16x16x32_bf16 v[24:27], v[96:99], v[120:123], v[24:27]
  s_mov_b32 exec_lo, -1
  s_mov_b32 exec_hi, 0xff
  s_add_u32 m0, s87, 640
  s_mov_b32 s82, 5120
  buffer_load_dwordx4 v2, s[8:11], s82 offen lds
  s_mov_b64 exec, -1
  v_mfma_f32_16x16x32_bf16 v[48:51], v[96:99], v[124:127], v[48:51]
  s_mov_b32 exec_lo, -1
  s_mov_b32 exec_hi, 0xff
  s_add_u32 m0, s87, 5120
  s_mov_b32 s82, 40960
  buffer_load_dwordx4 v2, s[8:11], s82 offen lds
  s_mov_b64 exec, -1
  v_mfma_f32_16x16x32_bf16 v[28:31], v[100:103], v[120:123], v[28:31]
  s_mov_b32 exec_lo, -1
  s_mov_b32 exec_hi, 0xff
  s_add_u32 m0, s87, 5760
  s_mov_b32 s82, 46080
  buffer_load_dwordx4 v2, s[8:11], s82 offen lds
  s_mov_b64 exec, -1
  v_mfma_f32_16x16x32_bf16 v[52:55], v[100:103], v[124:127], v[52:55]
  s_add_u32 s76, s6, 1
  s_and_b32 s76, s76, 3
  s_lshl_b32 s76, s76, 10
  v_mfma_f32_16x16x32_bf16 v[32:35], v[104:107], v[120:123], v[32:35]
  s_add_u32 s77, s6, 2
  s_and_b32 s77, s77, 3
  s_lshl_b32 s77, s77, 10
  v_mfma_f32_16x16x32_bf16 v[56:59], v[104:107], v[124:127], v[56:59]
  s_add_u32 s78, s6, 3
  s_and_b32 s78, s78, 3
  s_lshl_b32 s78, s78, 10
  v_mfma_f32_16x16x32_bf16 v[36:39], v[108:111], v[120:123], v[36:39]
  s_add_u32 s79, s6, 4
  s_and_b32 s79, s79, 3
  s_lshl_b32 s79, s79, 10
  v_mfma_f32_16x16x32_bf16 v[60:63], v[108:111], v[124:127], v[60:63]
  v_mfma_f32_16x16x32_bf16 v[12:15], v[132:135], v[120:123], v[12:15]
  s_mov_b32 s80, 0xbfb8aa3b
  s_mov_b32 s81, 0xbfb8aa3b
  s_mov_b32 s82, 1.0
  s_mov_b32 s83, 1.0
  s_and_b32 s85, s6, 1
  s_mul_i32 s85, s85, 12288
  s_add_u32 s85, s85, 73728
  s_add_u32 s84, s85, s79
  v_pk_mul_f32 v[64:65], v[16:17], s[80:81]
  v_pk_mul_f32 v[66:67], v[18:19], s[80:81]
  v_pk_mul_f32 v[68:69], v[20:21], s[80:81]
  v_pk_mul_f32 v[70:71], v[22:23], s[80:81]
  v_exp_f32 v64, v64
  v_exp_f32 v65, v65
  v_exp_f32 v66, v66
  v_exp_f32 v67, v67
  v_exp_f32 v68, v68
  v_exp_f32 v69, v69
  v_exp_f32 v70, v70
  v_exp_f32 v71, v71
  v_add_u32 v96, s84, v1
  v_xor_b32 v97, 1024, v96
  v_pk_add_f32 v[64:65], v[64:65], s[82:83]
  v_pk_add_f32 v[66:67], v[66:67], s[82:83]
  v_pk_add_f32 v[68:69], v[68:69], s[82:83]
  v_pk_add_f32 v[70:71], v[70:71], s[82:83]
  v_rcp_f32 v64, v64
  v_rcp_f32 v65, v65
  v_rcp_f32 v66, v66
  v_rcp_f32 v67, v67
  v_rcp_f32 v68, v68
  v_rcp_f32 v69, v69
  v_rcp_f32 v70, v70
  v_rcp_f32 v71, v71
  v_pk_mul_f32 v[64:65], v[64:65], v[16:17]
  v_pk_mul_f32 v[66:67], v[66:67], v[18:19]
  v_pk_mul_f32 v[68:69], v[68:69], v[20:21]
  v_pk_mul_f32 v[70:71], v[70:71], v[22:23]
  v_cvt_pk_bf16_f32 v72, v64, v65
  v_cvt_pk_bf16_f32 v73, v66, v67
  v_cvt_pk_bf16_f32 v74, v68, v69
  v_cvt_pk_bf16_f32 v75, v70, v71
  s_add_u32 s75, s97, 0
  buffer_store_dwordx4 v[72:75], v1, s[44:47], s75 offen sc1
  ds_write_b128 v96, v[72:75] offset:0
  v_pk_mul_f32 v[80:81], v[40:41], s[80:81]
  v_pk_mul_f32 v[82:83], v[42:43], s[80:81]
  v_pk_mul_f32 v[84:85], v[44:45], s[80:81]
  v_pk_mul_f32 v[86:87], v[46:47], s[80:81]
  v_exp_f32 v80, v80
  v_exp_f32 v81, v81
  v_exp_f32 v82, v82
  v_exp_f32 v83, v83
  v_exp_f32 v84, v84
  v_exp_f32 v85, v85
  v_exp_f32 v86, v86
  v_exp_f32 v87, v87
  v_add_u32 v92, 1024, v11
  v_add_u32 v93, 2048, v11
  v_add_u32 v94, 3072, v11
  v_pk_add_f32 v[80:81], v[80:81], s[82:83]
  v_pk_add_f32 v[82:83], v[82:83], s[82:83]
  v_pk_add_f32 v[84:85], v[84:85], s[82:83]
  v_pk_add_f32 v[86:87], v[86:87], s[82:83]
  v_rcp_f32 v80, v80
  v_rcp_f32 v81, v81
  v_rcp_f32 v82, v82
  v_rcp_f32 v83, v83
  v_rcp_f32 v84, v84
  v_rcp_f32 v85, v85
  v_rcp_f32 v86, v86
  v_rcp_f32 v87, v87
  v_pk_mul_f32 v[80:81], v[80:81], v[40:41]
  v_pk_mul_f32 v[82:83], v[82:83], v[42:43]
  v_pk_mul_f32 v[84:85], v[84:85], v[44:45]
  v_pk_mul_f32 v[86:87], v[86:87], v[46:47]
  v_cvt_pk_bf16_f32 v88, v80, v81
  v_cvt_pk_bf16_f32 v89, v82, v83
  v_cvt_pk_bf16_f32 v90, v84, v85
  v_cvt_pk_bf16_f32 v91, v86, v87
  s_add_u32 s75, s98, 0
  buffer_store_dwordx4 v[88:91], v1, s[44:47], s75 offen sc1
  ds_write_b128 v97, v[88:91] offset:0
  v_pk_mul_f32 v[64:65], v[24:25], s[80:81]
  v_pk_mul_f32 v[66:67], v[26:27], s[80:81]
  v_pk_mul_f32 v[68:69], v[28:29], s[80:81]
  v_pk_mul_f32 v[70:71], v[30:31], s[80:81]
  v_exp_f32 v64, v64
  v_exp_f32 v65, v65
  v_exp_f32 v66, v66
  v_exp_f32 v67, v67
  v_exp_f32 v68, v68
  v_exp_f32 v69, v69
  v_exp_f32 v70, v70
  v_exp_f32 v71, v71
  v_pk_add_f32 v[64:65], v[64:65], s[82:83]
  v_pk_add_f32 v[66:67], v[66:67], s[82:83]
  v_pk_add_f32 v[68:69], v[68:69], s[82:83]
  v_pk_add_f32 v[70:71], v[70:71], s[82:83]
  v_rcp_f32 v64, v64
  v_rcp_f32 v65, v65
  v_rcp_f32 v66, v66
  v_rcp_f32 v67, v67
  v_rcp_f32 v68, v68
  v_rcp_f32 v69, v69
  v_rcp_f32 v70, v70
  v_rcp_f32 v71, v71
  v_pk_mul_f32 v[64:65], v[64:65], v[24:25]
  v_pk_mul_f32 v[66:67], v[66:67], v[26:27]
  v_pk_mul_f32 v[68:69], v[68:69], v[28:29]
  v_pk_mul_f32 v[70:71], v[70:71], v[30:31]
  v_cvt_pk_bf16_f32 v72, v64, v65
  v_cvt_pk_bf16_f32 v73, v66, v67
  v_cvt_pk_bf16_f32 v74, v68, v69
  v_cvt_pk_bf16_f32 v75, v70, v71
  s_add_u32 s75, s97, 4096
  buffer_store_dwordx4 v[72:75], v1, s[44:47], s75 offen sc1
  ds_write_b128 v96, v[72:75] offset:4096
  v_pk_mul_f32 v[80:81], v[48:49], s[80:81]
  v_pk_mul_f32 v[82:83], v[50:51], s[80:81]
  v_pk_mul_f32 v[84:85], v[52:53], s[80:81]
  v_pk_mul_f32 v[86:87], v[54:55], s[80:81]
  v_exp_f32 v80, v80
  v_exp_f32 v81, v81
  v_exp_f32 v82, v82
  v_exp_f32 v83, v83
  v_exp_f32 v84, v84
  v_exp_f32 v85, v85
  v_exp_f32 v86, v86
  v_exp_f32 v87, v87
  v_pk_add_f32 v[80:81], v[80:81], s[82:83]
  v_pk_add_f32 v[82:83], v[82:83], s[82:83]
  v_pk_add_f32 v[84:85], v[84:85], s[82:83]
  v_pk_add_f32 v[86:87], v[86:87], s[82:83]
  v_rcp_f32 v80, v80
  v_rcp_f32 v81, v81
  v_rcp_f32 v82, v82
  v_rcp_f32 v83, v83
  v_rcp_f32 v84, v84
  v_rcp_f32 v85, v85
  v_rcp_f32 v86, v86
  v_rcp_f32 v87, v87
  v_pk_mul_f32 v[80:81], v[80:81], v[48:49]
  v_pk_mul_f32 v[82:83], v[82:83], v[50:51]
  v_pk_mul_f32 v[84:85], v[84:85], v[52:53]
  v_pk_mul_f32 v[86:87], v[86:87], v[54:55]
  v_cvt_pk_bf16_f32 v88, v80, v81
  v_cvt_pk_bf16_f32 v89, v82, v83
  v_cvt_pk_bf16_f32 v90, v84, v85
  v_cvt_pk_bf16_f32 v91, v86, v87
  s_add_u32 s75, s98, 4096
  buffer_store_dwordx4 v[88:91], v1, s[44:47], s75 offen sc1
  ds_write_b128 v97, v[88:91] offset:4096
  v_add_u32 v95, s69, v1
  s_waitcnt vmcnt(22)
  v_pk_mul_f32 v[64:65], v[32:33], s[80:81]
  ds_read_b128 v[128:131], v95 offset:0
  ds_read_b32 v132, v95 offset:16
  v_pk_mul_f32 v[66:67], v[34:35], s[80:81]
  v_pk_mul_f32 v[68:69], v[36:37], s[80:81]
  ds_read_b128 v[136:139], v95 offset:1024
  ds_read_b32 v140, v95 offset:1040
  v_pk_mul_f32 v[70:71], v[38:39], s[80:81]
  v_exp_f32 v64, v64
  ds_read_b128 v[144:147], v95 offset:2048
  ds_read_b32 v148, v95 offset:2064
  v_exp_f32 v65, v65
  v_exp_f32 v66, v66
  ds_read_b128 v[152:155], v95 offset:3072
  ds_read_b32 v156, v95 offset:3088
  v_exp_f32 v67, v67
  v_exp_f32 v68, v68
  v_exp_f32 v69, v69
  v_exp_f32 v70, v70
  v_exp_f32 v71, v71
  v_pk_add_f32 v[64:65], v[64:65], s[82:83]
  v_pk_add_f32 v[66:67], v[66:67], s[82:83]
  v_pk_add_f32 v[68:69], v[68:69], s[82:83]
  v_pk_add_f32 v[70:71], v[70:71], s[82:83]
  v_rcp_f32 v64, v64
  v_rcp_f32 v65, v65
  v_rcp_f32 v66, v66
  v_rcp_f32 v67, v67
  v_rcp_f32 v68, v68
  v_rcp_f32 v69, v69
  v_rcp_f32 v70, v70
  v_rcp_f32 v71, v71
  v_pk_mul_f32 v[64:65], v[64:65], v[32:33]
  v_pk_mul_f32 v[66:67], v[66:67], v[34:35]
  v_pk_mul_f32 v[68:69], v[68:69], v[36:37]
  v_pk_mul_f32 v[70:71], v[70:71], v[38:39]
  v_cvt_pk_bf16_f32 v72, v64, v65
  v_cvt_pk_bf16_f32 v73, v66, v67
  v_cvt_pk_bf16_f32 v74, v68, v69
  v_cvt_pk_bf16_f32 v75, v70, v71
  s_add_u32 s75, s97, 8192
  buffer_store_dwordx4 v[72:75], v1, s[44:47], s75 offen sc1
  ds_write_b128 v96, v[72:75] offset:8192
  s_waitcnt vmcnt(19) lgkmcnt(1)
  v_pk_mul_f32 v[80:81], v[56:57], s[80:81]
  ds_read2_b32 v[192:193], v11 offset0:112 offset1:113
  v_pk_mul_f32 v[82:83], v[58:59], s[80:81]
  ds_read2_b32 v[194:195], v11 offset0:114 offset1:115
  v_pk_mul_f32 v[84:85], v[60:61], s[80:81]
  v_pk_mul_f32 v[86:87], v[62:63], s[80:81]
  ds_read2_b32 v[196:197], v11 offset0:240 offset1:241
  v_exp_f32 v80, v80
  ds_read2_b32 v[198:199], v11 offset0:242 offset1:243
  v_exp_f32 v81, v81
  v_exp_f32 v82, v82
  ds_read2_b32 v[200:201], v92 offset0:112 offset1:113
  v_exp_f32 v83, v83
  ds_read2_b32 v[202:203], v92 offset0:114 offset1:115
  v_exp_f32 v84, v84
  v_exp_f32 v85, v85
  ds_read2_b32 v[204:205], v92 offset0:240 offset1:241
  v_exp_f32 v86, v86
  ds_read2_b32 v[206:207], v92 offset0:242 offset1:243
  v_exp_f32 v87, v87
  v_pk_add_f32 v[80:81], v[80:81], s[82:83]
  ds_read2_b32 v[208:209], v93 offset0:112 offset1:113
  v_pk_add_f32 v[82:83], v[82:83], s[82:83]
  ds_read2_b32 v[210:211], v93 offset0:114 offset1:115
  v_pk_add_f32 v[84:85], v[84:85], s[82:83]
  v_pk_add_f32 v[86:87], v[86:87], s[82:83]
  ds_read2_b32 v[212:213], v93 offset0:240 offset1:241
  v_rcp_f32 v80, v80
  ds_read2_b32 v[214:215], v93 offset0:242 offset1:243
  v_rcp_f32 v81, v81
  v_rcp_f32 v82, v82
  ds_read2_b32 v[216:217], v94 offset0:112 offset1:113
  v_rcp_f32 v83, v83
  ds_read2_b32 v[218:219], v94 offset0:114 offset1:115
  v_rcp_f32 v84, v84
  v_rcp_f32 v85, v85
  ds_read2_b32 v[220:221], v94 offset0:240 offset1:241
  v_rcp_f32 v86, v86
  ds_read2_b32 v[222:223], v94 offset0:242 offset1:243
  v_rcp_f32 v87, v87
  v_pk_mul_f32 v[80:81], v[80:81], v[56:57]
  v_pk_mul_f32 v[82:83], v[82:83], v[58:59]
  v_pk_mul_f32 v[84:85], v[84:85], v[60:61]
  v_pk_mul_f32 v[86:87], v[86:87], v[62:63]
  v_cvt_pk_bf16_f32 v88, v80, v81
  v_cvt_pk_bf16_f32 v89, v82, v83
  v_cvt_pk_bf16_f32 v90, v84, v85
  v_cvt_pk_bf16_f32 v91, v86, v87
  s_add_u32 s75, s98, 8192
  buffer_store_dwordx4 v[88:91], v1, s[44:47], s75 offen sc1
  ds_write_b128 v97, v[88:91] offset:8192
  v_alignbit_b32 v128, v129, v128, 16
  v_alignbit_b32 v129, v130, v129, 16
  v_alignbit_b32 v130, v131, v130, 16
  v_alignbit_b32 v131, v132, v131, 16
  ds_write_b128 v95, v[128:131] offset:4576
  v_alignbit_b32 v136, v137, v136, 16
  v_alignbit_b32 v137, v138, v137, 16
  v_alignbit_b32 v138, v139, v138, 16
  v_alignbit_b32 v139, v140, v139, 16
  ds_write_b128 v95, v[136:139] offset:5600
  v_alignbit_b32 v144, v145, v144, 16
  v_alignbit_b32 v145, v146, v145, 16
  v_alignbit_b32 v146, v147, v146, 16
  v_alignbit_b32 v147, v148, v147, 16
  ds_write_b128 v95, v[144:147] offset:6624
  v_alignbit_b32 v152, v153, v152, 16
  v_alignbit_b32 v153, v154, v153, 16
  v_alignbit_b32 v154, v155, v154, 16
  v_alignbit_b32 v155, v156, v155, 16
  ds_write_b128 v95, v[152:155] offset:7648
  ds_read_b128 v[128:131], v10 offset:4032
  ds_read_b128 v[132:135], v10 offset:3520
  ds_read_b128 v[136:139], v10 offset:3008
  ds_read_b128 v[140:143], v10 offset:2496
  ds_read_b128 v[144:147], v10 offset:1984
  ds_read_b128 v[148:151], v10 offset:1472
  ds_read_b128 v[152:155], v10 offset:960
  ds_read_b128 v[156:159], v10 offset:448
  v_cvt_pk_bf16_f32 v12, v12, v12
  v_lshlrev_b32 v12, 16, v12
  v_mul_f32 v12, 0xbfb8aa3b, v12
  v_exp_f32 v12, v12
  s_nop 0
  v_add_f32 v12, 1.0, v12
  v_rcp_f32 v12, v12
  s_nop 0
  v_cvt_pk_bf16_f32 v12, v12, v12
  v_lshlrev_b32 v12, 16, v12
  v_sub_f32 v14, 1.0, v12
  v_cvt_pk_bf16_f32 v14, v14, v14
  v_lshlrev_b32 v14, 16, v14
  v_mov_b32 v13, v12
  v_mov_b32 v15, v14
  s_lshl_b32 s84, s4, 7
  s_lshl_b32 s86, s5, 4
  s_add_u32 s84, s84, s86
  s_lshl_b32 s86, s6, 2
  s_add_u32 s84, s84, s86
  s_lshl_b32 s84, s84, 6
  s_add_u32 s84, s84, 16408576
  s_waitcnt lgkmcnt(0)
  s_barrier
  v_mfma_f32_16x16x32_bf16 v[96:99], v[128:131], v[192:195], 0
  ds_read_b128 v[160:163], v10 offset:3968
  v_mfma_f32_16x16x32_bf16 v[100:103], v[128:131], v[196:199], 0
  ds_read2_b32 v[224:225], v11 offset0:96 offset1:97
  v_mfma_f32_16x16x32_bf16 v[100:103], v[132:135], v[192:195], v[100:103]
  ds_read2_b32 v[226:227], v11 offset0:98 offset1:99
  buffer_load_dwordx4 a[40:43], v1, s[44:47], s71 offen offset:0 sc1
  v_mfma_f32_16x16x32_bf16 v[104:107], v[128:131], v[200:203], 0
  ds_read_b128 v[164:167], v10 offset:3456
  v_mfma_f32_16x16x32_bf16 v[104:107], v[132:135], v[196:199], v[104:107]
  ds_read2_b32 v[228:229], v11 offset0:224 offset1:225
  v_mfma_f32_16x16x32_bf16 v[104:107], v[136:139], v[192:195], v[104:107]
  ds_read2_b32 v[230:231], v11 offset0:226 offset1:227
  v_mfma_f32_16x16x32_bf16 v[108:111], v[128:131], v[204:207], 0
  ds_read_b128 v[168:171], v10 offset:2944
  v_mfma_f32_16x16x32_bf16 v[108:111], v[132:135], v[200:203], v[108:111]
  ds_read2_b32 v[232:233], v92 offset0:96 offset1:97
  buffer_load_dwordx4 a[44:47], v1, s[44:47], s71 offen offset:1024 sc1
  v_mfma_f32_16x16x32_bf16 v[108:111], v[136:139], v[196:199], v[108:111]
  ds_read2_b32 v[234:235], v92 offset0:98 offset1:99
  v_mfma_f32_16x16x32_bf16 v[108:111], v[140:143], v[192:195], v[108:111]
  ds_read_b128 v[172:175], v10 offset:2432
  v_mfma_f32_16x16x32_bf16 v[112:115], v[128:131], v[208:211], 0
  ds_read2_b32 v[236:237], v92 offset0:224 offset1:225
  v_mfma_f32_16x16x32_bf16 v[112:115], v[132:135], v[204:207], v[112:115]
  ds_read2_b32 v[238:239], v92 offset0:226 offset1:227
  v_mfma_f32_16x16x32_bf16 v[112:115], v[136:139], v[200:203], v[112:115]
  ds_read_b128 v[176:179], v10 offset:1920
  buffer_load_dwordx4 a[48:51], v1, s[44:47], s71 offen offset:2048 sc1
  v_mfma_f32_16x16x32_bf16 v[112:115], v[140:143], v[196:199], v[112:115]
  ds_read2_b32 v[240:241], v93 offset0:96 offset1:97
  v_mfma_f32_16x16x32_bf16 v[112:115], v[144:147], v[192:195], v[112:115]
  ds_read2_b32 v[242:243], v93 offset0:98 offset1:99
  v_mfma_f32_16x16x32_bf16 v[116:119], v[128:131], v[212:215], 0
  ds_read_b128 v[180:183], v10 offset:1408
  v_mfma_f32_16x16x32_bf16 v[116:119], v[132:135], v[208:211], v[116:119]
  ds_read2_b32 v[244:245], v93 offset0:224 offset1:225
  v_mfma_f32_16x16x32_bf16 v[116:119], v[136:139], v[204:207], v[116:119]
  ds_read2_b32 v[246:247], v93 offset0:226 offset1:227
  v_mfma_f32_16x16x32_bf16 v[116:119], v[140:143], v[200:203], v[116:119]
  ds_read_b128 v[184:187], v10 offset:896
  s_waitcnt vmcnt(3)
  s_mov_b64 exec, 1
  buffer_store_dword v7, off, s[44:47], s84 sc1
  s_mov_b64 exec, -1
  v_mfma_f32_16x16x32_bf16 v[116:119], v[144:147], v[196:199], v[116:119]
  ds_read2_b32 v[248:249], v94 offset0:96 offset1:97
  v_mfma_f32_16x16x32_bf16 v[116:119], v[148:151], v[192:195], v[116:119]
  ds_read2_b32 v[250:251], v94 offset0:98 offset1:99
  v_mfma_f32_16x16x32_bf16 v[120:123], v[128:131], v[216:219], 0
  ds_read_b128 v[188:191], v10 offset:384
  v_mfma_f32_16x16x32_bf16 v[120:123], v[132:135], v[212:215], v[120:123]
  ds_read2_b32 v[252:253], v94 offset0:224 offset1:225
  v_mfma_f32_16x16x32_bf16 v[120:123], v[136:139], v[208:211], v[120:123]
  ds_read2_b32 v[254:255], v94 offset0:226 offset1:227
  buffer_load_dwordx4 a[52:55], v1, s[44:47], s71 offen offset:3072 sc1
  v_mfma_f32_16x16x32_bf16 v[120:123], v[140:143], v[204:207], v[120:123]
  s_add_u32 s49, s48, 4096
  s_cmp_eq_u32 s49, s59
  s_cselect_b32 s49, s58, s49
  v_mfma_f32_16x16x32_bf16 v[120:123], v[144:147], v[200:203], v[120:123]
  s_add_u32 s50, s49, 4096
  s_cmp_eq_u32 s50, s59
  s_cselect_b32 s50, s58, s50
  v_mfma_f32_16x16x32_bf16 v[120:123], v[148:151], v[196:199], v[120:123]
  s_add_u32 s51, s50, 4096
  s_cmp_eq_u32 s51, s59
  s_cselect_b32 s51, s58, s51
  v_mfma_f32_16x16x32_bf16 v[120:123], v[152:155], v[192:195], v[120:123]
  s_add_u32 s52, s51, 4096
  s_cmp_eq_u32 s52, s59
  s_cselect_b32 s52, s58, s52
  v_mfma_f32_16x16x32_bf16 v[124:127], v[128:131], v[220:223], 0
  s_add_u32 s53, s52, 4096
  s_cmp_eq_u32 s53, s59
  s_cselect_b32 s53, s58, s53
  s_add_u32 s74, s71, 4096
  s_add_u32 s71, s71, 5120
  buffer_load_dwordx4 a[56:59], v1, s[44:47], s74 offen sc1
  s_cmp_ge_u32 s71, s73
  s_cselect_b32 s74, 245760, 0
  s_sub_u32 s71, s71, s74
  v_mfma_f32_16x16x32_bf16 v[124:127], v[132:135], v[216:219], v[124:127]
  s_add_u32 s54, s53, 4096
  s_cmp_eq_u32 s54, s59
  s_cselect_b32 s54, s58, s54
  v_mfma_f32_16x16x32_bf16 v[124:127], v[136:139], v[212:215], v[124:127]
  s_add_u32 s55, s54, 4096
  s_cmp_eq_u32 s55, s59
  s_cselect_b32 s55, s58, s55
  v_mfma_f32_16x16x32_bf16 v[124:127], v[140:143], v[208:211], v[124:127]
  s_add_u32 s56, s55, 4096
  s_cmp_eq_u32 s56, s59
  s_cselect_b32 s56, s58, s56
  v_mfma_f32_16x16x32_bf16 v[124:127], v[144:147], v[204:207], v[124:127]
  s_add_u32 s57, s56, 4096
  s_cmp_eq_u32 s57, s59
  s_cselect_b32 s57, s58, s57
  v_mfma_f32_16x16x32_bf16 v[124:127], v[148:151], v[200:203], v[124:127]
  buffer_load_dwordx4 a[60:63], v1, s[44:47], s71 offen offset:0 sc1
  v_mfma_f32_16x16x32_bf16 v[124:127], v[152:155], v[196:199], v[124:127]
  v_mfma_f32_16x16x32_bf16 v[124:127], v[156:159], v[192:195], v[124:127]
  s_waitcnt lgkmcnt(0)
  v_mfma_f32_16x16x32_bf16 v[96:99], v[160:163], v[224:227], v[96:99]
  ds_read_b128 v[128:131], v10 offset:3904
  v_mfma_f32_16x16x32_bf16 v[100:103], v[160:163], v[228:231], v[100:103]
  ds_read2_b32 v[192:193], v11 offset0:80 offset1:81
  v_mfma_f32_16x16x32_bf16 v[100:103], v[164:167], v[224:227], v[100:103]
  ds_read2_b32 v[194:195], v11 offset0:82 offset1:83
  buffer_load_dwordx4 a[64:67], v1, s[44:47], s71 offen offset:1024 sc1
  v_mfma_f32_16x16x32_bf16 v[104:107], v[160:163], v[232:235], v[104:107]
  ds_read_b128 v[132:135], v10 offset:3392
  v_mfma_f32_16x16x32_bf16 v[104:107], v[164:167], v[228:231], v[104:107]
  ds_read2_b32 v[196:197], v11 offset0:208 offset1:209
  v_mfma_f32_16x16x32_bf16 v[104:107], v[168:171], v[224:227], v[104:107]
  ds_read2_b32 v[198:199], v11 offset0:210 offset1:211
  v_mfma_f32_16x16x32_bf16 v[108:111], v[160:163], v[236:239], v[108:111]
  ds_read_b128 v[136:139], v10 offset:2880
  buffer_load_dwordx4 a[68:71], v1, s[44:47], s71 offen offset:2048 sc1
  v_mfma_f32_16x16x32_bf16 v[108:111], v[164:167], v[232:235], v[108:111]
  ds_read2_b32 v[200:201], v92 offset0:80 offset1:81
  v_mfma_f32_16x16x32_bf16 v[108:111], v[168:171], v[228:231], v[108:111]
  ds_read2_b32 v[202:203], v92 offset0:82 offset1:83
  v_mfma_f32_16x16x32_bf16 v[108:111], v[172:175], v[224:227], v[108:111]
  ds_read_b128 v[140:143], v10 offset:2368
  v_mfma_f32_16x16x32_bf16 v[112:115], v[160:163], v[240:243], v[112:115]
  ds_read2_b32 v[204:205], v92 offset0:208 offset1:209
  v_mfma_f32_16x16x32_bf16 v[112:115], v[164:167], v[236:239], v[112:115]
  ds_read2_b32 v[206:207], v92 offset0:210 offset1:211
  buffer_load_dwordx4 a[72:75], v1, s[44:47], s71 offen offset:3072 sc1
  v_mfma_f32_16x16x32_bf16 v[112:115], v[168:171], v[232:235], v[112:115]
  ds_read_b128 v[144:147], v10 offset:1856
  v_mfma_f32_16x16x32_bf16 v[112:115], v[172:175], v[228:231], v[112:115]
  ds_read2_b32 v[208:209], v93 offset0:80 offset1:81
  v_mfma_f32_16x16x32_bf16 v[112:115], v[176:179], v[224:227], v[112:115]
  ds_read2_b32 v[210:211], v93 offset0:82 offset1:83
  v_mfma_f32_16x16x32_bf16 v[116:119], v[160:163], v[244:247], v[116:119]
  ds_read_b128 v[148:151], v10 offset:1344
  s_add_u32 s74, s71, 4096
  s_add_u32 s71, s71, 5120
  buffer_load_dwordx4 a[76:79], v1, s[44:47], s74 offen sc1
  s_cmp_ge_u32 s71, s73
  s_cselect_b32 s74, 245760, 0
  s_sub_u32 s71, s71, s74
  v_mfma_f32_16x16x32_bf16 v[116:119], v[164:167], v[240:243], v[116:119]
  ds_read2_b32 v[212:213], v93 offset0:208 offset1:209
  v_mfma_f32_16x16x32_bf16 v[116:119], v[168:171], v[236:239], v[116:119]
  ds_read2_b32 v[214:215], v93 offset0:210 offset1:211
  v_mfma_f32_16x16x32_bf16 v[116:119], v[172:175], v[232:235], v[116:119]
  ds_read_b128 v[152:155], v10 offset:832
  v_mfma_f32_16x16x32_bf16 v[116:119], v[176:179], v[228:231], v[116:119]
  ds_read2_b32 v[216:217], v94 offset0:80 offset1:81
  v_mfma_f32_16x16x32_bf16 v[116:119], v[180:183], v[224:227], v[116:119]
  ds_read2_b32 v[218:219], v94 offset0:82 offset1:83
  buffer_load_dwordx4 a[80:83], v1, s[44:47], s71 offen offset:0 sc1
  v_mfma_f32_16x16x32_bf16 v[120:123], v[160:163], v[248:251], v[120:123]
  ds_read_b128 v[156:159], v10 offset:320
  v_mfma_f32_16x16x32_bf16 v[120:123], v[164:167], v[244:247], v[120:123]
  ds_read2_b32 v[220:221], v94 offset0:208 offset1:209
  v_mfma_f32_16x16x32_bf16 v[120:123], v[168:171], v[240:243], v[120:123]
  ds_read2_b32 v[222:223], v94 offset0:210 offset1:211
  v_mfma_f32_16x16x32_bf16 v[120:123], v[172:175], v[236:239], v[120:123]
  buffer_load_dwordx4 a[84:87], v1, s[44:47], s71 offen offset:1024 sc1
  v_mfma_f32_16x16x32_bf16 v[120:123], v[176:179], v[232:235], v[120:123]
  v_mfma_f32_16x16x32_bf16 v[120:123], v[180:183], v[228:231], v[120:123]
  v_mfma_f32_16x16x32_bf16 v[120:123], v[184:187], v[224:227], v[120:123]
  v_mfma_f32_16x16x32_bf16 v[124:127], v[160:163], v[252:255], v[124:127]
  v_mfma_f32_16x16x32_bf16 v[124:127], v[164:167], v[248:251], v[124:127]
  buffer_load_dwordx4 a[88:91], v1, s[44:47], s71 offen offset:2048 sc1
  v_mfma_f32_16x16x32_bf16 v[124:127], v[168:171], v[244:247], v[124:127]
  v_mfma_f32_16x16x32_bf16 v[124:127], v[172:175], v[240:243], v[124:127]
  v_mfma_f32_16x16x32_bf16 v[124:127], v[176:179], v[236:239], v[124:127]
  v_mfma_f32_16x16x32_bf16 v[124:127], v[180:183], v[232:235], v[124:127]
  buffer_load_dwordx4 a[92:95], v1, s[44:47], s71 offen offset:3072 sc1
  v_mfma_f32_16x16x32_bf16 v[124:127], v[184:187], v[228:231], v[124:127]
  v_mfma_f32_16x16x32_bf16 v[124:127], v[188:191], v[224:227], v[124:127]
  s_waitcnt lgkmcnt(0)
  v_mfma_f32_16x16x32_bf16 v[96:99], v[128:131], v[192:195], v[96:99]
  ds_read_b128 v[160:163], v10 offset:3840
  v_mfma_f32_16x16x32_bf16 v[100:103], v[128:131], v[196:199], v[100:103]
  ds_read2_b32 v[224:225], v11 offset0:64 offset1:65
  v_mfma_f32_16x16x32_bf16 v[100:103], v[132:135], v[192:195], v[100:103]
  ds_read2_b32 v[226:227], v11 offset0:66 offset1:67
  s_add_u32 s74, s71, 4096
  s_add_u32 s71, s71, 5120
  buffer_load_dwordx4 a[96:99], v1, s[44:47], s74 offen sc1
  s_cmp_ge_u32 s71, s73
  s_cselect_b32 s74, 245760, 0
  s_sub_u32 s71, s71, s74
  v_mfma_f32_16x16x32_bf16 v[104:107], v[128:131], v[200:203], v[104:107]
  ds_read_b128 v[164:167], v10 offset:3328
  v_mfma_f32_16x16x32_bf16 v[104:107], v[132:135], v[196:199], v[104:107]
  ds_read2_b32 v[228:229], v11 offset0:192 offset1:193
  v_mfma_f32_16x16x32_bf16 v[104:107], v[136:139], v[192:195], v[104:107]
  ds_read2_b32 v[230:231], v11 offset0:194 offset1:195
  v_mfma_f32_16x16x32_bf16 v[108:111], v[128:131], v[204:207], v[108:111]
  ds_read_b128 v[168:171], v10 offset:2816
  buffer_load_dwordx4 a[100:103], v1, s[44:47], s71 offen offset:0 sc1
  v_mfma_f32_16x16x32_bf16 v[108:111], v[132:135], v[200:203], v[108:111]
  ds_read2_b32 v[232:233], v92 offset0:64 offset1:65
  v_mfma_f32_16x16x32_bf16 v[108:111], v[136:139], v[196:199], v[108:111]
  ds_read2_b32 v[234:235], v92 offset0:66 offset1:67
  v_mfma_f32_16x16x32_bf16 v[108:111], v[140:143], v[192:195], v[108:111]
  ds_read_b128 v[172:175], v10 offset:2304
  v_mfma_f32_16x16x32_bf16 v[112:115], v[128:131], v[208:211], v[112:115]
  ds_read2_b32 v[236:237], v92 offset0:192 offset1:193
  v_mfma_f32_16x16x32_bf16 v[112:115], v[132:135], v[204:207], v[112:115]
  ds_read2_b32 v[238:239], v92 offset0:194 offset1:195
  buffer_load_dwordx4 a[104:107], v1, s[44:47], s71 offen offset:1024 sc1
  v_mfma_f32_16x16x32_bf16 v[112:115], v[136:139], v[200:203], v[112:115]
  ds_read_b128 v[176:179], v10 offset:1792
  v_mfma_f32_16x16x32_bf16 v[112:115], v[140:143], v[196:199], v[112:115]
  ds_read2_b32 v[240:241], v93 offset0:64 offset1:65
  v_mfma_f32_16x16x32_bf16 v[112:115], v[144:147], v[192:195], v[112:115]
  ds_read2_b32 v[242:243], v93 offset0:66 offset1:67
  v_mfma_f32_16x16x32_bf16 v[116:119], v[128:131], v[212:215], v[116:119]
  ds_read_b128 v[180:183], v10 offset:1280
  buffer_load_dwordx4 a[108:111], v1, s[44:47], s71 offen offset:2048 sc1
  v_mfma_f32_16x16x32_bf16 v[116:119], v[132:135], v[208:211], v[116:119]
  ds_read2_b32 v[244:245], v93 offset0:192 offset1:193
  v_mfma_f32_16x16x32_bf16 v[116:119], v[136:139], v[204:207], v[116:119]
  ds_read2_b32 v[246:247], v93 offset0:194 offset1:195
  v_mfma_f32_16x16x32_bf16 v[116:119], v[140:143], v[200:203], v[116:119]
  ds_read_b128 v[184:187], v10 offset:768
  v_mfma_f32_16x16x32_bf16 v[116:119], v[144:147], v[196:199], v[116:119]
  ds_read2_b32 v[248:249], v94 offset0:64 offset1:65
  v_mfma_f32_16x16x32_bf16 v[116:119], v[148:151], v[192:195], v[116:119]
  ds_read2_b32 v[250:251], v94 offset0:66 offset1:67
  buffer_load_dwordx4 a[112:115], v1, s[44:47], s71 offen offset:3072 sc1
  v_mfma_f32_16x16x32_bf16 v[120:123], v[128:131], v[216:219], v[120:123]
  ds_read_b128 v[188:191], v10 offset:256
  v_mfma_f32_16x16x32_bf16 v[120:123], v[132:135], v[212:215], v[120:123]
  ds_read2_b32 v[252:253], v94 offset0:192 offset1:193
  v_mfma_f32_16x16x32_bf16 v[120:123], v[136:139], v[208:211], v[120:123]
  ds_read2_b32 v[254:255], v94 offset0:194 offset1:195
  v_mfma_f32_16x16x32_bf16 v[120:123], v[140:143], v[204:207], v[120:123]
  s_add_u32 s74, s71, 4096
  s_add_u32 s71, s71, 5120
  buffer_load_dwordx4 a[116:119], v1, s[44:47], s74 offen sc1
  s_cmp_ge_u32 s71, s73
  s_cselect_b32 s74, 245760, 0
  s_sub_u32 s71, s71, s74
  v_mfma_f32_16x16x32_bf16 v[120:123], v[144:147], v[200:203], v[120:123]
  v_mfma_f32_16x16x32_bf16 v[120:123], v[148:151], v[196:199], v[120:123]
L_st2:
  s_cbranch_execz L_st0
  v_mfma_f32_16x16x32_bf16 v[120:123], v[152:155], v[192:195], v[120:123]
  v_mfma_f32_16x16x32_bf16 v[124:127], v[128:131], v[220:223], v[124:127]
  v_mfma_f32_16x16x32_bf16 v[124:127], v[132:135], v[216:219], v[124:127]
  buffer_load_dwordx4 a[120:123], v1, s[44:47], s71 offen offset:0 sc1
  v_mfma_f32_16x16x32_bf16 v[124:127], v[136:139], v[212:215], v[124:127]
  v_mfma_f32_16x16x32_bf16 v[124:127], v[140:143], v[208:211], v[124:127]
  v_mfma_f32_16x16x32_bf16 v[124:127], v[144:147], v[204:207], v[124:127]
  v_mfma_f32_16x16x32_bf16 v[124:127], v[148:151], v[200:203], v[124:127]
  buffer_load_dwordx4 a[124:127], v1, s[44:47], s71 offen offset:1024 sc1
  v_mfma_f32_16x16x32_bf16 v[124:127], v[152:155], v[196:199], v[124:127]
  v_mfma_f32_16x16x32_bf16 v[124:127], v[156:159], v[192:195], v[124:127]
  s_waitcnt lgkmcnt(0)
  v_mfma_f32_16x16x32_bf16 v[96:99], v[160:163], v[224:227], v[96:99]
  ds_read_b128 v[128:131], v10 offset:3776
  v_mfma_f32_16x16x32_bf16 v[100:103], v[160:163], v[228:231], v[100:103]
  ds_read2_b32 v[192:193], v11 offset0:48 offset1:49
  v_mfma_f32_16x16x32_bf16 v[100:103], v[164:167], v[224:227], v[100:103]
  ds_read2_b32 v[194:195], v11 offset0:50 offset1:51
  v_mfma_f32_16x16x32_bf16 v[104:107], v[160:163], v[232:235], v[104:107]
  ds_read_b128 v[132:135], v10 offset:3264
  buffer_load_dwordx4 a[128:131], v1, s[44:47], s71 offen offset:2048 sc1
  v_mfma_f32_16x16x32_bf16 v[104:107], v[164:167], v[228:231], v[104:107]
  ds_read2_b32 v[196:197], v11 offset0:176 offset1:177
  v_mfma_f32_16x16x32_bf16 v[104:107], v[168:171], v[224:227], v[104:107]
  ds_read2_b32 v[198:199], v11 offset0:178 offset1:179
  v_mfma_f32_16x16x32_bf16 v[108:111], v[160:163], v[236:239], v[108:111]
  ds_read_b128 v[136:139], v10 offset:2752
  v_mfma_f32_16x16x32_bf16 v[108:111], v[164:167], v[232:235], v[108:111]
  ds_read2_b32 v[200:201], v92 offset0:48 offset1:49
  v_mfma_f32_16x16x32_bf16 v[108:111], v[168:171], v[228:231], v[108:111]
  ds_read2_b32 v[202:203], v92 offset0:50 offset1:51
  v_mfma_f32_16x16x32_bf16 v[108:111], v[172:175], v[224:227], v[108:111]
  ds_read_b128 v[140:143], v10 offset:2240
  buffer_load_dwordx4 a[132:135], v1, s[44:47], s71 offen offset:3072 sc1
  v_mfma_f32_16x16x32_bf16 v[112:115], v[160:163], v[240:243], v[112:115]
  ds_read2_b32 v[204:205], v92 offset0:176 offset1:177
  v_mfma_f32_16x16x32_bf16 v[112:115], v[164:167], v[236:239], v[112:115]
  ds_read2_b32 v[206:207], v92 offset0:178 offset1:179
  v_mfma_f32_16x16x32_bf16 v[112:115], v[168:171], v[232:235], v[112:115]
  ds_read_b128 v[144:147], v10 offset:1728
  v_mfma_f32_16x16x32_bf16 v[112:115], v[172:175], v[228:231], v[112:115]
  ds_read2_b32 v[208:209], v93 offset0:48 offset1:49
  v_mfma_f32_16x16x32_bf16 v[112:115], v[176:179], v[224:227], v[112:115]
  ds_read2_b32 v[210:211], v93 offset0:50 offset1:51
  v_mfma_f32_16x16x32_bf16 v[116:119], v[160:163], v[244:247], v[116:119]
  ds_read_b128 v[148:151], v10 offset:1216
  s_add_u32 s74, s71, 4096
  s_add_u32 s71, s71, 5120
  buffer_load_dwordx4 a[136:139], v1, s[44:47], s74 offen sc1
  s_cmp_ge_u32 s71, s73
  s_cselect_b32 s74, 245760, 0
  s_sub_u32 s71, s71, s74
  v_mfma_f32_16x16x32_bf16 v[116:119], v[164:167], v[240:243], v[116:119]
  ds_read2_b32 v[212:213], v93 offset0:176 offset1:177
  v_mfma_f32_16x16x32_bf16 v[116:119], v[168:171], v[236:239], v[116:119]
  ds_read2_b32 v[214:215], v93 offset0:178 offset1:179
  v_mfma_f32_16x16x32_bf16 v[116:119], v[172:175], v[232:235], v[116:119]
  ds_read_b128 v[152:155], v10 offset:704
  v_mfma_f32_16x16x32_bf16 v[116:119], v[176:179], v[228:231], v[116:119]
  ds_read2_b32 v[216:217], v94 offset0:48 offset1:49
  v_mfma_f32_16x16x32_bf16 v[116:119], v[180:183], v[224:227], v[116:119]
  ds_read2_b32 v[218:219], v94 offset0:50 offset1:51
  v_mfma_f32_16x16x32_bf16 v[120:123], v[160:163], v[248:251], v[120:123]
  ds_read_b128 v[156:159], v10 offset:192
  buffer_load_dwordx4 a[140:143], v1, s[44:47], s71 offen offset:0 sc1
  v_mfma_f32_16x16x32_bf16 v[120:123], v[164:167], v[244:247], v[120:123]
  ds_read2_b32 v[220:221], v94 offset0:176 offset1:177
  v_mfma_f32_16x16x32_bf16 v[120:123], v[168:171], v[240:243], v[120:123]
  ds_read2_b32 v[222:223], v94 offset0:178 offset1:179
  v_mfma_f32_16x16x32_bf16 v[120:123], v[172:175], v[236:239], v[120:123]
  v_mfma_f32_16x16x32_bf16 v[120:123], v[176:179], v[232:235], v[120:123]
  v_mfma_f32_16x16x32_bf16 v[120:123], v[180:183], v[228:231], v[120:123]
  v_mfma_f32_16x16x32_bf16 v[120:123], v[184:187], v[224:227], v[120:123]
  buffer_load_dwordx4 a[144:147], v1, s[44:47], s71 offen offset:1024 sc1
  v_mfma_f32_16x16x32_bf16 v[124:127], v[160:163], v[252:255], v[124:127]
  v_mfma_f32_16x16x32_bf16 v[124:127], v[164:167], v[248:251], v[124:127]
  v_mfma_f32_16x16x32_bf16 v[124:127], v[168:171], v[244:247], v[124:127]
  v_mfma_f32_16x16x32_bf16 v[124:127], v[172:175], v[240:243], v[124:127]
  v_mfma_f32_16x16x32_bf16 v[124:127], v[176:179], v[236:239], v[124:127]
  v_mfma_f32_16x16x32_bf16 v[124:127], v[180:183], v[232:235], v[124:127]
  buffer_load_dwordx4 a[148:151], v1, s[44:47], s71 offen offset:2048 sc1
  v_mfma_f32_16x16x32_bf16 v[124:127], v[184:187], v[228:231], v[124:127]
  v_mfma_f32_16x16x32_bf16 v[124:127], v[188:191], v[224:227], v[124:127]
  s_waitcnt lgkmcnt(0)
  v_mfma_f32_16x16x32_bf16 v[96:99], v[128:131], v[192:195], v[96:99]
  ds_read_b128 v[160:163], v10 offset:3712
  v_mfma_f32_16x16x32_bf16 v[100:103], v[128:131], v[196:199], v[100:103]
  ds_read2_b32 v[224:225], v11 offset0:32 offset1:33
  v_mfma_f32_16x16x32_bf16 v[100:103], v[132:135], v[192:195], v[100:103]
  ds_read2_b32 v[226:227], v11 offset0:34 offset1:35
  v_mov_b32 v5, v7
  s_mov_b32 exec_lo, 0xfff
  s_mov_b32 exec_hi, 0
  buffer_load_dword v5, v3, s[44:47], 0 offen sc1
  s_mov_b64 exec, -1
  v_mfma_f32_16x16x32_bf16 v[104:107], v[128:131], v[200:203], v[104:107]
  ds_read_b128 v[164:167], v10 offset:3200
  v_mfma_f32_16x16x32_bf16 v[104:107], v[132:135], v[196:199], v[104:107]
  ds_read2_b32 v[228:229], v11 offset0:160 offset1:161
  v_mfma_f32_16x16x32_bf16 v[104:107], v[136:139], v[192:195], v[104:107]
  ds_read2_b32 v[230:231], v11 offset0:162 offset1:163
  v_mfma_f32_16x16x32_bf16 v[108:111], v[128:131], v[204:207], v[108:111]
  ds_read_b128 v[168:171], v10 offset:2688
  v_mfma_f32_16x16x32_bf16 v[108:111], v[132:135], v[200:203], v[108:111]
  ds_read2_b32 v[232:233], v92 offset0:32 offset1:33
  buffer_load_dwordx4 a[152:155], v1, s[44:47], s71 offen offset:3072 sc1
  v_mfma_f32_16x16x32_bf16 v[108:111], v[136:139], v[196:199], v[108:111]
  ds_read2_b32 v[234:235], v92 offset0:34 offset1:35
  v_mfma_f32_16x16x32_bf16 v[108:111], v[140:143], v[192:195], v[108:111]
  ds_read_b128 v[172:175], v10 offset:2176
  v_mfma_f32_16x16x32_bf16 v[112:115], v[128:131], v[208:211], v[112:115]
  ds_read2_b32 v[236:237], v92 offset0:160 offset1:161
  v_mfma_f32_16x16x32_bf16 v[112:115], v[132:135], v[204:207], v[112:115]
  ds_read2_b32 v[238:239], v92 offset0:162 offset1:163
  v_mfma_f32_16x16x32_bf16 v[112:115], v[136:139], v[200:203], v[112:115]
  ds_read_b128 v[176:179], v10 offset:1664
  s_add_u32 s74, s71, 4096
  s_add_u32 s71, s71, 5120
  buffer_load_dwordx4 a[156:159], v1, s[44:47], s74 offen sc1
  s_cmp_ge_u32 s71, s73
  s_cselect_b32 s74, 245760, 0
  s_sub_u32 s71, s71, s74
  v_mfma_f32_16x16x32_bf16 v[112:115], v[140:143], v[196:199], v[112:115]
  ds_read2_b32 v[240:241], v93 offset0:32 offset1:33
  v_mfma_f32_16x16x32_bf16 v[112:115], v[144:147], v[192:195], v[112:115]
  ds_read2_b32 v[242:243], v93 offset0:34 offset1:35
  v_mfma_f32_16x16x32_bf16 v[116:119], v[128:131], v[212:215], v[116:119]
  ds_read_b128 v[180:183], v10 offset:1152
  v_mfma_f32_16x16x32_bf16 v[116:119], v[132:135], v[208:211], v[116:119]
  ds_read2_b32 v[244:245], v93 offset0:160 offset1:161
  v_mfma_f32_16x16x32_bf16 v[116:119], v[136:139], v[204:207], v[116:119]
  ds_read2_b32 v[246:247], v93 offset0:162 offset1:163
  v_mfma_f32_16x16x32_bf16 v[116:119], v[140:143], v[200:203], v[116:119]
  ds_read_b128 v[184:187], v10 offset:640
  buffer_load_dwordx4 a[160:163], v1, s[44:47], s71 offen offset:0 sc1
  v_mfma_f32_16x16x32_bf16 v[116:119], v[144:147], v[196:199], v[116:119]
  ds_read2_b32 v[248:249], v94 offset0:32 offset1:33
  v_mfma_f32_16x16x32_bf16 v[116:119], v[148:151], v[192:195], v[116:119]
  ds_read2_b32 v[250:251], v94 offset0:34 offset1:35
  v_mfma_f32_16x16x32_bf16 v[120:123], v[128:131], v[216:219], v[120:123]
  ds_read_b128 v[188:191], v10 offset:128
  v_mfma_f32_16x16x32_bf16 v[120:123], v[132:135], v[212:215], v[120:123]
  ds_read2_b32 v[252:253], v94 offset0:160 offset1:161
  v_mfma_f32_16x16x32_bf16 v[120:123], v[136:139], v[208:211], v[120:123]
  ds_read2_b32 v[254:255], v94 offset0:162 offset1:163
  buffer_load_dwordx4 a[164:167], v1, s[44:47], s71 offen offset:1024 sc1
  v_mfma_f32_16x16x32_bf16 v[120:123], v[140:143], v[204:207], v[120:123]
  v_mfma_f32_16x16x32_bf16 v[120:123], v[144:147], v[200:203], v[120:123]
  v_mfma_f32_16x16x32_bf16 v[120:123], v[148:151], v[196:199], v[120:123]
  v_mfma_f32_16x16x32_bf16 v[120:123], v[152:155], v[192:195], v[120:123]
  v_mfma_f32_16x16x32_bf16 v[124:127], v[128:131], v[220:223], v[124:127]
  buffer_load_dwordx4 a[168:171], v1, s[44:47], s71 offen offset:2048 sc1
  v_mfma_f32_16x16x32_bf16 v[124:127], v[132:135], v[216:219], v[124:127]
  v_mfma_f32_16x16x32_bf16 v[124:127], v[136:139], v[212:215], v[124:127]
  v_mfma_f32_16x16x32_bf16 v[124:127], v[140:143], v[208:211], v[124:127]
  v_mfma_f32_16x16x32_bf16 v[124:127], v[144:147], v[204:207], v[124:127]
  v_mfma_f32_16x16x32_bf16 v[124:127], v[148:151], v[200:203], v[124:127]
  buffer_load_dwordx4 a[172:175], v1, s[44:47], s71 offen offset:3072 sc1
  v_mfma_f32_16x16x32_bf16 v[124:127], v[152:155], v[196:199], v[124:127]
  v_mfma_f32_16x16x32_bf16 v[124:127], v[156:159], v[192:195], v[124:127]
  s_waitcnt lgkmcnt(0)
  v_mfma_f32_16x16x32_bf16 v[96:99], v[160:163], v[224:227], v[96:99]
  ds_read_b128 v[128:131], v10 offset:3648
  v_mfma_f32_16x16x32_bf16 v[100:103], v[160:163], v[228:231], v[100:103]
  ds_read2_b32 v[192:193], v11 offset0:16 offset1:17
  s_waitcnt vmcnt(6)
  v_cmp_ne_u32 vcc, s61, v5
  s_cbranch_vccnz L_spin_Bb3
L_ret_Bb3:
  v_mfma_f32_16x16x32_bf16 v[100:103], v[164:167], v[224:227], v[100:103]
  ds_read2_b32 v[194:195], v11 offset0:18 offset1:19
  v_mfma_f32_16x16x32_bf16 v[104:107], v[160:163], v[232:235], v[104:107]
  ds_read_b128 v[132:135], v10 offset:3136
  v_mfma_f32_16x16x32_bf16 v[104:107], v[164:167], v[228:231], v[104:107]
  ds_read2_b32 v[196:197], v11 offset0:144 offset1:145
  s_add_u32 s74, s71, 4096
  s_add_u32 s71, s71, 5120
  buffer_load_dwordx4 a[176:179], v1, s[44:47], s74 offen sc1
  s_cmp_ge_u32 s71, s73
  s_cselect_b32 s74, 245760, 0
  s_sub_u32 s71, s71, s74
  v_mfma_f32_16x16x32_bf16 v[104:107], v[168:171], v[224:227], v[104:107]
  ds_read2_b32 v[198:199], v11 offset0:146 offset1:147
  v_mfma_f32_16x16x32_bf16 v[108:111], v[160:163], v[236:239], v[108:111]
  ds_read_b128 v[136:139], v10 offset:2624
  v_mfma_f32_16x16x32_bf16 v[108:111], v[164:167], v[232:235], v[108:111]
  ds_read2_b32 v[200:201], v92 offset0:16 offset1:17
  v_mfma_f32_16x16x32_bf16 v[108:111], v[168:171], v[228:231], v[108:111]
  ds_read2_b32 v[202:203], v92 offset0:18 offset1:19
  buffer_load_dwordx4 a[180:183], v1, s[44:47], s71 offen offset:0 sc1
  v_mfma_f32_16x16x32_bf16 v[108:111], v[172:175], v[224:227], v[108:111]
  ds_read_b128 v[140:143], v10 offset:2112
  v_mfma_f32_16x16x32_bf16 v[112:115], v[160:163], v[240:243], v[112:115]
  ds_read2_b32 v[204:205], v92 offset0:144 offset1:145
  v_mfma_f32_16x16x32_bf16 v[112:115], v[164:167], v[236:239], v[112:115]
  ds_read2_b32 v[206:207], v92 offset0:146 offset1:147
  buffer_load_dwordx4 a[184:187], v1, s[44:47], s71 offen offset:1024 sc1
  v_mfma_f32_16x16x32_bf16 v[112:115], v[168:171], v[232:235], v[112:115]
  ds_read_b128 v[144:147], v10 offset:1600
  v_mfma_f32_16x16x32_bf16 v[112:115], v[172:175], v[228:231], v[112:115]
  ds_read2_b32 v[208:209], v93 offset0:16 offset1:17
  v_mfma_f32_16x16x32_bf16 v[112:115], v[176:179], v[224:227], v[112:115]
  ds_read2_b32 v[210:211], v93 offset0:18 offset1:19
  buffer_load_dwordx4 a[188:191], v1, s[44:47], s71 offen offset:2048 sc1
  v_mfma_f32_16x16x32_bf16 v[116:119], v[160:163], v[244:247], v[116:119]
  ds_read_b128 v[148:151], v10 offset:1088
  v_mfma_f32_16x16x32_bf16 v[116:119], v[164:167], v[240:243], v[116:119]
  ds_read2_b32 v[212:213], v93 offset0:144 offset1:145
  v_mfma_f32_16x16x32_bf16 v[116:119], v[168:171], v[236:239], v[116:119]
  ds_read2_b32 v[214:215], v93 offset0:146 offset1:147
  v_mfma_f32_16x16x32_bf16 v[116:119], v[172:175], v[232:235], v[116:119]
  ds_read_b128 v[152:155], v10 offset:576
  buffer_load_dwordx4 a[192:195], v1, s[44:47], s71 offen offset:3072 sc1
  v_mfma_f32_16x16x32_bf16 v[116:119], v[176:179], v[228:231], v[116:119]
  ds_read2_b32 v[216:217], v94 offset0:16 offset1:17
  v_mfma_f32_16x16x32_bf16 v[116:119], v[180:183], v[224:227], v[116:119]
  ds_read2_b32 v[218:219], v94 offset0:18 offset1:19
  v_mfma_f32_16x16x32_bf16 v[120:123], v[160:163], v[248:251], v[120:123]
  ds_read_b128 v[156:159], v10 offset:64
  s_add_u32 s74, s71, 4096
  s_add_u32 s71, s71, 5120
  buffer_load_dwordx4 a[196:199], v1, s[44:47], s74 offen sc1
  s_cmp_ge_u32 s71, s73
  s_cselect_b32 s74, 245760, 0
  s_sub_u32 s71, s71, s74
  v_mfma_f32_16x16x32_bf16 v[120:123], v[164:167], v[244:247], v[120:123]
  ds_read2_b32 v[220:221], v94 offset0:144 offset1:145
  v_mfma_f32_16x16x32_bf16 v[120:123], v[168:171], v[240:243], v[120:123]
  ds_read2_b32 v[222:223], v94 offset0:146 offset1:147
  v_mfma_f32_16x16x32_bf16 v[120:123], v[172:175], v[236:239], v[120:123]
  s_add_u32 s75, s48, s76
  buffer_load_dwordx4 v[16:19], v1, s[44:47], s75 offen sc1
  v_mfma_f32_16x16x32_bf16 v[120:123], v[176:179], v[232:235], v[120:123]
  v_mfma_f32_16x16x32_bf16 v[120:123], v[180:183], v[228:231], v[120:123]
  v_mfma_f32_16x16x32_bf16 v[120:123], v[184:187], v[224:227], v[120:123]
  s_add_u32 s75, s49, s76
  buffer_load_dwordx4 v[20:23], v1, s[44:47], s75 offen sc1
  v_mfma_f32_16x16x32_bf16 v[124:127], v[160:163], v[252:255], v[124:127]
  v_mfma_f32_16x16x32_bf16 v[124:127], v[164:167], v[248:251], v[124:127]
  v_mfma_f32_16x16x32_bf16 v[124:127], v[168:171], v[244:247], v[124:127]
  v_mfma_f32_16x16x32_bf16 v[124:127], v[172:175], v[240:243], v[124:127]
  s_add_u32 s75, s50, s76
  buffer_load_dwordx4 v[24:27], v1, s[44:47], s75 offen sc1
  v_mfma_f32_16x16x32_bf16 v[124:127], v[176:179], v[236:239], v[124:127]
  v_mfma_f32_16x16x32_bf16 v[124:127], v[180:183], v[232:235], v[124:127]
  v_mfma_f32_16x16x32_bf16 v[124:127], v[184:187], v[228:231], v[124:127]
  s_add_u32 s75, s51, s76
  buffer_load_dwordx4 v[28:31], v1, s[44:47], s75 offen sc1
  v_mfma_f32_16x16x32_bf16 v[124:127], v[188:191], v[224:227], v[124:127]
  s_waitcnt lgkmcnt(0)
  v_mfma_f32_16x16x32_bf16 v[96:99], v[128:131], v[192:195], v[96:99]
  ds_read_b128 v[160:163], v10 offset:3584
  v_mfma_f32_16x16x32_bf16 v[100:103], v[128:131], v[196:199], v[100:103]
  ds_read2_b32 v[224:225], v11 offset0:0 offset1:1
  v_mfma_f32_16x16x32_bf16 v[100:103], v[132:135], v[192:195], v[100:103]
  ds_read2_b32 v[226:227], v11 offset0:2 offset1:3
  v_mfma_f32_16x16x32_bf16 v[104:107], v[128:131], v[200:203], v[104:107]
  ds_read_b128 v[164:167], v10 offset:3072
  s_add_u32 s75, s52, s76
  buffer_load_dwordx4 v[32:35], v1, s[44:47], s75 offen sc1
  v_mfma_f32_16x16x32_bf16 v[104:107], v[132:135], v[196:199], v[104:107]
  ds_read2_b32 v[228:229], v11 offset0:128 offset1:129
  v_mfma_f32_16x16x32_bf16 v[104:107], v[136:139], v[192:195], v[104:107]
  ds_read2_b32 v[230:231], v11 offset0:130 offset1:131
  v_mfma_f32_16x16x32_bf16 v[108:111], v[128:131], v[204:207], v[108:111]
  ds_read_b128 v[168:171], v10 offset:2560
  v_mfma_f32_16x16x32_bf16 v[108:111], v[132:135], v[200:203], v[108:111]
  ds_read2_b32 v[232:233], v92 offset0:0 offset1:1
  v_mfma_f32_16x16x32_bf16 v[108:111], v[136:139], v[196:199], v[108:111]
  ds_read2_b32 v[234:235], v92 offset0:2 offset1:3
  v_mfma_f32_16x16x32_bf16 v[108:111], v[140:143], v[192:195], v[108:111]
  ds_read_b128 v[172:175], v10 offset:2048
  s_add_u32 s75, s53, s76
  buffer_load_dwordx4 v[36:39], v1, s[44:47], s75 offen sc1
  v_mfma_f32_16x16x32_bf16 v[112:115], v[128:131], v[208:211], v[112:115]
  ds_read2_b32 v[236:237], v92 offset0:128 offset1:129
  v_mfma_f32_16x16x32_bf16 v[112:115], v[132:135], v[204:207], v[112:115]
  ds_read2_b32 v[238:239], v92 offset0:130 offset1:131
  v_mfma_f32_16x16x32_bf16 v[112:115], v[136:139], v[200:203], v[112:115]
  ds_read_b128 v[176:179], v10 offset:1536
  v_mfma_f32_16x16x32_bf16 v[112:115], v[140:143], v[196:199], v[112:115]
  ds_read2_b32 v[240:241], v93 offset0:0 offset1:1
  v_mfma_f32_16x16x32_bf16 v[112:115], v[144:147], v[192:195], v[112:115]
  ds_read2_b32 v[242:243], v93 offset0:2 offset1:3
  v_mfma_f32_16x16x32_bf16 v[116:119], v[128:131], v[212:215], v[116:119]
  ds_read_b128 v[180:183], v10 offset:1024
  s_add_u32 s75, s54, s76
  buffer_load_dwordx4 v[40:43], v1, s[44:47], s75 offen sc1
  v_mfma_f32_16x16x32_bf16 v[116:119], v[132:135], v[208:211], v[116:119]
  ds_read2_b32 v[244:245], v93 offset0:128 offset1:129
  v_mfma_f32_16x16x32_bf16 v[116:119], v[136:139], v[204:207], v[116:119]
  ds_read2_b32 v[246:247], v93 offset0:130 offset1:131
  v_mfma_f32_16x16x32_bf16 v[116:119], v[140:143], v[200:203], v[116:119]
  ds_read_b128 v[184:187], v10 offset:512
  v_mfma_f32_16x16x32_bf16 v[116:119], v[144:147], v[196:199], v[116:119]
  ds_read2_b32 v[248:249], v94 offset0:0 offset1:1
  v_mfma_f32_16x16x32_bf16 v[116:119], v[148:151], v[192:195], v[116:119]
  ds_read2_b32 v[250:251], v94 offset0:2 offset1:3
  v_mfma_f32_16x16x32_bf16 v[120:123], v[128:131], v[216:219], v[120:123]
  ds_read_b128 v[188:191], v10 offset:0
  s_add_u32 s75, s55, s76
  buffer_load_dwordx4 v[44:47], v1, s[44:47], s75 offen sc1
  v_mfma_f32_16x16x32_bf16 v[120:123], v[132:135], v[212:215], v[120:123]
  ds_read2_b32 v[252:253], v94 offset0:128 offset1:129
  v_mfma_f32_16x16x32_bf16 v[120:123], v[136:139], v[208:211], v[120:123]
  ds_read2_b32 v[254:255], v94 offset0:130 offset1:131
  v_mfma_f32_16x16x32_bf16 v[120:123], v[140:143], v[204:207], v[120:123]
  v_mfma_f32_16x16x32_bf16 v[120:123], v[144:147], v[200:203], v[120:123]
  v_mfma_f32_16x16x32_bf16 v[120:123], v[148:151], v[196:199], v[120:123]
  v_mfma_f32_16x16x32_bf16 v[120:123], v[152:155], v[192:195], v[120:123]
  s_add_u32 s75, s56, s76
  buffer_load_dwordx4 v[48:51], v1, s[44:47], s75 offen sc1
  v_mfma_f32_16x16x32_bf16 v[124:127], v[128:131], v[220:223], v[124:127]
  v_mfma_f32_16x16x32_bf16 v[124:127], v[132:135], v[216:219], v[124:127]
  v_mfma_f32_16x16x32_bf16 v[124:127], v[136:139], v[212:215], v[124:127]
  v_mfma_f32_16x16x32_bf16 v[124:127], v[140:143], v[208:211], v[124:127]
  v_mfma_f32_16x16x32_bf16 v[124:127], v[144:147], v[204:207], v[124:127]
  v_mfma_f32_16x16x32_bf16 v[124:127], v[148:151], v[200:203], v[124:127]
  s_add_u32 s75, s57, s76
  buffer_load_dwordx4 v[52:55], v1, s[44:47], s75 offen sc1
  v_mfma_f32_16x16x32_bf16 v[124:127], v[152:155], v[196:199], v[124:127]
  v_mfma_f32_16x16x32_bf16 v[124:127], v[156:159], v[192:195], v[124:127]
  s_waitcnt lgkmcnt(0)
  v_mfma_f32_16x16x32_bf16 v[96:99], v[160:163], v[224:227], v[96:99]
  v_mfma_f32_16x16x32_bf16 v[100:103], v[160:163], v[228:231], v[100:103]
  s_add_u32 s75, s48, s77
  buffer_load_dwordx4 v[56:59], v1, s[44:47], s75 offen sc1
  v_mfma_f32_16x16x32_bf16 v[100:103], v[164:167], v[224:227], v[100:103]
  v_mfma_f32_16x16x32_bf16 v[104:107], v[160:163], v[232:235], v[104:107]
  v_mfma_f32_16x16x32_bf16 v[104:107], v[164:167], v[228:231], v[104:107]
  v_mfma_f32_16x16x32_bf16 v[104:107], v[168:171], v[224:227], v[104:107]
  s_add_u32 s75, s49, s77
  buffer_load_dwordx4 v[60:63], v1, s[44:47], s75 offen sc1
  v_mfma_f32_16x16x32_bf16 v[108:111], v[160:163], v[236:239], v[108:111]
  v_mfma_f32_16x16x32_bf16 v[108:111], v[164:167], v[232:235], v[108:111]
  v_mfma_f32_16x16x32_bf16 v[108:111], v[168:171], v[228:231], v[108:111]
  v_mfma_f32_16x16x32_bf16 v[108:111], v[172:175], v[224:227], v[108:111]
  s_add_u32 s75, s50, s77
  buffer_load_dwordx4 v[64:67], v1, s[44:47], s75 offen sc1
  v_mfma_f32_16x16x32_bf16 v[112:115], v[160:163], v[240:243], v[112:115]
  v_mfma_f32_16x16x32_bf16 v[112:115], v[164:167], v[236:239], v[112:115]
  v_mfma_f32_16x16x32_bf16 v[112:115], v[168:171], v[232:235], v[112:115]
  s_add_u32 s75, s51, s77
  buffer_load_dwordx4 v[68:71], v1, s[44:47], s75 offen sc1
  v_mfma_f32_16x16x32_bf16 v[112:115], v[172:175], v[228:231], v[112:115]
  v_mfma_f32_16x16x32_bf16 v[112:115], v[176:179], v[224:227], v[112:115]
  v_mfma_f32_16x16x32_bf16 v[116:119], v[160:163], v[244:247], v[116:119]
  v_mfma_f32_16x16x32_bf16 v[116:119], v[164:167], v[240:243], v[116:119]
  s_add_u32 s75, s52, s77
  buffer_load_dwordx4 v[72:75], v1, s[44:47], s75 offen sc1
  v_mfma_f32_16x16x32_bf16 v[116:119], v[168:171], v[236:239], v[116:119]
  v_mfma_f32_16x16x32_bf16 v[116:119], v[172:175], v[232:235], v[116:119]
  v_mfma_f32_16x16x32_bf16 v[116:119], v[176:179], v[228:231], v[116:119]
  s_add_u32 s75, s53, s77
  buffer_load_dwordx4 v[76:79], v1, s[44:47], s75 offen sc1
  v_mfma_f32_16x16x32_bf16 v[116:119], v[180:183], v[224:227], v[116:119]
  v_mfma_f32_16x16x32_bf16 v[120:123], v[160:163], v[248:251], v[120:123]
  v_mfma_f32_16x16x32_bf16 v[120:123], v[164:167], v[244:247], v[120:123]
  v_mfma_f32_16x16x32_bf16 v[120:123], v[168:171], v[240:243], v[120:123]
  s_add_u32 s75, s54, s77
  buffer_load_dwordx4 v[80:83], v1, s[44:47], s75 offen sc1
  v_mfma_f32_16x16x32_bf16 v[120:123], v[172:175], v[236:239], v[120:123]
  v_mfma_f32_16x16x32_bf16 v[120:123], v[176:179], v[232:235], v[120:123]
  v_mfma_f32_16x16x32_bf16 v[120:123], v[180:183], v[228:231], v[120:123]
  v_mfma_f32_16x16x32_bf16 v[120:123], v[184:187], v[224:227], v[120:123]
  s_add_u32 s75, s55, s77
  buffer_load_dwordx4 v[84:87], v1, s[44:47], s75 offen sc1
  v_mfma_f32_16x16x32_bf16 v[124:127], v[160:163], v[252:255], v[124:127]
  v_mfma_f32_16x16x32_bf16 v[124:127], v[164:167], v[248:251], v[124:127]
  v_mfma_f32_16x16x32_bf16 v[124:127], v[168:171], v[244:247], v[124:127]
  s_add_u32 s75, s56, s77
  buffer_load_dwordx4 v[88:91], v1, s[44:47], s75 offen sc1
  v_mfma_f32_16x16x32_bf16 v[124:127], v[172:175], v[240:243], v[124:127]
  v_mfma_f32_16x16x32_bf16 v[124:127], v[176:179], v[236:239], v[124:127]
  v_mfma_f32_16x16x32_bf16 v[124:127], v[180:183], v[232:235], v[124:127]
  v_mfma_f32_16x16x32_bf16 v[124:127], v[184:187], v[228:231], v[124:127]
  s_add_u32 s75, s57, s77
  buffer_load_dwordx4 v[92:95], v1, s[44:47], s75 offen sc1
  v_mfma_f32_16x16x32_bf16 v[124:127], v[188:191], v[224:227], v[124:127]
  s_waitcnt vmcnt(19)
  v_mfma_f32_16x16x32_bf16 v[216:219], a[0:3], v[16:19], 0
  v_mfma_f32_16x16x32_bf16 v[220:223], a[4:7], v[16:19], 0
  s_lshl_b32 s85, s70, 1
  s_add_u32 s85, s85, 16932864
  v_mfma_f32_16x16x32_bf16 v[224:227], a[8:11], v[16:19], 0
  v_mfma_f32_16x16x32_bf16 v[228:231], a[12:15], v[16:19], 0
  v_cvt_pk_bf16_f32 v96, v96, v97
  v_cvt_pk_bf16_f32 v98, v98, v99
  v_mov_b32 v97, v6
  v_mov_b32 v99, v6
  buffer_store_dwordx4 v[96:99], v1, s[44:47], s85 offen offset:0 sc1
  v_mfma_f32_16x16x32_bf16 v[232:235], a[16:19], v[16:19], 0
  s_waitcnt vmcnt(19)
  v_mfma_f32_16x16x32_bf16 v[216:219], a[20:23], v[20:23], v[216:219]
  v_cvt_pk_bf16_f32 v100, v100, v101
  v_cvt_pk_bf16_f32 v102, v102, v103
  v_mov_b32 v101, v6
  v_mov_b32 v103, v6
  buffer_store_dwordx4 v[100:103], v1, s[44:47], s85 offen offset:1024 sc1
  v_mfma_f32_16x16x32_bf16 v[220:223], a[24:27], v[20:23], v[220:223]
  v_mfma_f32_16x16x32_bf16 v[224:227], a[28:31], v[20:23], v[224:227]
  v_cvt_pk_bf16_f32 v104, v104, v105
  v_cvt_pk_bf16_f32 v106, v106, v107
  v_mov_b32 v105, v6
  v_mov_b32 v107, v6
  buffer_store_dwordx4 v[104:107], v1, s[44:47], s85 offen offset:2048 sc1
  v_mfma_f32_16x16x32_bf16 v[228:231], a[32:35], v[20:23], v[228:231]
  v_mfma_f32_16x16x32_bf16 v[232:235], a[36:39], v[20:23], v[232:235]
  v_cvt_pk_bf16_f32 v108, v108, v109
  v_cvt_pk_bf16_f32 v110, v110, v111
  v_mov_b32 v109, v6
  v_mov_b32 v111, v6
  buffer_store_dwordx4 v[108:111], v1, s[44:47], s85 offen offset:3072 sc1
  s_waitcnt vmcnt(21)
  v_mfma_f32_16x16x32_bf16 v[216:219], a[40:43], v[24:27], v[216:219]
  v_mfma_f32_16x16x32_bf16 v[220:223], a[44:47], v[24:27], v[220:223]
  v_cvt_pk_bf16_f32 v112, v112, v113
  v_cvt_pk_bf16_f32 v114, v114, v115
  v_mov_b32 v113, v6
  v_mov_b32 v115, v6
  s_add_u32 s85, s85, 4096
  buffer_store_dwordx4 v[112:115], v1, s[44:47], s85 offen offset:0 sc1
  v_mfma_f32_16x16x32_bf16 v[224:227], a[48:51], v[24:27], v[224:227]
  v_mfma_f32_16x16x32_bf16 v[228:231], a[52:55], v[24:27], v[228:231]
  v_cvt_pk_bf16_f32 v116, v116, v117
  v_cvt_pk_bf16_f32 v118, v118, v119
  v_mov_b32 v117, v6
  v_mov_b32 v119, v6
  buffer_store_dwordx4 v[116:119], v1, s[44:47], s85 offen offset:1024 sc1
  v_mfma_f32_16x16x32_bf16 v[232:235], a[56:59], v[24:27], v[232:235]
  s_waitcnt vmcnt(22)
  v_mfma_f32_16x16x32_bf16 v[216:219], a[60:63], v[28:31], v[216:219]
  v_cvt_pk_bf16_f32 v120, v120, v121
  v_cvt_pk_bf16_f32 v122, v122, v123
  v_mov_b32 v121, v6
  v_mov_b32 v123, v6
  buffer_store_dwordx4 v[120:123], v1, s[44:47], s85 offen offset:2048 sc1
  v_mfma_f32_16x16x32_bf16 v[220:223], a[64:67], v[28:31], v[220:223]
  v_mfma_f32_16x16x32_bf16 v[224:227], a[68:71], v[28:31], v[224:227]
  v_cvt_pk_bf16_f32 v124, v124, v125
  v_cvt_pk_bf16_f32 v126, v126, v127
  v_mov_b32 v125, v6
  v_mov_b32 v127, v6
  buffer_store_dwordx4 v[124:127], v1, s[44:47], s85 offen offset:3072 sc1
  v_mfma_f32_16x16x32_bf16 v[228:231], a[72:75], v[28:31], v[228:231]
  v_mfma_f32_16x16x32_bf16 v[232:235], a[76:79], v[28:31], v[232:235]
  s_mul_i32 s86, s6, 2560
  s_add_u32 s86, s86, 61440
  v_mov_b32 v10, s86
  v_lshl_add_u32 v10, v0, 3, v10
  s_waitcnt vmcnt(23)
  v_mfma_f32_16x16x32_bf16 v[216:219], a[80:83], v[32:35], v[216:219]
  v_mfma_f32_16x16x32_bf16 v[220:223], a[84:87], v[32:35], v[220:223]
  s_add_u32 s75, s48, s78
  buffer_load_dwordx4 v[96:99], v1, s[44:47], s75 offen sc1
  v_mfma_f32_16x16x32_bf16 v[224:227], a[88:91], v[32:35], v[224:227]
  v_mfma_f32_16x16x32_bf16 v[228:231], a[92:95], v[32:35], v[228:231]
  v_and_b32 v208, 15, v0
  v_lshrrev_b32 v209, 2, v208
  v_lshlrev_b32 v209, 1, v209
  v_and_b32 v210, 1, v208
  v_mfma_f32_16x16x32_bf16 v[232:235], a[96:99], v[32:35], v[232:235]
  s_waitcnt vmcnt(23)
  v_mfma_f32_16x16x32_bf16 v[216:219], a[100:103], v[36:39], v[216:219]
  s_add_u32 s75, s49, s78
  buffer_load_dwordx4 v[100:103], v1, s[44:47], s75 offen sc1
  v_mfma_f32_16x16x32_bf16 v[220:223], a[104:107], v[36:39], v[220:223]
  v_mfma_f32_16x16x32_bf16 v[224:227], a[108:111], v[36:39], v[224:227]
  v_or_b32 v209, v209, v210
  v_and_b32 v210, 2, v208
  v_lshl_add_u32 v208, v210, 4, v209
  v_mfma_f32_16x16x32_bf16 v[228:231], a[112:115], v[36:39], v[228:231]
  v_mfma_f32_16x16x32_bf16 v[232:235], a[116:119], v[36:39], v[232:235]
  s_add_u32 s75, s50, s78
  buffer_load_dwordx4 v[104:107], v1, s[44:47], s75 offen sc1
  s_waitcnt vmcnt(24)
  v_mfma_f32_16x16x32_bf16 v[216:219], a[120:123], v[40:43], v[216:219]
  v_mfma_f32_16x16x32_bf16 v[220:223], a[124:127], v[40:43], v[220:223]
  v_mul_u32_u24 v208, 160, v208
  v_lshrrev_b32 v209, 4, v0
  v_lshl_add_u32 v208, v209, 3, v208
  v_add_u32 v11, s87, v208
  v_mfma_f32_16x16x32_bf16 v[224:227], a[128:131], v[40:43], v[224:227]
  v_mfma_f32_16x16x32_bf16 v[228:231], a[132:135], v[40:43], v[228:231]
  s_add_u32 s75, s51, s78
  buffer_load_dwordx4 v[108:111], v1, s[44:47], s75 offen sc1
  v_mfma_f32_16x16x32_bf16 v[232:235], a[136:139], v[40:43], v[232:235]
  s_waitcnt vmcnt(24)
  v_mfma_f32_16x16x32_bf16 v[216:219], a[140:143], v[44:47], v[216:219]
  v_mfma_f32_16x16x32_bf16 v[220:223], a[144:147], v[44:47], v[220:223]
  v_mfma_f32_16x16x32_bf16 v[224:227], a[148:151], v[44:47], v[224:227]
  s_add_u32 s75, s52, s78
  buffer_load_dwordx4 v[112:115], v1, s[44:47], s75 offen sc1
  v_mfma_f32_16x16x32_bf16 v[228:231], a[152:155], v[44:47], v[228:231]
  v_mfma_f32_16x16x32_bf16 v[232:235], a[156:159], v[44:47], v[232:235]
  s_waitcnt vmcnt(24)
  v_mfma_f32_16x16x32_bf16 v[216:219], a[160:163], v[48:51], v[216:219]
  v_mfma_f32_16x16x32_bf16 v[220:223], a[164:167], v[48:51], v[220:223]
  s_add_u32 s75, s53, s78
  buffer_load_dwordx4 v[116:119], v1, s[44:47], s75 offen sc1
  v_mfma_f32_16x16x32_bf16 v[224:227], a[168:171], v[48:51], v[224:227]
  v_mfma_f32_16x16x32_bf16 v[228:231], a[172:175], v[48:51], v[228:231]
  v_mfma_f32_16x16x32_bf16 v[232:235], a[176:179], v[48:51], v[232:235]
  s_waitcnt vmcnt(24)
  v_mfma_f32_16x16x32_bf16 v[216:219], a[180:183], v[52:55], v[216:219]
  s_add_u32 s75, s54, s78
  buffer_load_dwordx4 v[120:123], v1, s[44:47], s75 offen sc1
  v_mfma_f32_16x16x32_bf16 v[220:223], a[184:187], v[52:55], v[220:223]
  v_mfma_f32_16x16x32_bf16 v[224:227], a[188:191], v[52:55], v[224:227]
  v_mfma_f32_16x16x32_bf16 v[228:231], a[192:195], v[52:55], v[228:231]
  v_mfma_f32_16x16x32_bf16 v[232:235], a[196:199], v[52:55], v[232:235]
  s_add_u32 s75, s55, s78
  buffer_load_dwordx4 v[124:127], v1, s[44:47], s75 offen sc1
  s_waitcnt vmcnt(25)
  v_mfma_f32_16x16x32_bf16 v[236:239], a[0:3], v[56:59], 0
  v_mfma_f32_16x16x32_bf16 v[240:243], a[4:7], v[56:59], 0
  s_mul_i32 s84, s76, 15
  s_add_u32 s84, s84, 0
  v_add_u32 v8, s84, v1
  v_mfma_f32_16x16x32_bf16 v[244:247], a[8:11], v[56:59], 0
  v_mfma_f32_16x16x32_bf16 v[248:251], a[12:15], v[56:59], 0
  s_add_u32 s75, s56, s78
  buffer_load_dwordx4 v[128:131], v1, s[44:47], s75 offen sc1
  v_mfma_f32_16x16x32_bf16 v[252:255], a[16:19], v[56:59], 0
  s_waitcnt vmcnt(25)
  v_mfma_f32_16x16x32_bf16 v[236:239], a[20:23], v[60:63], v[236:239]
  ds_write_b128 v8, v[216:219] offset:0
  v_mfma_f32_16x16x32_bf16 v[240:243], a[24:27], v[60:63], v[240:243]
  v_mfma_f32_16x16x32_bf16 v[244:247], a[28:31], v[60:63], v[244:247]
  s_add_u32 s75, s57, s78
  buffer_load_dwordx4 v[132:135], v1, s[44:47], s75 offen sc1
  v_mfma_f32_16x16x32_bf16 v[248:251], a[32:35], v[60:63], v[248:251]
  v_mfma_f32_16x16x32_bf16 v[252:255], a[36:39], v[60:63], v[252:255]
  ds_write_b128 v8, v[220:223] offset:1024
  s_waitcnt vmcnt(25)
  v_mfma_f32_16x16x32_bf16 v[236:239], a[40:43], v[64:67], v[236:239]
  v_mfma_f32_16x16x32_bf16 v[240:243], a[44:47], v[64:67], v[240:243]
  s_add_u32 s75, s48, s79
  buffer_load_dwordx4 v[136:139], v1, s[44:47], s75 offen sc1
  v_mfma_f32_16x16x32_bf16 v[244:247], a[48:51], v[64:67], v[244:247]
  v_mfma_f32_16x16x32_bf16 v[248:251], a[52:55], v[64:67], v[248:251]
  ds_write_b128 v8, v[224:227] offset:2048
  v_mfma_f32_16x16x32_bf16 v[252:255], a[56:59], v[64:67], v[252:255]
  s_waitcnt vmcnt(25)
  v_mfma_f32_16x16x32_bf16 v[236:239], a[60:63], v[68:71], v[236:239]
  s_add_u32 s75, s49, s79
  buffer_load_dwordx4 v[140:143], v1, s[44:47], s75 offen sc1
  v_mfma_f32_16x16x32_bf16 v[240:243], a[64:67], v[68:71], v[240:243]
  v_mfma_f32_16x16x32_bf16 v[244:247], a[68:71], v[68:71], v[244:247]
  ds_write_b128 v8, v[228:231] offset:3072
  v_mfma_f32_16x16x32_bf16 v[248:251], a[72:75], v[68:71], v[248:251]
  v_mfma_f32_16x16x32_bf16 v[252:255], a[76:79], v[68:71], v[252:255]
  s_add_u32 s75, s50, s79
  buffer_load_dwordx4 v[144:147], v1, s[44:47], s75 offen sc1
  s_waitcnt vmcnt(26)
  v_mfma_f32_16x16x32_bf16 v[236:239], a[80:83], v[72:75], v[236:239]
  v_mfma_f32_16x16x32_bf16 v[240:243], a[84:87], v[72:75], v[240:243]
  ds_write_b128 v8, v[232:235] offset:4096
  v_mfma_f32_16x16x32_bf16 v[244:247], a[88:91], v[72:75], v[244:247]
  v_mfma_f32_16x16x32_bf16 v[248:251], a[92:95], v[72:75], v[248:251]
L_st3:
  s_cbranch_execz L_st1
  s_add_u32 s75, s51, s79
  buffer_load_dwordx4 v[148:151], v1, s[44:47], s75 offen sc1
  v_mfma_f32_16x16x32_bf16 v[252:255], a[96:99], v[72:75], v[252:255]
  s_waitcnt vmcnt(26)
  v_mfma_f32_16x16x32_bf16 v[236:239], a[100:103], v[76:79], v[236:239]
  s_waitcnt vmcnt(63)
  ds_read_b64 v[16:17], v11 offset:0
  ds_read_b64 v[18:19], v11 offset:32
  ds_read_b64 v[20:21], v11 offset:64
  ds_read_b64 v[22:23], v11 offset:96
  ds_read_b64 v[24:25], v11 offset:128
  v_mfma_f32_16x16x32_bf16 v[240:243], a[104:107], v[76:79], v[240:243]
  v_mfma_f32_16x16x32_bf16 v[244:247], a[108:111], v[76:79], v[244:247]
  s_add_u32 s75, s52, s79
  buffer_load_dwordx4 v[152:155], v1, s[44:47], s75 offen sc1
  v_mfma_f32_16x16x32_bf16 v[248:251], a[112:115], v[76:79], v[248:251]
  v_mfma_f32_16x16x32_bf16 v[252:255], a[116:119], v[76:79], v[252:255]
  v_lshrrev_b32 v3, 2, v0
  v_lshlrev_b32 v3, 13, v3
  s_waitcnt vmcnt(26)
  v_mfma_f32_16x16x32_bf16 v[236:239], a[120:123], v[80:83], v[236:239]
  v_mfma_f32_16x16x32_bf16 v[240:243], a[124:127], v[80:83], v[240:243]
  s_add_u32 s75, s53, s79
  buffer_load_dwordx4 v[156:159], v1, s[44:47], s75 offen sc1
  v_mfma_f32_16x16x32_bf16 v[244:247], a[128:131], v[80:83], v[244:247]
  v_mfma_f32_16x16x32_bf16 v[248:251], a[132:135], v[80:83], v[248:251]
  v_and_b32 v4, 3, v0
  v_lshl_add_u32 v3, v4, 4, v3
  v_mfma_f32_16x16x32_bf16 v[252:255], a[136:139], v[80:83], v[252:255]
  s_waitcnt vmcnt(26)
  v_mfma_f32_16x16x32_bf16 v[236:239], a[140:143], v[84:87], v[236:239]
  s_add_u32 s75, s54, s79
  buffer_load_dwordx4 v[160:163], v1, s[44:47], s75 offen sc1
  v_mfma_f32_16x16x32_bf16 v[240:243], a[144:147], v[84:87], v[240:243]
  v_mfma_f32_16x16x32_bf16 v[244:247], a[148:151], v[84:87], v[244:247]
  s_mul_i32 s80, s5, 655360
  s_lshl_b32 s81, s4, 8
  s_add_u32 s80, s80, s81
  s_lshl_b32 s81, s6, 6
  v_mfma_f32_16x16x32_bf16 v[248:251], a[152:155], v[84:87], v[248:251]
  v_mfma_f32_16x16x32_bf16 v[252:255], a[156:159], v[84:87], v[252:255]
  s_add_u32 s75, s55, s79
  buffer_load_dwordx4 v[164:167], v1, s[44:47], s75 offen sc1
  s_waitcnt vmcnt(27)
  v_mfma_f32_16x16x32_bf16 v[236:239], a[160:163], v[88:91], v[236:239]
  v_mfma_f32_16x16x32_bf16 v[240:243], a[164:167], v[88:91], v[240:243]
  s_add_u32 s80, s80, s81
  s_add_u32 s80, s80, 16932864
  s_add_u32 s81, s80, 131072
  s_add_u32 s82, s81, 131072
  v_mfma_f32_16x16x32_bf16 v[244:247], a[168:171], v[88:91], v[244:247]
  v_mfma_f32_16x16x32_bf16 v[248:251], a[172:175], v[88:91], v[248:251]
  s_add_u32 s75, s56, s79
  buffer_load_dwordx4 v[168:171], v1, s[44:47], s75 offen sc1
  v_mfma_f32_16x16x32_bf16 v[252:255], a[176:179], v[88:91], v[252:255]
  s_waitcnt vmcnt(27)
  v_mfma_f32_16x16x32_bf16 v[236:239], a[180:183], v[92:95], v[236:239]
  s_add_u32 s83, s82, 131072
  s_add_u32 s85, s83, 131072
  v_mfma_f32_16x16x32_bf16 v[240:243], a[184:187], v[92:95], v[240:243]
  v_mfma_f32_16x16x32_bf16 v[244:247], a[188:191], v[92:95], v[244:247]
  s_add_u32 s75, s57, s79
  buffer_load_dwordx4 v[172:175], v1, s[44:47], s75 offen sc1
  v_mfma_f32_16x16x32_bf16 v[248:251], a[192:195], v[92:95], v[248:251]
  v_mfma_f32_16x16x32_bf16 v[252:255], a[196:199], v[92:95], v[252:255]
  s_waitcnt lgkmcnt(0)
  v_lshlrev_b32 v196, 16, v16
  v_and_b32 v197, 0xffff0000, v16
  s_waitcnt vmcnt(19)
  v_mfma_f32_16x16x32_bf16 v[216:219], a[0:3], v[96:99], 0
  v_mfma_f32_16x16x32_bf16 v[220:223], a[4:7], v[96:99], 0
  v_mul_f32 v196, v12, v196
  v_mul_f32 v197, v12, v197
  v_mfma_f32_16x16x32_bf16 v[224:227], a[8:11], v[96:99], 0
  v_mfma_f32_16x16x32_bf16 v[228:231], a[12:15], v[96:99], 0
  v_lshlrev_b32 v198, 16, v17
  v_and_b32 v199, 0xffff0000, v17
  v_mfma_f32_16x16x32_bf16 v[232:235], a[16:19], v[96:99], 0
  s_waitcnt vmcnt(18)
  v_mfma_f32_16x16x32_bf16 v[216:219], a[20:23], v[100:103], v[216:219]
  s_mul_i32 s84, s77, 15
  s_add_u32 s84, s84, 5120
  v_add_u32 v8, s84, v1
  v_mfma_f32_16x16x32_bf16 v[220:223], a[24:27], v[100:103], v[220:223]
  v_mfma_f32_16x16x32_bf16 v[224:227], a[28:31], v[100:103], v[224:227]
  ds_write_b128 v8, v[236:239] offset:0
  v_mfma_f32_16x16x32_bf16 v[228:231], a[32:35], v[100:103], v[228:231]
  v_mfma_f32_16x16x32_bf16 v[232:235], a[36:39], v[100:103], v[232:235]
  ds_write_b128 v8, v[240:243] offset:1024
  s_waitcnt vmcnt(17)
  v_mfma_f32_16x16x32_bf16 v[216:219], a[40:43], v[104:107], v[216:219]
  v_mfma_f32_16x16x32_bf16 v[220:223], a[44:47], v[104:107], v[220:223]
  ds_write_b128 v8, v[244:247] offset:2048
  v_mfma_f32_16x16x32_bf16 v[224:227], a[48:51], v[104:107], v[224:227]
  v_mfma_f32_16x16x32_bf16 v[228:231], a[52:55], v[104:107], v[228:231]
  ds_write_b128 v8, v[248:251] offset:3072
  v_mfma_f32_16x16x32_bf16 v[232:235], a[56:59], v[104:107], v[232:235]
  s_waitcnt vmcnt(16)
  v_mfma_f32_16x16x32_bf16 v[216:219], a[60:63], v[108:111], v[216:219]
  ds_write_b128 v8, v[252:255] offset:4096
  v_mfma_f32_16x16x32_bf16 v[220:223], a[64:67], v[108:111], v[220:223]
  v_mfma_f32_16x16x32_bf16 v[224:227], a[68:71], v[108:111], v[224:227]
  v_mul_f32 v198, v12, v198
  v_mul_f32 v199, v12, v199
  v_mfma_f32_16x16x32_bf16 v[228:231], a[72:75], v[108:111], v[228:231]
  v_mfma_f32_16x16x32_bf16 v[232:235], a[76:79], v[108:111], v[232:235]
  v_lshlrev_b32 v200, 16, v18
  v_and_b32 v201, 0xffff0000, v18
  s_waitcnt vmcnt(15)
  v_mfma_f32_16x16x32_bf16 v[216:219], a[80:83], v[112:115], v[216:219]
  v_mfma_f32_16x16x32_bf16 v[220:223], a[84:87], v[112:115], v[220:223]
  v_mul_f32 v200, v12, v200
  v_mul_f32 v201, v12, v201
  v_mfma_f32_16x16x32_bf16 v[224:227], a[88:91], v[112:115], v[224:227]
  v_mfma_f32_16x16x32_bf16 v[228:231], a[92:95], v[112:115], v[228:231]
  v_lshlrev_b32 v202, 16, v19
  v_and_b32 v203, 0xffff0000, v19
  v_mfma_f32_16x16x32_bf16 v[232:235], a[96:99], v[112:115], v[232:235]
  s_waitcnt vmcnt(14)
  v_mfma_f32_16x16x32_bf16 v[216:219], a[100:103], v[116:119], v[216:219]
  v_mul_f32 v202, v12, v202
  v_mul_f32 v203, v12, v203
  v_mfma_f32_16x16x32_bf16 v[220:223], a[104:107], v[116:119], v[220:223]
  v_mfma_f32_16x16x32_bf16 v[224:227], a[108:111], v[116:119], v[224:227]
  v_lshlrev_b32 v204, 16, v20
  v_and_b32 v205, 0xffff0000, v20
  v_mfma_f32_16x16x32_bf16 v[228:231], a[112:115], v[116:119], v[228:231]
  v_mfma_f32_16x16x32_bf16 v[232:235], a[116:119], v[116:119], v[232:235]
  v_mul_f32 v204, v12, v204
  v_mul_f32 v205, v12, v205
  s_waitcnt vmcnt(13)
  v_mfma_f32_16x16x32_bf16 v[216:219], a[120:123], v[120:123], v[216:219]
  v_mfma_f32_16x16x32_bf16 v[220:223], a[124:127], v[120:123], v[220:223]
  v_lshlrev_b32 v206, 16, v21
  v_and_b32 v207, 0xffff0000, v21
  v_mfma_f32_16x16x32_bf16 v[224:227], a[128:131], v[120:123], v[224:227]
  v_mfma_f32_16x16x32_bf16 v[228:231], a[132:135], v[120:123], v[228:231]
  v_mul_f32 v206, v12, v206
  v_mul_f32 v207, v12, v207
  v_mfma_f32_16x16x32_bf16 v[232:235], a[136:139], v[120:123], v[232:235]
  s_waitcnt vmcnt(12)
  v_mfma_f32_16x16x32_bf16 v[216:219], a[140:143], v[124:127], v[216:219]
  v_lshlrev_b32 v208, 16, v22
  v_and_b32 v209, 0xffff0000, v22
  v_mfma_f32_16x16x32_bf16 v[220:223], a[144:147], v[124:127], v[220:223]
  v_mfma_f32_16x16x32_bf16 v[224:227], a[148:151], v[124:127], v[224:227]
  v_mul_f32 v208, v12, v208
  v_mul_f32 v209, v12, v209
  v_mfma_f32_16x16x32_bf16 v[228:231], a[152:155], v[124:127], v[228:231]
  v_mfma_f32_16x16x32_bf16 v[232:235], a[156:159], v[124:127], v[232:235]
  v_lshlrev_b32 v210, 16, v23
  v_and_b32 v211, 0xffff0000, v23
  s_waitcnt vmcnt(11)
  v_mfma_f32_16x16x32_bf16 v[216:219], a[160:163], v[128:131], v[216:219]
  v_mfma_f32_16x16x32_bf16 v[220:223], a[164:167], v[128:131], v[220:223]
  v_mul_f32 v210, v12, v210
  v_mul_f32 v211, v12, v211
  v_mfma_f32_16x16x32_bf16 v[224:227], a[168:171], v[128:131], v[224:227]
  v_mfma_f32_16x16x32_bf16 v[228:231], a[172:175], v[128:131], v[228:231]
  v_lshlrev_b32 v212, 16, v24
  v_and_b32 v213, 0xffff0000, v24
  v_mfma_f32_16x16x32_bf16 v[232:235], a[176:179], v[128:131], v[232:235]
  s_waitcnt vmcnt(10)
  v_mfma_f32_16x16x32_bf16 v[216:219], a[180:183], v[132:135], v[216:219]
  v_mul_f32 v212, v12, v212
  v_mul_f32 v213, v12, v213
  v_mfma_f32_16x16x32_bf16 v[220:223], a[184:187], v[132:135], v[220:223]
  v_mfma_f32_16x16x32_bf16 v[224:227], a[188:191], v[132:135], v[224:227]
  v_lshlrev_b32 v214, 16, v25
  v_and_b32 v215, 0xffff0000, v25
  v_mfma_f32_16x16x32_bf16 v[228:231], a[192:195], v[132:135], v[228:231]
  v_mfma_f32_16x16x32_bf16 v[232:235], a[196:199], v[132:135], v[232:235]
  v_mul_f32 v214, v12, v214
  v_mul_f32 v215, v12, v215
  buffer_load_dwordx4 v[176:179], v3, s[44:47], s80 offen sc1
  buffer_load_dwordx4 v[180:183], v3, s[44:47], s81 offen sc1
  buffer_load_dwordx4 v[184:187], v3, s[44:47], s82 offen sc1
  buffer_load_dwordx4 v[188:191], v3, s[44:47], s83 offen sc1
  buffer_load_dwordx4 v[192:195], v3, s[44:47], s85 offen sc1
  s_waitcnt vmcnt(14)
  v_mfma_f32_16x16x32_bf16 v[236:239], a[0:3], v[136:139], 0
  s_mul_i32 s84, s78, 15
  s_add_u32 s84, s84, 10240
  v_add_u32 v8, s84, v1
  v_mfma_f32_16x16x32_bf16 v[240:243], a[4:7], v[136:139], 0
  ds_write_b128 v8, v[216:219] offset:0
  v_mfma_f32_16x16x32_bf16 v[244:247], a[8:11], v[136:139], 0
  ds_write_b128 v8, v[220:223] offset:1024
  v_mfma_f32_16x16x32_bf16 v[248:251], a[12:15], v[136:139], 0
  ds_write_b128 v8, v[224:227] offset:2048
  v_mfma_f32_16x16x32_bf16 v[252:255], a[16:19], v[136:139], 0
  ds_write_b128 v8, v[228:231] offset:3072
  s_waitcnt vmcnt(13)
  v_mfma_f32_16x16x32_bf16 v[236:239], a[20:23], v[140:143], v[236:239]
  ds_write_b128 v8, v[232:235] offset:4096
  v_mfma_f32_16x16x32_bf16 v[240:243], a[24:27], v[140:143], v[240:243]
  v_mfma_f32_16x16x32_bf16 v[244:247], a[28:31], v[140:143], v[244:247]
  v_mfma_f32_16x16x32_bf16 v[248:251], a[32:35], v[140:143], v[248:251]
  v_mfma_f32_16x16x32_bf16 v[252:255], a[36:39], v[140:143], v[252:255]
  s_mul_i32 s84, s6, 15360
  s_waitcnt lgkmcnt(0)
  v_add_u32 v109, s84, v1
  s_barrier
  s_waitcnt vmcnt(12)
  v_mfma_f32_16x16x32_bf16 v[236:239], a[40:43], v[144:147], v[236:239]
  ds_read_b128 v[16:19], v109 offset:0
  ds_read_b128 v[20:23], v109 offset:1024
  v_mfma_f32_16x16x32_bf16 v[240:243], a[44:47], v[144:147], v[240:243]
  ds_read_b128 v[24:27], v109 offset:2048
  ds_read_b128 v[28:31], v109 offset:3072
  v_mfma_f32_16x16x32_bf16 v[244:247], a[48:51], v[144:147], v[244:247]
  ds_read_b128 v[32:35], v109 offset:4096
  ds_read_b128 v[36:39], v109 offset:5120
  v_mfma_f32_16x16x32_bf16 v[248:251], a[52:55], v[144:147], v[248:251]
  ds_read_b128 v[40:43], v109 offset:6144
  ds_read_b128 v[44:47], v109 offset:7168
  v_mfma_f32_16x16x32_bf16 v[252:255], a[56:59], v[144:147], v[252:255]
  ds_read_b128 v[48:51], v109 offset:8192
  ds_read_b128 v[52:55], v109 offset:9216
  s_waitcnt vmcnt(11)
  v_mfma_f32_16x16x32_bf16 v[236:239], a[60:63], v[148:151], v[236:239]
  ds_read_b128 v[56:59], v109 offset:10240
  ds_read_b128 v[60:63], v109 offset:11264
  v_mfma_f32_16x16x32_bf16 v[240:243], a[64:67], v[148:151], v[240:243]
  ds_read_b128 v[64:67], v109 offset:12288
  ds_read_b128 v[68:71], v109 offset:13312
  v_mfma_f32_16x16x32_bf16 v[244:247], a[68:71], v[148:151], v[244:247]
  ds_read_b128 v[72:75], v109 offset:14336
  v_mfma_f32_16x16x32_bf16 v[248:251], a[72:75], v[148:151], v[248:251]
  s_waitcnt lgkmcnt(14)
  v_mul_f32 v16, v14, v16
  v_mul_f32 v17, v14, v17
  v_mul_f32 v18, v14, v18
  v_mfma_f32_16x16x32_bf16 v[252:255], a[76:79], v[148:151], v[252:255]
  v_mul_f32 v19, v14, v19
  s_waitcnt lgkmcnt(13)
  v_mul_f32 v20, v14, v20
  v_mul_f32 v21, v14, v21
  s_waitcnt vmcnt(10)
  v_mfma_f32_16x16x32_bf16 v[236:239], a[80:83], v[152:155], v[236:239]
  v_mul_f32 v22, v14, v22
  v_mul_f32 v23, v14, v23
  s_waitcnt lgkmcnt(12)
  v_mul_f32 v24, v14, v24
  v_mfma_f32_16x16x32_bf16 v[240:243], a[84:87], v[152:155], v[240:243]
  v_mul_f32 v25, v14, v25
  v_mul_f32 v26, v14, v26
  v_mul_f32 v27, v14, v27
  v_mfma_f32_16x16x32_bf16 v[244:247], a[88:91], v[152:155], v[244:247]
  s_waitcnt lgkmcnt(11)
  v_mul_f32 v28, v14, v28
  v_mul_f32 v29, v14, v29
  v_mul_f32 v30, v14, v30
  v_mfma_f32_16x16x32_bf16 v[248:251], a[92:95], v[152:155], v[248:251]
  v_mul_f32 v31, v14, v31
  s_waitcnt lgkmcnt(10)
  v_mul_f32 v32, v14, v32
  v_mul_f32 v33, v14, v33
  v_mfma_f32_16x16x32_bf16 v[252:255], a[96:99], v[152:155], v[252:255]
  v_mul_f32 v34, v14, v34
  v_mul_f32 v35, v14, v35
  s_waitcnt lgkmcnt(9)
  v_fma_f32 v16, v36, v14, v16
  s_waitcnt vmcnt(9)
  v_mfma_f32_16x16x32_bf16 v[236:239], a[100:103], v[156:159], v[236:239]
  v_fma_f32 v17, v37, v14, v17
  v_fma_f32 v18, v38, v14, v18
  v_fma_f32 v19, v39, v14, v19
  v_mfma_f32_16x16x32_bf16 v[240:243], a[104:107], v[156:159], v[240:243]
  s_waitcnt lgkmcnt(8)
  v_fma_f32 v20, v40, v14, v20
  v_fma_f32 v21, v41, v14, v21
  v_fma_f32 v22, v42, v14, v22
  v_mfma_f32_16x16x32_bf16 v[244:247], a[108:111], v[156:159], v[244:247]
  v_fma_f32 v23, v43, v14, v23
  s_waitcnt lgkmcnt(7)
  v_fma_f32 v24, v44, v14, v24
  v_fma_f32 v25, v45, v14, v25
  v_mfma_f32_16x16x32_bf16 v[248:251], a[112:115], v[156:159], v[248:251]
  v_fma_f32 v26, v46, v14, v26
  v_fma_f32 v27, v47, v14, v27
  s_waitcnt lgkmcnt(6)
  v_fma_f32 v28, v48, v14, v28
  v_mfma_f32_16x16x32_bf16 v[252:255], a[116:119], v[156:159], v[252:255]
  v_fma_f32 v29, v49, v14, v29
  v_fma_f32 v30, v50, v14, v30
  v_fma_f32 v31, v51, v14, v31
  s_waitcnt vmcnt(8)
  v_mfma_f32_16x16x32_bf16 v[236:239], a[120:123], v[160:163], v[236:239]
  s_waitcnt lgkmcnt(5)
  v_fma_f32 v32, v52, v14, v32
  v_fma_f32 v33, v53, v14, v33
  v_fma_f32 v34, v54, v14, v34
  v_mfma_f32_16x16x32_bf16 v[240:243], a[124:127], v[160:163], v[240:243]
  v_fma_f32 v35, v55, v14, v35
  s_waitcnt lgkmcnt(4)
  v_fma_f32 v16, v56, v14, v16
  v_fma_f32 v17, v57, v14, v17
  v_mfma_f32_16x16x32_bf16 v[244:247], a[128:131], v[160:163], v[244:247]
  v_fma_f32 v18, v58, v14, v18
  v_fma_f32 v19, v59, v14, v19
  s_waitcnt lgkmcnt(3)
  v_fma_f32 v20, v60, v14, v20
  v_mfma_f32_16x16x32_bf16 v[248:251], a[132:135], v[160:163], v[248:251]
  v_fma_f32 v21, v61, v14, v21
  v_fma_f32 v22, v62, v14, v22
  v_fma_f32 v23, v63, v14, v23
  v_mfma_f32_16x16x32_bf16 v[252:255], a[136:139], v[160:163], v[252:255]
  s_waitcnt lgkmcnt(2)
  v_fma_f32 v24, v64, v14, v24
  v_fma_f32 v25, v65, v14, v25
  v_fma_f32 v26, v66, v14, v26
  s_waitcnt vmcnt(7)
  v_mfma_f32_16x16x32_bf16 v[236:239], a[140:143], v[164:167], v[236:239]
  v_fma_f32 v27, v67, v14, v27
  s_waitcnt lgkmcnt(1)
  v_fma_f32 v28, v68, v14, v28
  v_fma_f32 v29, v69, v14, v29
  v_mfma_f32_16x16x32_bf16 v[240:243], a[144:147], v[164:167], v[240:243]
  v_fma_f32 v30, v70, v14, v30
  v_fma_f32 v31, v71, v14, v31
  s_waitcnt lgkmcnt(0)
  v_fma_f32 v32, v72, v14, v32
  v_mfma_f32_16x16x32_bf16 v[244:247], a[148:151], v[164:167], v[244:247]
  v_fma_f32 v33, v73, v14, v33
  v_fma_f32 v34, v74, v14, v34
  v_fma_f32 v35, v75, v14, v35
  v_mfma_f32_16x16x32_bf16 v[248:251], a[152:155], v[164:167], v[248:251]
  s_waitcnt vmcnt(0)
  v_bitop3_b32 v179, v177, v179, v6 bitop3:0x7e
  v_bitop3_b32 v183, v181, v183, v6 bitop3:0x7e
  v_bitop3_b32 v187, v185, v187, v6 bitop3:0x7e
  v_mfma_f32_16x16x32_bf16 v[252:255], a[156:159], v[164:167], v[252:255]
  v_bitop3_b32 v191, v189, v191, v6 bitop3:0x7e
  v_bitop3_b32 v195, v193, v195, v6 bitop3:0x7e
  v_or3_b32 v4, v179, v183, v187
  s_waitcnt vmcnt(6)
  v_mfma_f32_16x16x32_bf16 v[236:239], a[160:163], v[168:171], v[236:239]
  v_or3_b32 v4, v4, v191, v195
  v_cmp_ne_u32 vcc, 0, v4
  s_cbranch_vccnz L_spin_Yb3
L_ret_Yb3:
  v_mov_b32 v177, v178
  v_mfma_f32_16x16x32_bf16 v[240:243], a[164:167], v[168:171], v[240:243]
  ds_write_b64 v10, v[176:177] offset:0
  v_mov_b32 v181, v182
  ds_write_b64 v10, v[180:181] offset:512
  v_mfma_f32_16x16x32_bf16 v[244:247], a[168:171], v[168:171], v[244:247]
  v_mov_b32 v185, v186
  ds_write_b64 v10, v[184:185] offset:1024
  v_mov_b32 v189, v190
  v_mfma_f32_16x16x32_bf16 v[248:251], a[172:175], v[168:171], v[248:251]
  ds_write_b64 v10, v[188:189] offset:1536
  v_mov_b32 v193, v194
  ds_write_b64 v10, v[192:193] offset:2048
  v_mfma_f32_16x16x32_bf16 v[252:255], a[176:179], v[168:171], v[252:255]
  ds_read_b64_tr_b16 v[96:97], v10 offset:0
  ds_read_b64_tr_b16 v[98:99], v10 offset:512
  ds_read_b64_tr_b16 v[100:101], v10 offset:1024
  s_waitcnt vmcnt(5)
  v_mfma_f32_16x16x32_bf16 v[236:239], a[180:183], v[172:175], v[236:239]
  ds_read_b64_tr_b16 v[102:103], v10 offset:1536
  ds_read_b64_tr_b16 v[104:105], v10 offset:2048
  s_waitcnt lgkmcnt(4)
  v_lshlrev_b32 v176, 16, v96
  v_mfma_f32_16x16x32_bf16 v[240:243], a[184:187], v[172:175], v[240:243]
  v_and_b32 v177, 0xffff0000, v96
  v_fma_f32 v16, v176, v196, v16
  v_fma_f32 v17, v177, v197, v17
  v_mfma_f32_16x16x32_bf16 v[244:247], a[188:191], v[172:175], v[244:247]
  v_lshlrev_b32 v178, 16, v97
  v_and_b32 v179, 0xffff0000, v97
  v_fma_f32 v18, v178, v198, v18
  v_mfma_f32_16x16x32_bf16 v[248:251], a[192:195], v[172:175], v[248:251]
  v_fma_f32 v19, v179, v199, v19
  s_waitcnt lgkmcnt(3)
  v_lshlrev_b32 v180, 16, v98
  v_and_b32 v181, 0xffff0000, v98
  v_mfma_f32_16x16x32_bf16 v[252:255], a[196:199], v[172:175], v[252:255]
  v_fma_f32 v20, v180, v200, v20
  v_fma_f32 v21, v181, v201, v21
  v_lshlrev_b32 v182, 16, v99
  v_and_b32 v183, 0xffff0000, v99
  v_fma_f32 v22, v182, v202, v22
  v_fma_f32 v23, v183, v203, v23
  s_waitcnt lgkmcnt(2)
  v_lshlrev_b32 v184, 16, v100
  v_and_b32 v185, 0xffff0000, v100
  v_fma_f32 v24, v184, v204, v24
  v_fma_f32 v25, v185, v205, v25
  v_lshlrev_b32 v186, 16, v101
  v_and_b32 v187, 0xffff0000, v101
  v_fma_f32 v26, v186, v206, v26
  v_fma_f32 v27, v187, v207, v27
  s_waitcnt lgkmcnt(1)
  v_lshlrev_b32 v188, 16, v102
  v_and_b32 v189, 0xffff0000, v102
  v_fma_f32 v28, v188, v208, v28
  v_fma_f32 v29, v189, v209, v29
  v_lshlrev_b32 v190, 16, v103
  v_and_b32 v191, 0xffff0000, v103
  v_fma_f32 v30, v190, v210, v30
  v_fma_f32 v31, v191, v211, v31
  s_waitcnt lgkmcnt(0)
  v_lshlrev_b32 v192, 16, v104
  v_and_b32 v193, 0xffff0000, v104
  v_fma_f32 v32, v192, v212, v32
  v_fma_f32 v33, v193, v213, v33
  v_lshlrev_b32 v194, 16, v105
  v_and_b32 v195, 0xffff0000, v105
  v_fma_f32 v34, v194, v214, v34
  v_fma_f32 v35, v195, v215, v35
  v_pk_fma_f32 v[16:17], v[236:237], v[14:15], v[16:17]
  v_pk_fma_f32 v[18:19], v[238:239], v[14:15], v[18:19]
  v_cvt_pk_bf16_f32 v96, v16, v17
  v_cvt_pk_bf16_f32 v97, v18, v19
  ds_write_b64 v11, v[96:97] offset:0
  v_pk_fma_f32 v[20:21], v[240:241], v[14:15], v[20:21]
  v_pk_fma_f32 v[22:23], v[242:243], v[14:15], v[22:23]
  v_cvt_pk_bf16_f32 v98, v20, v21
  v_cvt_pk_bf16_f32 v99, v22, v23
  ds_write_b64 v11, v[98:99] offset:32
  v_pk_fma_f32 v[24:25], v[244:245], v[14:15], v[24:25]
  v_pk_fma_f32 v[26:27], v[246:247], v[14:15], v[26:27]
  v_cvt_pk_bf16_f32 v100, v24, v25
  v_cvt_pk_bf16_f32 v101, v26, v27
  ds_write_b64 v11, v[100:101] offset:64
  v_pk_fma_f32 v[28:29], v[248:249], v[14:15], v[28:29]
  v_pk_fma_f32 v[30:31], v[250:251], v[14:15], v[30:31]
  v_cvt_pk_bf16_f32 v102, v28, v29
  v_cvt_pk_bf16_f32 v103, v30, v31
  ds_write_b64 v11, v[102:103] offset:96
  v_pk_fma_f32 v[32:33], v[252:253], v[14:15], v[32:33]
  v_pk_fma_f32 v[34:35], v[254:255], v[14:15], v[34:35]
  v_cvt_pk_bf16_f32 v104, v32, v33
  v_cvt_pk_bf16_f32 v105, v34, v35
  ds_write_b64 v11, v[104:105] offset:128
  v_add_u32 v8, s87, v1
  ds_read_b128 v[116:119], v8 offset:0
  ds_read_b128 v[120:123], v8 offset:640
  ds_read_b128 v[124:127], v8 offset:5120
  ds_read_b128 v[128:131], v8 offset:5760
  s_mov_b32 exec_lo, -1
  s_mov_b32 exec_hi, 0xff
  s_waitcnt lgkmcnt(3)
  s_mov_b32 s82, 0
  buffer_store_dwordx4 v[116:119], v2, s[40:43], s82 offen sc1
  s_waitcnt lgkmcnt(2)
  s_mov_b32 s82, 5120
  buffer_store_dwordx4 v[120:123], v2, s[40:43], s82 offen sc1
  s_waitcnt lgkmcnt(1)
  s_mov_b32 s82, 40960
  buffer_store_dwordx4 v[124:127], v2, s[40:43], s82 offen sc1
  s_waitcnt lgkmcnt(0)
  s_mov_b32 s82, 46080
  buffer_store_dwordx4 v[128:131], v2, s[40:43], s82 offen sc1
  s_or_b32 s84, s4, s6
  s_cmp_lg_u32 s84, 0
  s_cbranch_scc1 L_noecb3
  s_lshl_b32 s84, s5, 7
  s_add_u32 s84, s84, 16138240
  s_mov_b64 exec, 1
  buffer_store_dword v6, off, s[44:47], s84 sc1
  s_mov_b64 exec, -1
L_noecb3:
  s_or_b32 s84, s5, s6
  s_cmp_lg_u32 s84, 0
  s_cbranch_scc1 L_noerb3
  s_lshl_b32 s84, s4, 7
  s_add_u32 s84, s84, 16139264
  s_mov_b64 exec, 1
  buffer_store_dword v7, off, s[44:47], s84 sc1
  s_mov_b64 exec, -1
L_noerb3:
  s_endpgm
.p2align 12
L_b2:
L_st4:
  s_cbranch_execz L_hb2
  s_nop 7
  s_nop 3
  s_waitcnt vmcnt(8)
  v_cmp_ne_u32 vcc, s60, v5
  s_cbranch_vccnz L_spin_Ab2
L_ret_Ab2:
  s_barrier
  s_add_u32 s84, s70, 2
  s_add_u32 m0, s69, 0
  s_nop 0
  buffer_load_dwordx4 v1, s[44:47], s70 offen offset:0 sc1 lds
  v_mfma_f32_16x16x32_bf16 v[16:19], v[88:91], v[120:123], v[16:19]
  ds_read_b128 v[112:115], v248 offset:0
  ds_read_b128 v[116:119], v249 offset:0
  v_mfma_f32_16x16x32_bf16 v[40:43], v[88:91], v[124:127], v[40:43]
  ds_read_b64_tr_b16 v[64:65], v242 offset:0
  ds_read_b64_tr_b16 v[66:67], v242 offset:1536
  v_mfma_f32_16x16x32_bf16 v[20:23], v[92:95], v[120:123], v[20:23]
  ds_read_b64_tr_b16 v[68:69], v243 offset:0
  ds_read_b64_tr_b16 v[70:71], v243 offset:1536
  v_mfma_f32_16x16x32_bf16 v[44:47], v[92:95], v[124:127], v[44:47]
  ds_read_b64_tr_b16 v[72:73], v244 offset:0
  ds_read_b64_tr_b16 v[74:75], v244 offset:1536
  buffer_load_dwordx4 v1, s[44:47], s70 offen offset:1024 sc1 lds
  v_mfma_f32_16x16x32_bf16 v[24:27], v[96:99], v[120:123], v[24:27]
  ds_read_b64_tr_b16 v[76:77], v245 offset:0
  ds_read_b64_tr_b16 v[78:79], v245 offset:1536
  v_mfma_f32_16x16x32_bf16 v[48:51], v[96:99], v[124:127], v[48:51]
  ds_read_b64_tr_b16 v[80:81], v246 offset:0
  ds_read_b64_tr_b16 v[82:83], v246 offset:1536
  v_mfma_f32_16x16x32_bf16 v[28:31], v[100:103], v[120:123], v[28:31]
  ds_read_b64_tr_b16 v[84:85], v247 offset:0
  ds_read_b64_tr_b16 v[86:87], v247 offset:1536
  v_mfma_f32_16x16x32_bf16 v[52:55], v[100:103], v[124:127], v[52:55]
  ds_read_b128 v[128:131], v252 offset:1024
  buffer_load_dwordx4 v1, s[44:47], s70 offen offset:2048 sc1 lds
  v_mfma_f32_16x16x32_bf16 v[32:35], v[104:107], v[120:123], v[32:35]
  v_mfma_f32_16x16x32_bf16 v[56:59], v[104:107], v[124:127], v[56:59]
  v_mfma_f32_16x16x32_bf16 v[36:39], v[108:111], v[120:123], v[36:39]
  v_mfma_f32_16x16x32_bf16 v[60:63], v[108:111], v[124:127], v[60:63]
  v_mfma_f32_16x16x32_bf16 v[12:15], v[132:135], v[120:123], v[12:15]
  s_waitcnt lgkmcnt(0)
  buffer_load_dwordx4 v1, s[44:47], s70 offen offset:3072 sc1 lds
  v_mfma_f32_16x16x32_bf16 v[16:19], v[64:67], v[112:115], v[16:19]
  ds_read_b128 v[120:123], v250 offset:0
  ds_read_b128 v[124:127], v251 offset:0
  v_mfma_f32_16x16x32_bf16 v[40:43], v[64:67], v[116:119], v[40:43]
  ds_read_b64_tr_b16 v[88:89], v242 offset:12288
  ds_read_b64_tr_b16 v[90:91], v242 offset:13824
  v_mfma_f32_16x16x32_bf16 v[20:23], v[68:71], v[112:115], v[20:23]
  ds_read_b64_tr_b16 v[92:93], v243 offset:12288
  ds_read_b64_tr_b16 v[94:95], v243 offset:13824
  v_mfma_f32_16x16x32_bf16 v[44:47], v[68:71], v[116:119], v[44:47]
  ds_read_b64_tr_b16 v[96:97], v244 offset:12288
  ds_read_b64_tr_b16 v[98:99], v244 offset:13824
  s_add_u32 m0, s69, 13440
  s_add_u32 s74, s70, 4
  s_mov_b64 exec, s[62:63]
  buffer_load_dwordx4 v1, s[24:27], s74 offen offset:0 lds
  buffer_load_dwordx4 v1, s[24:27], s74 offen offset:1024 lds
  s_mov_b64 exec, -1
  v_mfma_f32_16x16x32_bf16 v[24:27], v[72:75], v[112:115], v[24:27]
  ds_read_b64_tr_b16 v[100:101], v245 offset:12288
  ds_read_b64_tr_b16 v[102:103], v245 offset:13824
  v_mfma_f32_16x16x32_bf16 v[48:51], v[72:75], v[116:119], v[48:51]
  ds_read_b64_tr_b16 v[104:105], v246 offset:12288
  ds_read_b64_tr_b16 v[106:107], v246 offset:13824
  v_mfma_f32_16x16x32_bf16 v[28:31], v[76:79], v[112:115], v[28:31]
  ds_read_b64_tr_b16 v[108:109], v247 offset:12288
  ds_read_b64_tr_b16 v[110:111], v247 offset:13824
  v_mfma_f32_16x16x32_bf16 v[52:55], v[76:79], v[116:119], v[52:55]
  ds_read_b128 v[132:135], v252 offset:1088
  s_add_u32 m0, s69, 13440
  s_add_u32 s74, s70, 4
  s_mov_b64 exec, s[62:63]
  buffer_load_dwordx4 v1, s[24:27], s74 offen offset:2048 lds
  buffer_load_dwordx4 v1, s[24:27], s74 offen offset:3072 lds
  s_mov_b64 exec, -1
  v_mfma_f32_16x16x32_bf16 v[32:35], v[80:83], v[112:115], v[32:35]
  v_mfma_f32_16x16x32_bf16 v[56:59], v[80:83], v[116:119], v[56:59]
  v_mfma_f32_16x16x32_bf16 v[36:39], v[84:87], v[112:115], v[36:39]
  v_mfma_f32_16x16x32_bf16 v[60:63], v[84:87], v[116:119], v[60:63]
  v_mfma_f32_16x16x32_bf16 v[12:15], v[128:131], v[112:115], v[12:15]
  s_waitcnt lgkmcnt(0)
  s_waitcnt vmcnt(8)
  s_barrier
  buffer_load_dwordx4 a[0:3], v1, s[44:47], s71 offen offset:0 sc1
  v_mfma_f32_16x16x32_bf16 v[16:19], v[88:91], v[120:123], v[16:19]
  ds_read_b128 v[112:115], v238 offset:0
  ds_read_b128 v[116:119], v239 offset:0
  v_mfma_f32_16x16x32_bf16 v[40:43], v[88:91], v[124:127], v[40:43]
  ds_read_b64_tr_b16 v[64:65], v232 offset:0
  ds_read_b64_tr_b16 v[66:67], v232 offset:1536
  buffer_load_dwordx4 a[4:7], v1, s[44:47], s71 offen offset:1024 sc1
  v_mfma_f32_16x16x32_bf16 v[20:23], v[92:95], v[120:123], v[20:23]
  ds_read_b64_tr_b16 v[68:69], v233 offset:0
  ds_read_b64_tr_b16 v[70:71], v233 offset:1536
  v_mfma_f32_16x16x32_bf16 v[44:47], v[92:95], v[124:127], v[44:47]
  ds_read_b64_tr_b16 v[72:73], v234 offset:0
  ds_read_b64_tr_b16 v[74:75], v234 offset:1536
  v_mfma_f32_16x16x32_bf16 v[24:27], v[96:99], v[120:123], v[24:27]
  ds_read_b64_tr_b16 v[76:77], v235 offset:0
  ds_read_b64_tr_b16 v[78:79], v235 offset:1536
  buffer_load_dwordx4 a[8:11], v1, s[44:47], s71 offen offset:2048 sc1
  v_mfma_f32_16x16x32_bf16 v[48:51], v[96:99], v[124:127], v[48:51]
  ds_read_b64_tr_b16 v[80:81], v236 offset:0
  ds_read_b64_tr_b16 v[82:83], v236 offset:1536
  v_mfma_f32_16x16x32_bf16 v[28:31], v[100:103], v[120:123], v[28:31]
  ds_read_b64_tr_b16 v[84:85], v237 offset:0
  ds_read_b64_tr_b16 v[86:87], v237 offset:1536
  buffer_load_dwordx4 a[12:15], v1, s[44:47], s71 offen offset:3072 sc1
  v_mfma_f32_16x16x32_bf16 v[52:55], v[100:103], v[124:127], v[52:55]
  ds_read_b128 v[128:131], v252 offset:1152
  v_mfma_f32_16x16x32_bf16 v[32:35], v[104:107], v[120:123], v[32:35]
  v_mfma_f32_16x16x32_bf16 v[56:59], v[104:107], v[124:127], v[56:59]
  s_add_u32 s74, s71, 4096
  s_add_u32 s71, s71, 5120
  buffer_load_dwordx4 a[16:19], v1, s[44:47], s74 offen sc1
  s_cmp_ge_u32 s71, s73
  s_cselect_b32 s74, 245760, 0
  s_sub_u32 s71, s71, s74
  v_mfma_f32_16x16x32_bf16 v[36:39], v[108:111], v[120:123], v[36:39]
  v_mfma_f32_16x16x32_bf16 v[60:63], v[108:111], v[124:127], v[60:63]
  v_mfma_f32_16x16x32_bf16 v[12:15], v[132:135], v[120:123], v[12:15]
  s_waitcnt lgkmcnt(0)
  buffer_load_dwordx4 a[20:23], v1, s[44:47], s71 offen offset:0 sc1
  v_mfma_f32_16x16x32_bf16 v[16:19], v[64:67], v[112:115], v[16:19]
  ds_read_b128 v[120:123], v240 offset:0
  ds_read_b128 v[124:127], v241 offset:0
  v_mfma_f32_16x16x32_bf16 v[40:43], v[64:67], v[116:119], v[40:43]
  ds_read_b64_tr_b16 v[88:89], v232 offset:12288
  ds_read_b64_tr_b16 v[90:91], v232 offset:13824
  buffer_load_dwordx4 a[24:27], v1, s[44:47], s71 offen offset:1024 sc1
  v_mfma_f32_16x16x32_bf16 v[20:23], v[68:71], v[112:115], v[20:23]
  ds_read_b64_tr_b16 v[92:93], v233 offset:12288
  ds_read_b64_tr_b16 v[94:95], v233 offset:13824
  v_mfma_f32_16x16x32_bf16 v[44:47], v[68:71], v[116:119], v[44:47]
  ds_read_b64_tr_b16 v[96:97], v234 offset:12288
  ds_read_b64_tr_b16 v[98:99], v234 offset:13824
  v_mfma_f32_16x16x32_bf16 v[24:27], v[72:75], v[112:115], v[24:27]
  ds_read_b64_tr_b16 v[100:101], v235 offset:12288
  ds_read_b64_tr_b16 v[102:103], v235 offset:13824
  buffer_load_dwordx4 a[28:31], v1, s[44:47], s71 offen offset:2048 sc1
  v_mfma_f32_16x16x32_bf16 v[48:51], v[72:75], v[116:119], v[48:51]
  ds_read_b64_tr_b16 v[104:105], v236 offset:12288
  ds_read_b64_tr_b16 v[106:107], v236 offset:13824
  v_mfma_f32_16x16x32_bf16 v[28:31], v[76:79], v[112:115], v[28:31]
  ds_read_b64_tr_b16 v[108:109], v237 offset:12288
  ds_read_b64_tr_b16 v[110:111], v237 offset:13824
  buffer_load_dwordx4 a[32:35], v1, s[44:47], s71 offen offset:3072 sc1
  v_mfma_f32_16x16x32_bf16 v[52:55], v[76:79], v[116:119], v[52:55]
  ds_read_b128 v[132:135], v252 offset:1216
  v_mfma_f32_16x16x32_bf16 v[32:35], v[80:83], v[112:115], v[32:35]
  v_mfma_f32_16x16x32_bf16 v[56:59], v[80:83], v[116:119], v[56:59]
  s_add_u32 s74, s71, 4096
  s_add_u32 s71, s71, 5120
  buffer_load_dwordx4 a[36:39], v1, s[44:47], s74 offen sc1
  s_cmp_ge_u32 s71, s73
  s_cselect_b32 s74, 245760, 0
  s_sub_u32 s71, s71, s74
  v_mfma_f32_16x16x32_bf16 v[36:39], v[84:87], v[112:115], v[36:39]
  v_mfma_f32_16x16x32_bf16 v[60:63], v[84:87], v[116:119], v[60:63]
  v_mfma_f32_16x16x32_bf16 v[12:15], v[128:131], v[112:115], v[12:15]
  s_waitcnt lgkmcnt(0)
  s_barrier
  v_mul_u32_u24 v136, 205, v0
  v_lshrrev_b32 v136, 11, v136
  v_mul_u32_u24 v137, 10, v136
  v_mfma_f32_16x16x32_bf16 v[16:19], v[88:91], v[120:123], v[16:19]
  v_sub_u32 v137, v0, v137
  v_mul_u32_u24 v136, 1280, v136
  v_lshl_add_u32 v136, v137, 4, v136
  v_mfma_f32_16x16x32_bf16 v[40:43], v[88:91], v[124:127], v[40:43]
  s_mul_i32 s80, s4, 81920
  s_mul_i32 s81, s5, 160
  s_add_u32 s80, s80, s81
  s_mul_i32 s81, s6, 10240
  s_add_u32 s80, s80, s81
  v_mfma_f32_16x16x32_bf16 v[20:23], v[92:95], v[120:123], v[20:23]
  v_add_u32 v2, s80, v136
  s_mul_i32 s87, s6, 1280
  s_add_u32 s87, s87, 153472
  v_mfma_f32_16x16x32_bf16 v[44:47], v[92:95], v[124:127], v[44:47]
  s_mov_b32 exec_lo, -1
  s_mov_b32 exec_hi, 0xff
  s_add_u32 m0, s87, 0
  s_mov_b32 s82, 0
  buffer_load_dwordx4 v2, s[8:11], s82 offen lds
  s_mov_b64 exec, -1
  v_mfma_f32_16x16x32_bf16 v[24:27], v[96:99], v[120:123], v[24:27]
  s_mov_b32 exec_lo, -1
  s_mov_b32 exec_hi, 0xff
  s_add_u32 m0, s87, 640
  s_mov_b32 s82, 5120
  buffer_load_dwordx4 v2, s[8:11], s82 offen lds
  s_mov_b64 exec, -1
  v_mfma_f32_16x16x32_bf16 v[48:51], v[96:99], v[124:127], v[48:51]
  s_mov_b32 exec_lo, -1
  s_mov_b32 exec_hi, 0xff
  s_add_u32 m0, s87, 5120
  s_mov_b32 s82, 40960
  buffer_load_dwordx4 v2, s[8:11], s82 offen lds
  s_mov_b64 exec, -1
  v_mfma_f32_16x16x32_bf16 v[28:31], v[100:103], v[120:123], v[28:31]
  s_mov_b32 exec_lo, -1
  s_mov_b32 exec_hi, 0xff
  s_add_u32 m0, s87, 5760
  s_mov_b32 s82, 46080
  buffer_load_dwordx4 v2, s[8:11], s82 offen lds
  s_mov_b64 exec, -1
  v_mfma_f32_16x16x32_bf16 v[52:55], v[100:103], v[124:127], v[52:55]
  s_add_u32 s76, s6, 1
  s_and_b32 s76, s76, 3
  s_lshl_b32 s76, s76, 10
  v_mfma_f32_16x16x32_bf16 v[32:35], v[104:107], v[120:123], v[32:35]
  s_add_u32 s77, s6, 2
  s_and_b32 s77, s77, 3
  s_lshl_b32 s77, s77, 10
  v_mfma_f32_16x16x32_bf16 v[56:59], v[104:107], v[124:127], v[56:59]
  s_add_u32 s78, s6, 3
  s_and_b32 s78, s78, 3
  s_lshl_b32 s78, s78, 10
  v_mfma_f32_16x16x32_bf16 v[36:39], v[108:111], v[120:123], v[36:39]
  s_add_u32 s79, s6, 4
  s_and_b32 s79, s79, 3
  s_lshl_b32 s79, s79, 10
  v_mfma_f32_16x16x32_bf16 v[60:63], v[108:111], v[124:127], v[60:63]
  v_mfma_f32_16x16x32_bf16 v[12:15], v[132:135], v[120:123], v[12:15]
  s_mov_b32 s80, 0xbfb8aa3b
  s_mov_b32 s81, 0xbfb8aa3b
  s_mov_b32 s82, 1.0
  s_mov_b32 s83, 1.0
  s_and_b32 s85, s6, 1
  s_mul_i32 s85, s85, 12288
  s_add_u32 s85, s85, 73728
  s_add_u32 s84, s85, s79
  v_pk_mul_f32 v[64:65], v[16:17], s[80:81]
  v_pk_mul_f32 v[66:67], v[18:19], s[80:81]
  v_pk_mul_f32 v[68:69], v[20:21], s[80:81]
  v_pk_mul_f32 v[70:71], v[22:23], s[80:81]
  v_exp_f32 v64, v64
  v_exp_f32 v65, v65
  v_exp_f32 v66, v66
  v_exp_f32 v67, v67
  v_exp_f32 v68, v68
  v_exp_f32 v69, v69
  v_exp_f32 v70, v70
  v_exp_f32 v71, v71
  v_add_u32 v96, s84, v1
  v_xor_b32 v97, 1024, v96
  v_pk_add_f32 v[64:65], v[64:65], s[82:83]
  v_pk_add_f32 v[66:67], v[66:67], s[82:83]
  v_pk_add_f32 v[68:69], v[68:69], s[82:83]
  v_pk_add_f32 v[70:71], v[70:71], s[82:83]
  v_rcp_f32 v64, v64
  v_rcp_f32 v65, v65
  v_rcp_f32 v66, v66
  v_rcp_f32 v67, v67
  v_rcp_f32 v68, v68
  v_rcp_f32 v69, v69
  v_rcp_f32 v70, v70
  v_rcp_f32 v71, v71
  v_pk_mul_f32 v[64:65], v[64:65], v[16:17]
  v_pk_mul_f32 v[66:67], v[66:67], v[18:19]
  v_pk_mul_f32 v[68:69], v[68:69], v[20:21]
  v_pk_mul_f32 v[70:71], v[70:71], v[22:23]
  v_cvt_pk_bf16_f32 v72, v64, v65
  v_cvt_pk_bf16_f32 v73, v66, v67
  v_cvt_pk_bf16_f32 v74, v68, v69
  v_cvt_pk_bf16_f32 v75, v70, v71
  s_add_u32 s75, s97, 0
  buffer_store_dwordx4 v[72:75], v1, s[44:47], s75 offen sc1
  ds_write_b128 v96, v[72:75] offset:0
  v_pk_mul_f32 v[80:81], v[40:41], s[80:81]
  v_pk_mul_f32 v[82:83], v[42:43], s[80:81]
  v_pk_mul_f32 v[84:85], v[44:45], s[80:81]
  v_pk_mul_f32 v[86:87], v[46:47], s[80:81]
  v_exp_f32 v80, v80
  v_exp_f32 v81, v81
  v_exp_f32 v82, v82
  v_exp_f32 v83, v83
  v_exp_f32 v84, v84
  v_exp_f32 v85, v85
  v_exp_f32 v86, v86
  v_exp_f32 v87, v87
  v_add_u32 v92, 1024, v11
  v_add_u32 v93, 2048, v11
  v_add_u32 v94, 3072, v11
  v_pk_add_f32 v[80:81], v[80:81], s[82:83]
  v_pk_add_f32 v[82:83], v[82:83], s[82:83]
  v_pk_add_f32 v[84:85], v[84:85], s[82:83]
  v_pk_add_f32 v[86:87], v[86:87], s[82:83]
  v_rcp_f32 v80, v80
  v_rcp_f32 v81, v81
  v_rcp_f32 v82, v82
  v_rcp_f32 v83, v83
  v_rcp_f32 v84, v84
  v_rcp_f32 v85, v85
  v_rcp_f32 v86, v86
  v_rcp_f32 v87, v87
  v_pk_mul_f32 v[80:81], v[80:81], v[40:41]
  v_pk_mul_f32 v[82:83], v[82:83], v[42:43]
  v_pk_mul_f32 v[84:85], v[84:85], v[44:45]
  v_pk_mul_f32 v[86:87], v[86:87], v[46:47]
  v_cvt_pk_bf16_f32 v88, v80, v81
  v_cvt_pk_bf16_f32 v89, v82, v83
  v_cvt_pk_bf16_f32 v90, v84, v85
  v_cvt_pk_bf16_f32 v91, v86, v87
  s_add_u32 s75, s98, 0
  buffer_store_dwordx4 v[88:91], v1, s[44:47], s75 offen sc1
  ds_write_b128 v97, v[88:91] offset:0
  v_pk_mul_f32 v[64:65], v[24:25], s[80:81]
  v_pk_mul_f32 v[66:67], v[26:27], s[80:81]
  v_pk_mul_f32 v[68:69], v[28:29], s[80:81]
  v_pk_mul_f32 v[70:71], v[30:31], s[80:81]
  v_exp_f32 v64, v64
  v_exp_f32 v65, v65
  v_exp_f32 v66, v66
  v_exp_f32 v67, v67
  v_exp_f32 v68, v68
  v_exp_f32 v69, v69
  v_exp_f32 v70, v70
  v_exp_f32 v71, v71
  v_pk_add_f32 v[64:65], v[64:65], s[82:83]
  v_pk_add_f32 v[66:67], v[66:67], s[82:83]
  v_pk_add_f32 v[68:69], v[68:69], s[82:83]
  v_pk_add_f32 v[70:71], v[70:71], s[82:83]
  v_rcp_f32 v64, v64
  v_rcp_f32 v65, v65
  v_rcp_f32 v66, v66
  v_rcp_f32 v67, v67
  v_rcp_f32 v68, v68
  v_rcp_f32 v69, v69
  v_rcp_f32 v70, v70
  v_rcp_f32 v71, v71
  v_pk_mul_f32 v[64:65], v[64:65], v[24:25]
  v_pk_mul_f32 v[66:67], v[66:67], v[26:27]
  v_pk_mul_f32 v[68:69], v[68:69], v[28:29]
  v_pk_mul_f32 v[70:71], v[70:71], v[30:31]
  v_cvt_pk_bf16_f32 v72, v64, v65
  v_cvt_pk_bf16_f32 v73, v66, v67
  v_cvt_pk_bf16_f32 v74, v68, v69
  v_cvt_pk_bf16_f32 v75, v70, v71
  s_add_u32 s75, s97, 4096
  buffer_store_dwordx4 v[72:75], v1, s[44:47], s75 offen sc1
  ds_write_b128 v96, v[72:75] offset:4096
  v_pk_mul_f32 v[80:81], v[48:49], s[80:81]
  v_pk_mul_f32 v[82:83], v[50:51], s[80:81]
  v_pk_mul_f32 v[84:85], v[52:53], s[80:81]
  v_pk_mul_f32 v[86:87], v[54:55], s[80:81]
  v_exp_f32 v80, v80
  v_exp_f32 v81, v81
  v_exp_f32 v82, v82
  v_exp_f32 v83, v83
  v_exp_f32 v84, v84
  v_exp_f32 v85, v85
  v_exp_f32 v86, v86
  v_exp_f32 v87, v87
  v_pk_add_f32 v[80:81], v[80:81], s[82:83]
  v_pk_add_f32 v[82:83], v[82:83], s[82:83]
  v_pk_add_f32 v[84:85], v[84:85], s[82:83]
  v_pk_add_f32 v[86:87], v[86:87], s[82:83]
  v_rcp_f32 v80, v80
  v_rcp_f32 v81, v81
  v_rcp_f32 v82, v82
  v_rcp_f32 v83, v83
  v_rcp_f32 v84, v84
  v_rcp_f32 v85, v85
  v_rcp_f32 v86, v86
  v_rcp_f32 v87, v87
  v_pk_mul_f32 v[80:81], v[80:81], v[48:49]
  v_pk_mul_f32 v[82:83], v[82:83], v[50:51]
  v_pk_mul_f32 v[84:85], v[84:85], v[52:53]
  v_pk_mul_f32 v[86:87], v[86:87], v[54:55]
  v_cvt_pk_bf16_f32 v88, v80, v81
  v_cvt_pk_bf16_f32 v89, v82, v83
  v_cvt_pk_bf16_f32 v90, v84, v85
  v_cvt_pk_bf16_f32 v91, v86, v87
  s_add_u32 s75, s98, 4096
  buffer_store_dwordx4 v[88:91], v1, s[44:47], s75 offen sc1
  ds_write_b128 v97, v[88:91] offset:4096
  v_add_u32 v95, s69, v1
  s_waitcnt vmcnt(22)
  v_pk_mul_f32 v[64:65], v[32:33], s[80:81]
  ds_read_b128 v[128:131], v95 offset:0
  ds_read_b32 v132, v95 offset:16
  v_pk_mul_f32 v[66:67], v[34:35], s[80:81]
  v_pk_mul_f32 v[68:69], v[36:37], s[80:81]
  ds_read_b128 v[136:139], v95 offset:1024
  ds_read_b32 v140, v95 offset:1040
  v_pk_mul_f32 v[70:71], v[38:39], s[80:81]
  v_exp_f32 v64, v64
  ds_read_b128 v[144:147], v95 offset:2048
  ds_read_b32 v148, v95 offset:2064
  v_exp_f32 v65, v65
  v_exp_f32 v66, v66
  ds_read_b128 v[152:155], v95 offset:3072
  ds_read_b32 v156, v95 offset:3088
  v_exp_f32 v67, v67
  v_exp_f32 v68, v68
  v_exp_f32 v69, v69
  v_exp_f32 v70, v70
  v_exp_f32 v71, v71
  v_pk_add_f32 v[64:65], v[64:65], s[82:83]
  v_pk_add_f32 v[66:67], v[66:67], s[82:83]
  v_pk_add_f32 v[68:69], v[68:69], s[82:83]
  v_pk_add_f32 v[70:71], v[70:71], s[82:83]
  v_rcp_f32 v64, v64
  v_rcp_f32 v65, v65
  v_rcp_f32 v66, v66
  v_rcp_f32 v67, v67
  v_rcp_f32 v68, v68
  v_rcp_f32 v69, v69
  v_rcp_f32 v70, v70
  v_rcp_f32 v71, v71
  v_pk_mul_f32 v[64:65], v[64:65], v[32:33]
  v_pk_mul_f32 v[66:67], v[66:67], v[34:35]
  v_pk_mul_f32 v[68:69], v[68:69], v[36:37]
  v_pk_mul_f32 v[70:71], v[70:71], v[38:39]
  v_cvt_pk_bf16_f32 v72, v64, v65
  v_cvt_pk_bf16_f32 v73, v66, v67
  v_cvt_pk_bf16_f32 v74, v68, v69
  v_cvt_pk_bf16_f32 v75, v70, v71
  s_add_u32 s75, s97, 8192
  buffer_store_dwordx4 v[72:75], v1, s[44:47], s75 offen sc1
  ds_write_b128 v96, v[72:75] offset:8192
  s_waitcnt vmcnt(19) lgkmcnt(1)
  v_pk_mul_f32 v[80:81], v[56:57], s[80:81]
  ds_read2_b32 v[192:193], v11 offset0:112 offset1:113
  v_pk_mul_f32 v[82:83], v[58:59], s[80:81]
  ds_read2_b32 v[194:195], v11 offset0:114 offset1:115
  v_pk_mul_f32 v[84:85], v[60:61], s[80:81]
  v_pk_mul_f32 v[86:87], v[62:63], s[80:81]
  ds_read2_b32 v[196:197], v11 offset0:240 offset1:241
  v_exp_f32 v80, v80
  ds_read2_b32 v[198:199], v11 offset0:242 offset1:243
  v_exp_f32 v81, v81
  v_exp_f32 v82, v82
  ds_read2_b32 v[200:201], v92 offset0:112 offset1:113
  v_exp_f32 v83, v83
  ds_read2_b32 v[202:203], v92 offset0:114 offset1:115
  v_exp_f32 v84, v84
  v_exp_f32 v85, v85
  ds_read2_b32 v[204:205], v92 offset0:240 offset1:241
  v_exp_f32 v86, v86
  ds_read2_b32 v[206:207], v92 offset0:242 offset1:243
  v_exp_f32 v87, v87
  v_pk_add_f32 v[80:81], v[80:81], s[82:83]
  ds_read2_b32 v[208:209], v93 offset0:112 offset1:113
  v_pk_add_f32 v[82:83], v[82:83], s[82:83]
  ds_read2_b32 v[210:211], v93 offset0:114 offset1:115
  v_pk_add_f32 v[84:85], v[84:85], s[82:83]
  v_pk_add_f32 v[86:87], v[86:87], s[82:83]
  ds_read2_b32 v[212:213], v93 offset0:240 offset1:241
  v_rcp_f32 v80, v80
  ds_read2_b32 v[214:215], v93 offset0:242 offset1:243
  v_rcp_f32 v81, v81
  v_rcp_f32 v82, v82
  ds_read2_b32 v[216:217], v94 offset0:112 offset1:113
  v_rcp_f32 v83, v83
  ds_read2_b32 v[218:219], v94 offset0:114 offset1:115
  v_rcp_f32 v84, v84
  v_rcp_f32 v85, v85
  ds_read2_b32 v[220:221], v94 offset0:240 offset1:241
  v_rcp_f32 v86, v86
  ds_read2_b32 v[222:223], v94 offset0:242 offset1:243
  v_rcp_f32 v87, v87
  v_pk_mul_f32 v[80:81], v[80:81], v[56:57]
  v_pk_mul_f32 v[82:83], v[82:83], v[58:59]
  v_pk_mul_f32 v[84:85], v[84:85], v[60:61]
  v_pk_mul_f32 v[86:87], v[86:87], v[62:63]
  v_cvt_pk_bf16_f32 v88, v80, v81
  v_cvt_pk_bf16_f32 v89, v82, v83
  v_cvt_pk_bf16_f32 v90, v84, v85
  v_cvt_pk_bf16_f32 v91, v86, v87
  s_add_u32 s75, s98, 8192
  buffer_store_dwordx4 v[88:91], v1, s[44:47], s75 offen sc1
  ds_write_b128 v97, v[88:91] offset:8192
  v_alignbit_b32 v128, v129, v128, 16
  v_alignbit_b32 v129, v130, v129, 16
  v_alignbit_b32 v130, v131, v130, 16
  v_alignbit_b32 v131, v132, v131, 16
  ds_write_b128 v95, v[128:131] offset:4576
  v_alignbit_b32 v136, v137, v136, 16
  v_alignbit_b32 v137, v138, v137, 16
  v_alignbit_b32 v138, v139, v138, 16
  v_alignbit_b32 v139, v140, v139, 16
  ds_write_b128 v95, v[136:139] offset:5600
  v_alignbit_b32 v144, v145, v144, 16
  v_alignbit_b32 v145, v146, v145, 16
  v_alignbit_b32 v146, v147, v146, 16
  v_alignbit_b32 v147, v148, v147, 16
  ds_write_b128 v95, v[144:147] offset:6624
  v_alignbit_b32 v152, v153, v152, 16
  v_alignbit_b32 v153, v154, v153, 16
  v_alignbit_b32 v154, v155, v154, 16
  v_alignbit_b32 v155, v156, v155, 16
  ds_write_b128 v95, v[152:155] offset:7648
  ds_read_b128 v[128:131], v10 offset:4032
  ds_read_b128 v[132:135], v10 offset:3520
  ds_read_b128 v[136:139], v10 offset:3008
  ds_read_b128 v[140:143], v10 offset:2496
  ds_read_b128 v[144:147], v10 offset:1984
  ds_read_b128 v[148:151], v10 offset:1472
  ds_read_b128 v[152:155], v10 offset:960
  ds_read_b128 v[156:159], v10 offset:448
  v_cvt_pk_bf16_f32 v12, v12, v12
  v_lshlrev_b32 v12, 16, v12
  v_mul_f32 v12, 0xbfb8aa3b, v12
  v_exp_f32 v12, v12
  s_nop 0
  v_add_f32 v12, 1.0, v12
  v_rcp_f32 v12, v12
  s_nop 0
  v_cvt_pk_bf16_f32 v12, v12, v12
  v_lshlrev_b32 v12, 16, v12
  v_sub_f32 v14, 1.0, v12
  v_cvt_pk_bf16_f32 v14, v14, v14
  v_lshlrev_b32 v14, 16, v14
  v_mov_b32 v13, v12
  v_mov_b32 v15, v14
  s_lshl_b32 s84, s4, 7
  s_lshl_b32 s86, s5, 4
  s_add_u32 s84, s84, s86
  s_lshl_b32 s86, s6, 2
  s_add_u32 s84, s84, s86
  s_lshl_b32 s84, s84, 6
  s_add_u32 s84, s84, 16408576
  s_waitcnt lgkmcnt(0)
  s_barrier
  v_mfma_f32_16x16x32_bf16 v[96:99], v[128:131], v[192:195], 0
  ds_read_b128 v[160:163], v10 offset:3968
  v_mfma_f32_16x16x32_bf16 v[100:103], v[128:131], v[196:199], 0
  ds_read2_b32 v[224:225], v11 offset0:96 offset1:97
  v_mfma_f32_16x16x32_bf16 v[100:103], v[132:135], v[192:195], v[100:103]
  ds_read2_b32 v[226:227], v11 offset0:98 offset1:99
  buffer_load_dwordx4 a[40:43], v1, s[44:47], s71 offen offset:0 sc1
  v_mfma_f32_16x16x32_bf16 v[104:107], v[128:131], v[200:203], 0
  ds_read_b128 v[164:167], v10 offset:3456
  v_mfma_f32_16x16x32_bf16 v[104:107], v[132:135], v[196:199], v[104:107]
  ds_read2_b32 v[228:229], v11 offset0:224 offset1:225
  v_mfma_f32_16x16x32_bf16 v[104:107], v[136:139], v[192:195], v[104:107]
  ds_read2_b32 v[230:231], v11 offset0:226 offset1:227
  v_mfma_f32_16x16x32_bf16 v[108:111], v[128:131], v[204:207], 0
  ds_read_b128 v[168:171], v10 offset:2944
  v_mfma_f32_16x16x32_bf16 v[108:111], v[132:135], v[200:203], v[108:111]
  ds_read2_b32 v[232:233], v92 offset0:96 offset1:97
  buffer_load_dwordx4 a[44:47], v1, s[44:47], s71 offen offset:1024 sc1
  v_mfma_f32_16x16x32_bf16 v[108:111], v[136:139], v[196:199], v[108:111]
  ds_read2_b32 v[234:235], v92 offset0:98 offset1:99
  v_mfma_f32_16x16x32_bf16 v[108:111], v[140:143], v[192:195], v[108:111]
  ds_read_b128 v[172:175], v10 offset:2432
  v_mfma_f32_16x16x32_bf16 v[112:115], v[128:131], v[208:211], 0
  ds_read2_b32 v[236:237], v92 offset0:224 offset1:225
  v_mfma_f32_16x16x32_bf16 v[112:115], v[132:135], v[204:207], v[112:115]
  ds_read2_b32 v[238:239], v92 offset0:226 offset1:227
  v_mfma_f32_16x16x32_bf16 v[112:115], v[136:139], v[200:203], v[112:115]
  ds_read_b128 v[176:179], v10 offset:1920
  buffer_load_dwordx4 a[48:51], v1, s[44:47], s71 offen offset:2048 sc1
  v_mfma_f32_16x16x32_bf16 v[112:115], v[140:143], v[196:199], v[112:115]
  ds_read2_b32 v[240:241], v93 offset0:96 offset1:97
  v_mfma_f32_16x16x32_bf16 v[112:115], v[144:147], v[192:195], v[112:115]
  ds_read2_b32 v[242:243], v93 offset0:98 offset1:99
  v_mfma_f32_16x16x32_bf16 v[116:119], v[128:131], v[212:215], 0
  ds_read_b128 v[180:183], v10 offset:1408
  v_mfma_f32_16x16x32_bf16 v[116:119], v[132:135], v[208:211], v[116:119]
  ds_read2_b32 v[244:245], v93 offset0:224 offset1:225
  v_mfma_f32_16x16x32_bf16 v[116:119], v[136:139], v[204:207], v[116:119]
  ds_read2_b32 v[246:247], v93 offset0:226 offset1:227
  v_mfma_f32_16x16x32_bf16 v[116:119], v[140:143], v[200:203], v[116:119]
  ds_read_b128 v[184:187], v10 offset:896
  s_waitcnt vmcnt(3)
  s_mov_b64 exec, 1
  buffer_store_dword v7, off, s[44:47], s84 sc1
  s_mov_b64 exec, -1
  v_mfma_f32_16x16x32_bf16 v[116:119], v[144:147], v[196:199], v[116:119]
  ds_read2_b32 v[248:249], v94 offset0:96 offset1:97
  v_mfma_f32_16x16x32_bf16 v[116:119], v[148:151], v[192:195], v[116:119]
  ds_read2_b32 v[250:251], v94 offset0:98 offset1:99
  v_mfma_f32_16x16x32_bf16 v[120:123], v[128:131], v[216:219], 0
  ds_read_b128 v[188:191], v10 offset:384
  v_mfma_f32_16x16x32_bf16 v[120:123], v[132:135], v[212:215], v[120:123]
  ds_read2_b32 v[252:253], v94 offset0:224 offset1:225
  v_mfma_f32_16x16x32_bf16 v[120:123], v[136:139], v[208:211], v[120:123]
  ds_read2_b32 v[254:255], v94 offset0:226 offset1:227
  buffer_load_dwordx4 a[52:55], v1, s[44:47], s71 offen offset:3072 sc1
  v_mfma_f32_16x16x32_bf16 v[120:123], v[140:143], v[204:207], v[120:123]
  s_add_u32 s49, s48, 4096
  s_cmp_eq_u32 s49, s59
  s_cselect_b32 s49, s58, s49
  v_mfma_f32_16x16x32_bf16 v[120:123], v[144:147], v[200:203], v[120:123]
  s_add_u32 s50, s49, 4096
  s_cmp_eq_u32 s50, s59
  s_cselect_b32 s50, s58, s50
  v_mfma_f32_16x16x32_bf16 v[120:123], v[148:151], v[196:199], v[120:123]
  s_add_u32 s51, s50, 4096
  s_cmp_eq_u32 s51, s59
  s_cselect_b32 s51, s58, s51
  v_mfma_f32_16x16x32_bf16 v[120:123], v[152:155], v[192:195], v[120:123]
  s_add_u32 s52, s51, 4096
  s_cmp_eq_u32 s52, s59
  s_cselect_b32 s52, s58, s52
  v_mfma_f32_16x16x32_bf16 v[124:127], v[128:131], v[220:223], 0
  s_add_u32 s53, s52, 4096
  s_cmp_eq_u32 s53, s59
  s_cselect_b32 s53, s58, s53
  s_add_u32 s74, s71, 4096
  s_add_u32 s71, s71, 5120
  buffer_load_dwordx4 a[56:59], v1, s[44:47], s74 offen sc1
L_st5:
  s_cbranch_execz L_hb2
  s_cmp_ge_u32 s71, s73
  s_cselect_b32 s74, 245760, 0
  s_sub_u32 s71, s71, s74
  v_mfma_f32_16x16x32_bf16 v[124:127], v[132:135], v[216:219], v[124:127]
  s_add_u32 s54, s53, 4096
  s_cmp_eq_u32 s54, s59
  s_cselect_b32 s54, s58, s54
  v_mfma_f32_16x16x32_bf16 v[124:127], v[136:139], v[212:215], v[124:127]
  s_add_u32 s55, s54, 4096
  s_cmp_eq_u32 s55, s59
  s_cselect_b32 s55, s58, s55
  v_mfma_f32_16x16x32_bf16 v[124:127], v[140:143], v[208:211], v[124:127]
  s_add_u32 s56, s55, 4096
  s_cmp_eq_u32 s56, s59
  s_cselect_b32 s56, s58, s56
  v_mfma_f32_16x16x32_bf16 v[124:127], v[144:147], v[204:207], v[124:127]
  v_mfma_f32_16x16x32_bf16 v[124:127], v[148:151], v[200:203], v[124:127]
  buffer_load_dwordx4 a[60:63], v1, s[44:47], s71 offen offset:0 sc1
  v_mfma_f32_16x16x32_bf16 v[124:127], v[152:155], v[196:199], v[124:127]
  v_mfma_f32_16x16x32_bf16 v[124:127], v[156:159], v[192:195], v[124:127]
  s_waitcnt lgkmcnt(0)
  v_mfma_f32_16x16x32_bf16 v[96:99], v[160:163], v[224:227], v[96:99]
  ds_read_b128 v[128:131], v10 offset:3904
  v_mfma_f32_16x16x32_bf16 v[100:103], v[160:163], v[228:231], v[100:103]
  ds_read2_b32 v[192:193], v11 offset0:80 offset1:81
  v_mfma_f32_16x16x32_bf16 v[100:103], v[164:167], v[224:227], v[100:103]
  ds_read2_b32 v[194:195], v11 offset0:82 offset1:83
  buffer_load_dwordx4 a[64:67], v1, s[44:47], s71 offen offset:1024 sc1
  v_mfma_f32_16x16x32_bf16 v[104:107], v[160:163], v[232:235], v[104:107]
  ds_read_b128 v[132:135], v10 offset:3392
  v_mfma_f32_16x16x32_bf16 v[104:107], v[164:167], v[228:231], v[104:107]
  ds_read2_b32 v[196:197], v11 offset0:208 offset1:209
  v_mfma_f32_16x16x32_bf16 v[104:107], v[168:171], v[224:227], v[104:107]
  ds_read2_b32 v[198:199], v11 offset0:210 offset1:211
  v_mfma_f32_16x16x32_bf16 v[108:111], v[160:163], v[236:239], v[108:111]
  ds_read_b128 v[136:139], v10 offset:2880
  buffer_load_dwordx4 a[68:71], v1, s[44:47], s71 offen offset:2048 sc1
  v_mfma_f32_16x16x32_bf16 v[108:111], v[164:167], v[232:235], v[108:111]
  ds_read2_b32 v[200:201], v92 offset0:80 offset1:81
  v_mfma_f32_16x16x32_bf16 v[108:111], v[168:171], v[228:231], v[108:111]
  ds_read2_b32 v[202:203], v92 offset0:82 offset1:83
  v_mfma_f32_16x16x32_bf16 v[108:111], v[172:175], v[224:227], v[108:111]
  ds_read_b128 v[140:143], v10 offset:2368
  v_mfma_f32_16x16x32_bf16 v[112:115], v[160:163], v[240:243], v[112:115]
  ds_read2_b32 v[204:205], v92 offset0:208 offset1:209
  v_mfma_f32_16x16x32_bf16 v[112:115], v[164:167], v[236:239], v[112:115]
  ds_read2_b32 v[206:207], v92 offset0:210 offset1:211
  buffer_load_dwordx4 a[72:75], v1, s[44:47], s71 offen offset:3072 sc1
  v_mfma_f32_16x16x32_bf16 v[112:115], v[168:171], v[232:235], v[112:115]
  ds_read_b128 v[144:147], v10 offset:1856
  v_mfma_f32_16x16x32_bf16 v[112:115], v[172:175], v[228:231], v[112:115]
  ds_read2_b32 v[208:209], v93 offset0:80 offset1:81
  v_mfma_f32_16x16x32_bf16 v[112:115], v[176:179], v[224:227], v[112:115]
  ds_read2_b32 v[210:211], v93 offset0:82 offset1:83
  v_mfma_f32_16x16x32_bf16 v[116:119], v[160:163], v[244:247], v[116:119]
  ds_read_b128 v[148:151], v10 offset:1344
  s_add_u32 s74, s71, 4096
  s_add_u32 s71, s71, 5120
  buffer_load_dwordx4 a[76:79], v1, s[44:47], s74 offen sc1
  s_cmp_ge_u32 s71, s73
  s_cselect_b32 s74, 245760, 0
  s_sub_u32 s71, s71, s74
  v_mfma_f32_16x16x32_bf16 v[116:119], v[164:167], v[240:243], v[116:119]
  ds_read2_b32 v[212:213], v93 offset0:208 offset1:209
  v_mfma_f32_16x16x32_bf16 v[116:119], v[168:171], v[236:239], v[116:119]
  ds_read2_b32 v[214:215], v93 offset0:210 offset1:211
  v_mfma_f32_16x16x32_bf16 v[116:119], v[172:175], v[232:235], v[116:119]
  ds_read_b128 v[152:155], v10 offset:832
  v_mfma_f32_16x16x32_bf16 v[116:119], v[176:179], v[228:231], v[116:119]
  ds_read2_b32 v[216:217], v94 offset0:80 offset1:81
  v_mfma_f32_16x16x32_bf16 v[116:119], v[180:183], v[224:227], v[116:119]
  ds_read2_b32 v[218:219], v94 offset0:82 offset1:83
  buffer_load_dwordx4 a[80:83], v1, s[44:47], s71 offen offset:0 sc1
  v_mfma_f32_16x16x32_bf16 v[120:123], v[160:163], v[248:251], v[120:123]
  ds_read_b128 v[156:159], v10 offset:320
  v_mfma_f32_16x16x32_bf16 v[120:123], v[164:167], v[244:247], v[120:123]
  ds_read2_b32 v[220:221], v94 offset0:208 offset1:209
  v_mfma_f32_16x16x32_bf16 v[120:123], v[168:171], v[240:243], v[120:123]
  ds_read2_b32 v[222:223], v94 offset0:210 offset1:211
  v_mfma_f32_16x16x32_bf16 v[120:123], v[172:175], v[236:239], v[120:123]
  buffer_load_dwordx4 a[84:87], v1, s[44:47], s71 offen offset:1024 sc1
  v_mfma_f32_16x16x32_bf16 v[120:123], v[176:179], v[232:235], v[120:123]
  v_mfma_f32_16x16x32_bf16 v[120:123], v[180:183], v[228:231], v[120:123]
  v_mfma_f32_16x16x32_bf16 v[120:123], v[184:187], v[224:227], v[120:123]
  v_mfma_f32_16x16x32_bf16 v[124:127], v[160:163], v[252:255], v[124:127]
  v_mfma_f32_16x16x32_bf16 v[124:127], v[164:167], v[248:251], v[124:127]
  buffer_load_dwordx4 a[88:91], v1, s[44:47], s71 offen offset:2048 sc1
  v_mfma_f32_16x16x32_bf16 v[124:127], v[168:171], v[244:247], v[124:127]
  v_mfma_f32_16x16x32_bf16 v[124:127], v[172:175], v[240:243], v[124:127]
  v_mfma_f32_16x16x32_bf16 v[124:127], v[176:179], v[236:239], v[124:127]
  v_mfma_f32_16x16x32_bf16 v[124:127], v[180:183], v[232:235], v[124:127]
  buffer_load_dwordx4 a[92:95], v1, s[44:47], s71 offen offset:3072 sc1
  v_mfma_f32_16x16x32_bf16 v[124:127], v[184:187], v[228:231], v[124:127]
  v_mfma_f32_16x16x32_bf16 v[124:127], v[188:191], v[224:227], v[124:127]
  s_waitcnt lgkmcnt(0)
  v_mfma_f32_16x16x32_bf16 v[96:99], v[128:131], v[192:195], v[96:99]
  ds_read_b128 v[160:163], v10 offset:3840
  v_mfma_f32_16x16x32_bf16 v[100:103], v[128:131], v[196:199], v[100:103]
  ds_read2_b32 v[224:225], v11 offset0:64 offset1:65
  v_mfma_f32_16x16x32_bf16 v[100:103], v[132:135], v[192:195], v[100:103]
  ds_read2_b32 v[226:227], v11 offset0:66 offset1:67
  s_add_u32 s74, s71, 4096
  s_add_u32 s71, s71, 5120
  buffer_load_dwordx4 a[96:99], v1, s[44:47], s74 offen sc1
  s_cmp_ge_u32 s71, s73
  s_cselect_b32 s74, 245760, 0
  s_sub_u32 s71, s71, s74
  v_mfma_f32_16x16x32_bf16 v[104:107], v[128:131], v[200:203], v[104:107]
  ds_read_b128 v[164:167], v10 offset:3328
  v_mfma_f32_16x16x32_bf16 v[104:107], v[132:135], v[196:199], v[104:107]
  ds_read2_b32 v[228:229], v11 offset0:192 offset1:193
  v_mfma_f32_16x16x32_bf16 v[104:107], v[136:139], v[192:195], v[104:107]
  ds_read2_b32 v[230:231], v11 offset0:194 offset1:195
  v_mfma_f32_16x16x32_bf16 v[108:111], v[128:131], v[204:207], v[108:111]
  ds_read_b128 v[168:171], v10 offset:2816
  buffer_load_dwordx4 a[100:103], v1, s[44:47], s71 offen offset:0 sc1
  v_mfma_f32_16x16x32_bf16 v[108:111], v[132:135], v[200:203], v[108:111]
  ds_read2_b32 v[232:233], v92 offset0:64 offset1:65
  v_mfma_f32_16x16x32_bf16 v[108:111], v[136:139], v[196:199], v[108:111]
  ds_read2_b32 v[234:235], v92 offset0:66 offset1:67
  v_mfma_f32_16x16x32_bf16 v[108:111], v[140:143], v[192:195], v[108:111]
  ds_read_b128 v[172:175], v10 offset:2304
  v_mfma_f32_16x16x32_bf16 v[112:115], v[128:131], v[208:211], v[112:115]
  ds_read2_b32 v[236:237], v92 offset0:192 offset1:193
  v_mfma_f32_16x16x32_bf16 v[112:115], v[132:135], v[204:207], v[112:115]
  ds_read2_b32 v[238:239], v92 offset0:194 offset1:195
  buffer_load_dwordx4 a[104:107], v1, s[44:47], s71 offen offset:1024 sc1
  v_mfma_f32_16x16x32_bf16 v[112:115], v[136:139], v[200:203], v[112:115]
  ds_read_b128 v[176:179], v10 offset:1792
  v_mfma_f32_16x16x32_bf16 v[112:115], v[140:143], v[196:199], v[112:115]
  ds_read2_b32 v[240:241], v93 offset0:64 offset1:65
  v_mfma_f32_16x16x32_bf16 v[112:115], v[144:147], v[192:195], v[112:115]
  ds_read2_b32 v[242:243], v93 offset0:66 offset1:67
  v_mfma_f32_16x16x32_bf16 v[116:119], v[128:131], v[212:215], v[116:119]
  ds_read_b128 v[180:183], v10 offset:1280
  buffer_load_dwordx4 a[108:111], v1, s[44:47], s71 offen offset:2048 sc1
  v_mfma_f32_16x16x32_bf16 v[116:119], v[132:135], v[208:211], v[116:119]
  ds_read2_b32 v[244:245], v93 offset0:192 offset1:193
  v_mfma_f32_16x16x32_bf16 v[116:119], v[136:139], v[204:207], v[116:119]
  ds_read2_b32 v[246:247], v93 offset0:194 offset1:195
  v_mfma_f32_16x16x32_bf16 v[116:119], v[140:143], v[200:203], v[116:119]
  ds_read_b128 v[184:187], v10 offset:768
  v_mfma_f32_16x16x32_bf16 v[116:119], v[144:147], v[196:199], v[116:119]
  ds_read2_b32 v[248:249], v94 offset0:64 offset1:65
  v_mfma_f32_16x16x32_bf16 v[116:119], v[148:151], v[192:195], v[116:119]
  ds_read2_b32 v[250:251], v94 offset0:66 offset1:67
  buffer_load_dwordx4 a[112:115], v1, s[44:47], s71 offen offset:3072 sc1
  v_mfma_f32_16x16x32_bf16 v[120:123], v[128:131], v[216:219], v[120:123]
  ds_read_b128 v[188:191], v10 offset:256
  v_mfma_f32_16x16x32_bf16 v[120:123], v[132:135], v[212:215], v[120:123]
  ds_read2_b32 v[252:253], v94 offset0:192 offset1:193
  v_mfma_f32_16x16x32_bf16 v[120:123], v[136:139], v[208:211], v[120:123]
  ds_read2_b32 v[254:255], v94 offset0:194 offset1:195
  v_mfma_f32_16x16x32_bf16 v[120:123], v[140:143], v[204:207], v[120:123]
  s_add_u32 s74, s71, 4096
  s_add_u32 s71, s71, 5120
  buffer_load_dwordx4 a[116:119], v1, s[44:47], s74 offen sc1
  s_cmp_ge_u32 s71, s73
  s_cselect_b32 s74, 245760, 0
  s_sub_u32 s71, s71, s74
  v_mfma_f32_16x16x32_bf16 v[120:123], v[144:147], v[200:203], v[120:123]
  v_mfma_f32_16x16x32_bf16 v[120:123], v[148:151], v[196:199], v[120:123]
  v_mfma_f32_16x16x32_bf16 v[120:123], v[152:155], v[192:195], v[120:123]
  v_mfma_f32_16x16x32_bf16 v[124:127], v[128:131], v[220:223], v[124:127]
  v_mfma_f32_16x16x32_bf16 v[124:127], v[132:135], v[216:219], v[124:127]
  buffer_load_dwordx4 a[120:123], v1, s[44:47], s71 offen offset:0 sc1
  v_mfma_f32_16x16x32_bf16 v[124:127], v[136:139], v[212:215], v[124:127]
  v_mfma_f32_16x16x32_bf16 v[124:127], v[140:143], v[208:211], v[124:127]
  v_mfma_f32_16x16x32_bf16 v[124:127], v[144:147], v[204:207], v[124:127]
  v_mfma_f32_16x16x32_bf16 v[124:127], v[148:151], v[200:203], v[124:127]
  buffer_load_dwordx4 a[124:127], v1, s[44:47], s71 offen offset:1024 sc1
  v_mfma_f32_16x16x32_bf16 v[124:127], v[152:155], v[196:199], v[124:127]
  v_mfma_f32_16x16x32_bf16 v[124:127], v[156:159], v[192:195], v[124:127]
  s_waitcnt lgkmcnt(0)
  v_mfma_f32_16x16x32_bf16 v[96:99], v[160:163], v[224:227], v[96:99]
  ds_read_b128 v[128:131], v10 offset:3776
  v_mfma_f32_16x16x32_bf16 v[100:103], v[160:163], v[228:231], v[100:103]
  ds_read2_b32 v[192:193], v11 offset0:48 offset1:49
  v_mfma_f32_16x16x32_bf16 v[100:103], v[164:167], v[224:227], v[100:103]
  ds_read2_b32 v[194:195], v11 offset0:50 offset1:51
  v_mfma_f32_16x16x32_bf16 v[104:107], v[160:163], v[232:235], v[104:107]
  ds_read_b128 v[132:135], v10 offset:3264
  buffer_load_dwordx4 a[128:131], v1, s[44:47], s71 offen offset:2048 sc1
  v_mfma_f32_16x16x32_bf16 v[104:107], v[164:167], v[228:231], v[104:107]
  ds_read2_b32 v[196:197], v11 offset0:176 offset1:177
  v_mfma_f32_16x16x32_bf16 v[104:107], v[168:171], v[224:227], v[104:107]
  ds_read2_b32 v[198:199], v11 offset0:178 offset1:179
  v_mfma_f32_16x16x32_bf16 v[108:111], v[160:163], v[236:239], v[108:111]
  ds_read_b128 v[136:139], v10 offset:2752
  v_mfma_f32_16x16x32_bf16 v[108:111], v[164:167], v[232:235], v[108:111]
  ds_read2_b32 v[200:201], v92 offset0:48 offset1:49
  v_mfma_f32_16x16x32_bf16 v[108:111], v[168:171], v[228:231], v[108:111]
  ds_read2_b32 v[202:203], v92 offset0:50 offset1:51
  v_mfma_f32_16x16x32_bf16 v[108:111], v[172:175], v[224:227], v[108:111]
  ds_read_b128 v[140:143], v10 offset:2240
  buffer_load_dwordx4 a[132:135], v1, s[44:47], s71 offen offset:3072 sc1
  v_mfma_f32_16x16x32_bf16 v[112:115], v[160:163], v[240:243], v[112:115]
  ds_read2_b32 v[204:205], v92 offset0:176 offset1:177
  v_mfma_f32_16x16x32_bf16 v[112:115], v[164:167], v[236:239], v[112:115]
  ds_read2_b32 v[206:207], v92 offset0:178 offset1:179
  v_mfma_f32_16x16x32_bf16 v[112:115], v[168:171], v[232:235], v[112:115]
  ds_read_b128 v[144:147], v10 offset:1728
  v_mfma_f32_16x16x32_bf16 v[112:115], v[172:175], v[228:231], v[112:115]
  ds_read2_b32 v[208:209], v93 offset0:48 offset1:49
  v_mfma_f32_16x16x32_bf16 v[112:115], v[176:179], v[224:227], v[112:115]
  ds_read2_b32 v[210:211], v93 offset0:50 offset1:51
  v_mfma_f32_16x16x32_bf16 v[116:119], v[160:163], v[244:247], v[116:119]
  ds_read_b128 v[148:151], v10 offset:1216
  s_add_u32 s74, s71, 4096
  s_add_u32 s71, s71, 5120
  buffer_load_dwordx4 a[136:139], v1, s[44:47], s74 offen sc1
  s_cmp_ge_u32 s71, s73
  s_cselect_b32 s74, 245760, 0
  s_sub_u32 s71, s71, s74
  v_mfma_f32_16x16x32_bf16 v[116:119], v[164:167], v[240:243], v[116:119]
  ds_read2_b32 v[212:213], v93 offset0:176 offset1:177
  v_mfma_f32_16x16x32_bf16 v[116:119], v[168:171], v[236:239], v[116:119]
  ds_read2_b32 v[214:215], v93 offset0:178 offset1:179
  v_mfma_f32_16x16x32_bf16 v[116:119], v[172:175], v[232:235], v[116:119]
  ds_read_b128 v[152:155], v10 offset:704
  v_mfma_f32_16x16x32_bf16 v[116:119], v[176:179], v[228:231], v[116:119]
  ds_read2_b32 v[216:217], v94 offset0:48 offset1:49
  v_mfma_f32_16x16x32_bf16 v[116:119], v[180:183], v[224:227], v[116:119]
  ds_read2_b32 v[218:219], v94 offset0:50 offset1:51
  v_mfma_f32_16x16x32_bf16 v[120:123], v[160:163], v[248:251], v[120:123]
  ds_read_b128 v[156:159], v10 offset:192
  buffer_load_dwordx4 a[140:143], v1, s[44:47], s71 offen offset:0 sc1
  v_mfma_f32_16x16x32_bf16 v[120:123], v[164:167], v[244:247], v[120:123]
  ds_read2_b32 v[220:221], v94 offset0:176 offset1:177
  v_mfma_f32_16x16x32_bf16 v[120:123], v[168:171], v[240:243], v[120:123]
  ds_read2_b32 v[222:223], v94 offset0:178 offset1:179
  v_mfma_f32_16x16x32_bf16 v[120:123], v[172:175], v[236:239], v[120:123]
  v_mfma_f32_16x16x32_bf16 v[120:123], v[176:179], v[232:235], v[120:123]
  v_mfma_f32_16x16x32_bf16 v[120:123], v[180:183], v[228:231], v[120:123]
  v_mfma_f32_16x16x32_bf16 v[120:123], v[184:187], v[224:227], v[120:123]
  buffer_load_dwordx4 a[144:147], v1, s[44:47], s71 offen offset:1024 sc1
  v_mfma_f32_16x16x32_bf16 v[124:127], v[160:163], v[252:255], v[124:127]
  v_mfma_f32_16x16x32_bf16 v[124:127], v[164:167], v[248:251], v[124:127]
  v_mfma_f32_16x16x32_bf16 v[124:127], v[168:171], v[244:247], v[124:127]
  v_mfma_f32_16x16x32_bf16 v[124:127], v[172:175], v[240:243], v[124:127]
  v_mfma_f32_16x16x32_bf16 v[124:127], v[176:179], v[236:239], v[124:127]
  v_mfma_f32_16x16x32_bf16 v[124:127], v[180:183], v[232:235], v[124:127]
  buffer_load_dwordx4 a[148:151], v1, s[44:47], s71 offen offset:2048 sc1
  v_mfma_f32_16x16x32_bf16 v[124:127], v[184:187], v[228:231], v[124:127]
  v_mfma_f32_16x16x32_bf16 v[124:127], v[188:191], v[224:227], v[124:127]
  s_waitcnt lgkmcnt(0)
  v_mfma_f32_16x16x32_bf16 v[96:99], v[128:131], v[192:195], v[96:99]
  ds_read_b128 v[160:163], v10 offset:3712
  v_mfma_f32_16x16x32_bf16 v[100:103], v[128:131], v[196:199], v[100:103]
  ds_read2_b32 v[224:225], v11 offset0:32 offset1:33
  v_mfma_f32_16x16x32_bf16 v[100:103], v[132:135], v[192:195], v[100:103]
  ds_read2_b32 v[226:227], v11 offset0:34 offset1:35
  v_mov_b32 v5, v7
  s_mov_b32 exec_lo, 0xff
  s_mov_b32 exec_hi, 0
  buffer_load_dword v5, v3, s[44:47], 0 offen sc1
  s_mov_b64 exec, -1
  v_mfma_f32_16x16x32_bf16 v[104:107], v[128:131], v[200:203], v[104:107]
  ds_read_b128 v[164:167], v10 offset:3200
  v_mfma_f32_16x16x32_bf16 v[104:107], v[132:135], v[196:199], v[104:107]
  ds_read2_b32 v[228:229], v11 offset0:160 offset1:161
  v_mfma_f32_16x16x32_bf16 v[104:107], v[136:139], v[192:195], v[104:107]
  ds_read2_b32 v[230:231], v11 offset0:162 offset1:163
  v_mfma_f32_16x16x32_bf16 v[108:111], v[128:131], v[204:207], v[108:111]
  ds_read_b128 v[168:171], v10 offset:2688
  v_mfma_f32_16x16x32_bf16 v[108:111], v[132:135], v[200:203], v[108:111]
  ds_read2_b32 v[232:233], v92 offset0:32 offset1:33
  buffer_load_dwordx4 a[152:155], v1, s[44:47], s71 offen offset:3072 sc1
  v_mfma_f32_16x16x32_bf16 v[108:111], v[136:139], v[196:199], v[108:111]
  ds_read2_b32 v[234:235], v92 offset0:34 offset1:35
  v_mfma_f32_16x16x32_bf16 v[108:111], v[140:143], v[192:195], v[108:111]
  ds_read_b128 v[172:175], v10 offset:2176
  v_mfma_f32_16x16x32_bf16 v[112:115], v[128:131], v[208:211], v[112:115]
  ds_read2_b32 v[236:237], v92 offset0:160 offset1:161
  v_mfma_f32_16x16x32_bf16 v[112:115], v[132:135], v[204:207], v[112:115]
  ds_read2_b32 v[238:239], v92 offset0:162 offset1:163
  v_mfma_f32_16x16x32_bf16 v[112:115], v[136:139], v[200:203], v[112:115]
  ds_read_b128 v[176:179], v10 offset:1664
  s_add_u32 s74, s71, 4096
  s_add_u32 s71, s71, 5120
  buffer_load_dwordx4 a[156:159], v1, s[44:47], s74 offen sc1
  s_cmp_ge_u32 s71, s73
  s_cselect_b32 s74, 245760, 0
  s_sub_u32 s71, s71, s74
  v_mfma_f32_16x16x32_bf16 v[112:115], v[140:143], v[196:199], v[112:115]
  ds_read2_b32 v[240:241], v93 offset0:32 offset1:33
  v_mfma_f32_16x16x32_bf16 v[112:115], v[144:147], v[192:195], v[112:115]
  ds_read2_b32 v[242:243], v93 offset0:34 offset1:35
  v_mfma_f32_16x16x32_bf16 v[116:119], v[128:131], v[212:215], v[116:119]
  ds_read_b128 v[180:183], v10 offset:1152
  v_mfma_f32_16x16x32_bf16 v[116:119], v[132:135], v[208:211], v[116:119]
  ds_read2_b32 v[244:245], v93 offset0:160 offset1:161
  v_mfma_f32_16x16x32_bf16 v[116:119], v[136:139], v[204:207], v[116:119]
  ds_read2_b32 v[246:247], v93 offset0:162 offset1:163
  v_mfma_f32_16x16x32_bf16 v[116:119], v[140:143], v[200:203], v[116:119]
  ds_read_b128 v[184:187], v10 offset:640
  buffer_load_dwordx4 a[160:163], v1, s[44:47], s71 offen offset:0 sc1
  v_mfma_f32_16x16x32_bf16 v[116:119], v[144:147], v[196:199], v[116:119]
  ds_read2_b32 v[248:249], v94 offset0:32 offset1:33
  v_mfma_f32_16x16x32_bf16 v[116:119], v[148:151], v[192:195], v[116:119]
  ds_read2_b32 v[250:251], v94 offset0:34 offset1:35
  v_mfma_f32_16x16x32_bf16 v[120:123], v[128:131], v[216:219], v[120:123]
  ds_read_b128 v[188:191], v10 offset:128
  v_mfma_f32_16x16x32_bf16 v[120:123], v[132:135], v[212:215], v[120:123]
  ds_read2_b32 v[252:253], v94 offset0:160 offset1:161
  v_mfma_f32_16x16x32_bf16 v[120:123], v[136:139], v[208:211], v[120:123]
  ds_read2_b32 v[254:255], v94 offset0:162 offset1:163
  buffer_load_dwordx4 a[164:167], v1, s[44:47], s71 offen offset:1024 sc1
  v_mfma_f32_16x16x32_bf16 v[120:123], v[140:143], v[204:207], v[120:123]
  v_mfma_f32_16x16x32_bf16 v[120:123], v[144:147], v[200:203], v[120:123]
  v_mfma_f32_16x16x32_bf16 v[120:123], v[148:151], v[196:199], v[120:123]
  v_mfma_f32_16x16x32_bf16 v[120:123], v[152:155], v[192:195], v[120:123]
  v_mfma_f32_16x16x32_bf16 v[124:127], v[128:131], v[220:223], v[124:127]
  buffer_load_dwordx4 a[168:171], v1, s[44:47], s71 offen offset:2048 sc1
  v_mfma_f32_16x16x32_bf16 v[124:127], v[132:135], v[216:219], v[124:127]
  v_mfma_f32_16x16x32_bf16 v[124:127], v[136:139], v[212:215], v[124:127]
  v_mfma_f32_16x16x32_bf16 v[124:127], v[140:143], v[208:211], v[124:127]
  v_mfma_f32_16x16x32_bf16 v[124:127], v[144:147], v[204:207], v[124:127]
  v_mfma_f32_16x16x32_bf16 v[124:127], v[148:151], v[200:203], v[124:127]
  buffer_load_dwordx4 a[172:175], v1, s[44:47], s71 offen offset:3072 sc1
  v_mfma_f32_16x16x32_bf16 v[124:127], v[152:155], v[196:199], v[124:127]
  v_mfma_f32_16x16x32_bf16 v[124:127], v[156:159], v[192:195], v[124:127]
  s_waitcnt lgkmcnt(0)
  v_mfma_f32_16x16x32_bf16 v[96:99], v[160:163], v[224:227], v[96:99]
  ds_read_b128 v[128:131], v10 offset:3648
  v_mfma_f32_16x16x32_bf16 v[100:103], v[160:163], v[228:231], v[100:103]
  ds_read2_b32 v[192:193], v11 offset0:16 offset1:17
  v_mfma_f32_16x16x32_bf16 v[100:103], v[164:167], v[224:227], v[100:103]
  ds_read2_b32 v[194:195], v11 offset0:18 offset1:19
  v_mfma_f32_16x16x32_bf16 v[104:107], v[160:163], v[232:235], v[104:107]
  ds_read_b128 v[132:135], v10 offset:3136
  s_waitcnt vmcnt(6)
  v_cmp_ne_u32 vcc, s61, v5
  s_cbranch_vccnz L_spin_Bb2
L_ret_Bb2:
  v_mfma_f32_16x16x32_bf16 v[104:107], v[164:167], v[228:231], v[104:107]
  ds_read2_b32 v[196:197], v11 offset0:144 offset1:145
  v_mfma_f32_16x16x32_bf16 v[104:107], v[168:171], v[224:227], v[104:107]
  ds_read2_b32 v[198:199], v11 offset0:146 offset1:147
  v_mfma_f32_16x16x32_bf16 v[108:111], v[160:163], v[236:239], v[108:111]
  ds_read_b128 v[136:139], v10 offset:2624
  v_mfma_f32_16x16x32_bf16 v[108:111], v[164:167], v[232:235], v[108:111]
  ds_read2_b32 v[200:201], v92 offset0:16 offset1:17
  v_mfma_f32_16x16x32_bf16 v[108:111], v[168:171], v[228:231], v[108:111]
  ds_read2_b32 v[202:203], v92 offset0:18 offset1:19
  v_mfma_f32_16x16x32_bf16 v[108:111], v[172:175], v[224:227], v[108:111]
  ds_read_b128 v[140:143], v10 offset:2112
  s_add_u32 s74, s71, 4096
  s_add_u32 s71, s71, 5120
  buffer_load_dwordx4 a[176:179], v1, s[44:47], s74 offen sc1
  s_cmp_ge_u32 s71, s73
  s_cselect_b32 s74, 245760, 0
  s_sub_u32 s71, s71, s74
  v_mfma_f32_16x16x32_bf16 v[112:115], v[160:163], v[240:243], v[112:115]
  ds_read2_b32 v[204:205], v92 offset0:144 offset1:145
  v_mfma_f32_16x16x32_bf16 v[112:115], v[164:167], v[236:239], v[112:115]
  ds_read2_b32 v[206:207], v92 offset0:146 offset1:147
  v_mfma_f32_16x16x32_bf16 v[112:115], v[168:171], v[232:235], v[112:115]
  ds_read_b128 v[144:147], v10 offset:1600
  v_mfma_f32_16x16x32_bf16 v[112:115], v[172:175], v[228:231], v[112:115]
  ds_read2_b32 v[208:209], v93 offset0:16 offset1:17
  v_mfma_f32_16x16x32_bf16 v[112:115], v[176:179], v[224:227], v[112:115]
  ds_read2_b32 v[210:211], v93 offset0:18 offset1:19
  v_mfma_f32_16x16x32_bf16 v[116:119], v[160:163], v[244:247], v[116:119]
  ds_read_b128 v[148:151], v10 offset:1088
  s_add_u32 s75, s48, s76
  buffer_load_dwordx4 v[16:19], v1, s[44:47], s75 offen sc1
  v_mfma_f32_16x16x32_bf16 v[116:119], v[164:167], v[240:243], v[116:119]
  ds_read2_b32 v[212:213], v93 offset0:144 offset1:145
  v_mfma_f32_16x16x32_bf16 v[116:119], v[168:171], v[236:239], v[116:119]
  ds_read2_b32 v[214:215], v93 offset0:146 offset1:147
  v_mfma_f32_16x16x32_bf16 v[116:119], v[172:175], v[232:235], v[116:119]
  ds_read_b128 v[152:155], v10 offset:576
  v_mfma_f32_16x16x32_bf16 v[116:119], v[176:179], v[228:231], v[116:119]
  ds_read2_b32 v[216:217], v94 offset0:16 offset1:17
  v_mfma_f32_16x16x32_bf16 v[116:119], v[180:183], v[224:227], v[116:119]
  ds_read2_b32 v[218:219], v94 offset0:18 offset1:19
  v_mfma_f32_16x16x32_bf16 v[120:123], v[160:163], v[248:251], v[120:123]
  ds_read_b128 v[156:159], v10 offset:64
  s_add_u32 s75, s49, s76
  buffer_load_dwordx4 v[20:23], v1, s[44:47], s75 offen sc1
  v_mfma_f32_16x16x32_bf16 v[120:123], v[164:167], v[244:247], v[120:123]
  ds_read2_b32 v[220:221], v94 offset0:144 offset1:145
  v_mfma_f32_16x16x32_bf16 v[120:123], v[168:171], v[240:243], v[120:123]
  ds_read2_b32 v[222:223], v94 offset0:146 offset1:147
  v_mfma_f32_16x16x32_bf16 v[120:123], v[172:175], v[236:239], v[120:123]
  v_mfma_f32_16x16x32_bf16 v[120:123], v[176:179], v[232:235], v[120:123]
  v_mfma_f32_16x16x32_bf16 v[120:123], v[180:183], v[228:231], v[120:123]
  v_mfma_f32_16x16x32_bf16 v[120:123], v[184:187], v[224:227], v[120:123]
  s_add_u32 s75, s50, s76
  buffer_load_dwordx4 v[24:27], v1, s[44:47], s75 offen sc1
  v_mfma_f32_16x16x32_bf16 v[124:127], v[160:163], v[252:255], v[124:127]
  v_mfma_f32_16x16x32_bf16 v[124:127], v[164:167], v[248:251], v[124:127]
  v_mfma_f32_16x16x32_bf16 v[124:127], v[168:171], v[244:247], v[124:127]
  v_mfma_f32_16x16x32_bf16 v[124:127], v[172:175], v[240:243], v[124:127]
  v_mfma_f32_16x16x32_bf16 v[124:127], v[176:179], v[236:239], v[124:127]
  v_mfma_f32_16x16x32_bf16 v[124:127], v[180:183], v[232:235], v[124:127]
  s_add_u32 s75, s51, s76
  buffer_load_dwordx4 v[28:31], v1, s[44:47], s75 offen sc1
  v_mfma_f32_16x16x32_bf16 v[124:127], v[184:187], v[228:231], v[124:127]
  v_mfma_f32_16x16x32_bf16 v[124:127], v[188:191], v[224:227], v[124:127]
  s_waitcnt lgkmcnt(0)
  v_mfma_f32_16x16x32_bf16 v[96:99], v[128:131], v[192:195], v[96:99]
  ds_read_b128 v[160:163], v10 offset:3584
  v_mfma_f32_16x16x32_bf16 v[100:103], v[128:131], v[196:199], v[100:103]
  ds_read2_b32 v[224:225], v11 offset0:0 offset1:1
  v_mfma_f32_16x16x32_bf16 v[100:103], v[132:135], v[192:195], v[100:103]
  ds_read2_b32 v[226:227], v11 offset0:2 offset1:3
  v_mfma_f32_16x16x32_bf16 v[104:107], v[128:131], v[200:203], v[104:107]
  ds_read_b128 v[164:167], v10 offset:3072
  s_add_u32 s75, s52, s76
  buffer_load_dwordx4 v[32:35], v1, s[44:47], s75 offen sc1
  v_mfma_f32_16x16x32_bf16 v[104:107], v[132:135], v[196:199], v[104:107]
  ds_read2_b32 v[228:229], v11 offset0:128 offset1:129
  v_mfma_f32_16x16x32_bf16 v[104:107], v[136:139], v[192:195], v[104:107]
  ds_read2_b32 v[230:231], v11 offset0:130 offset1:131
  v_mfma_f32_16x16x32_bf16 v[108:111], v[128:131], v[204:207], v[108:111]
  ds_read_b128 v[168:171], v10 offset:2560
  v_mfma_f32_16x16x32_bf16 v[108:111], v[132:135], v[200:203], v[108:111]
  ds_read2_b32 v[232:233], v92 offset0:0 offset1:1
  v_mfma_f32_16x16x32_bf16 v[108:111], v[136:139], v[196:199], v[108:111]
  ds_read2_b32 v[234:235], v92 offset0:2 offset1:3
  v_mfma_f32_16x16x32_bf16 v[108:111], v[140:143], v[192:195], v[108:111]
  ds_read_b128 v[172:175], v10 offset:2048
  s_add_u32 s75, s53, s76
  buffer_load_dwordx4 v[36:39], v1, s[44:47], s75 offen sc1
  v_mfma_f32_16x16x32_bf16 v[112:115], v[128:131], v[208:211], v[112:115]
  ds_read2_b32 v[236:237], v92 offset0:128 offset1:129
  v_mfma_f32_16x16x32_bf16 v[112:115], v[132:135], v[204:207], v[112:115]
  ds_read2_b32 v[238:239], v92 offset0:130 offset1:131
  v_mfma_f32_16x16x32_bf16 v[112:115], v[136:139], v[200:203], v[112:115]
  ds_read_b128 v[176:179], v10 offset:1536
  v_mfma_f32_16x16x32_bf16 v[112:115], v[140:143], v[196:199], v[112:115]
  ds_read2_b32 v[240:241], v93 offset0:0 offset1:1
  v_mfma_f32_16x16x32_bf16 v[112:115], v[144:147], v[192:195], v[112:115]
  ds_read2_b32 v[242:243], v93 offset0:2 offset1:3
  v_mfma_f32_16x16x32_bf16 v[116:119], v[128:131], v[212:215], v[116:119]
  ds_read_b128 v[180:183], v10 offset:1024
  s_add_u32 s75, s54, s76
  buffer_load_dwordx4 v[40:43], v1, s[44:47], s75 offen sc1
  v_mfma_f32_16x16x32_bf16 v[116:119], v[132:135], v[208:211], v[116:119]
  ds_read2_b32 v[244:245], v93 offset0:128 offset1:129
  v_mfma_f32_16x16x32_bf16 v[116:119], v[136:139], v[204:207], v[116:119]
  ds_read2_b32 v[246:247], v93 offset0:130 offset1:131
  v_mfma_f32_16x16x32_bf16 v[116:119], v[140:143], v[200:203], v[116:119]
  ds_read_b128 v[184:187], v10 offset:512
  v_mfma_f32_16x16x32_bf16 v[116:119], v[144:147], v[196:199], v[116:119]
  ds_read2_b32 v[248:249], v94 offset0:0 offset1:1
  v_mfma_f32_16x16x32_bf16 v[116:119], v[148:151], v[192:195], v[116:119]
  ds_read2_b32 v[250:251], v94 offset0:2 offset1:3
  v_mfma_f32_16x16x32_bf16 v[120:123], v[128:131], v[216:219], v[120:123]
  ds_read_b128 v[188:191], v10 offset:0
  s_add_u32 s75, s55, s76
  buffer_load_dwordx4 v[44:47], v1, s[44:47], s75 offen sc1
  v_mfma_f32_16x16x32_bf16 v[120:123], v[132:135], v[212:215], v[120:123]
  ds_read2_b32 v[252:253], v94 offset0:128 offset1:129
  v_mfma_f32_16x16x32_bf16 v[120:123], v[136:139], v[208:211], v[120:123]
  ds_read2_b32 v[254:255], v94 offset0:130 offset1:131
  v_mfma_f32_16x16x32_bf16 v[120:123], v[140:143], v[204:207], v[120:123]
  v_mfma_f32_16x16x32_bf16 v[120:123], v[144:147], v[200:203], v[120:123]
  v_mfma_f32_16x16x32_bf16 v[120:123], v[148:151], v[196:199], v[120:123]
  v_mfma_f32_16x16x32_bf16 v[120:123], v[152:155], v[192:195], v[120:123]
  s_add_u32 s75, s56, s76
  buffer_load_dwordx4 v[48:51], v1, s[44:47], s75 offen sc1
  v_mfma_f32_16x16x32_bf16 v[124:127], v[128:131], v[220:223], v[124:127]
  v_mfma_f32_16x16x32_bf16 v[124:127], v[132:135], v[216:219], v[124:127]
  v_mfma_f32_16x16x32_bf16 v[124:127], v[136:139], v[212:215], v[124:127]
  v_mfma_f32_16x16x32_bf16 v[124:127], v[140:143], v[208:211], v[124:127]
  v_mfma_f32_16x16x32_bf16 v[124:127], v[144:147], v[204:207], v[124:127]
  v_mfma_f32_16x16x32_bf16 v[124:127], v[148:151], v[200:203], v[124:127]
  s_add_u32 s75, s48, s77
  buffer_load_dwordx4 v[52:55], v1, s[44:47], s75 offen sc1
  v_mfma_f32_16x16x32_bf16 v[124:127], v[152:155], v[196:199], v[124:127]
  v_mfma_f32_16x16x32_bf16 v[124:127], v[156:159], v[192:195], v[124:127]
  s_waitcnt lgkmcnt(0)
  v_mfma_f32_16x16x32_bf16 v[96:99], v[160:163], v[224:227], v[96:99]
  v_mfma_f32_16x16x32_bf16 v[100:103], v[160:163], v[228:231], v[100:103]
  s_add_u32 s75, s49, s77
  buffer_load_dwordx4 v[56:59], v1, s[44:47], s75 offen sc1
  v_mfma_f32_16x16x32_bf16 v[100:103], v[164:167], v[224:227], v[100:103]
  v_mfma_f32_16x16x32_bf16 v[104:107], v[160:163], v[232:235], v[104:107]
  v_mfma_f32_16x16x32_bf16 v[104:107], v[164:167], v[228:231], v[104:107]
  v_mfma_f32_16x16x32_bf16 v[104:107], v[168:171], v[224:227], v[104:107]
  s_add_u32 s75, s50, s77
  buffer_load_dwordx4 v[60:63], v1, s[44:47], s75 offen sc1
  v_mfma_f32_16x16x32_bf16 v[108:111], v[160:163], v[236:239], v[108:111]
  v_mfma_f32_16x16x32_bf16 v[108:111], v[164:167], v[232:235], v[108:111]
  v_mfma_f32_16x16x32_bf16 v[108:111], v[168:171], v[228:231], v[108:111]
  v_mfma_f32_16x16x32_bf16 v[108:111], v[172:175], v[224:227], v[108:111]
  s_add_u32 s75, s51, s77
  buffer_load_dwordx4 v[64:67], v1, s[44:47], s75 offen sc1
  v_mfma_f32_16x16x32_bf16 v[112:115], v[160:163], v[240:243], v[112:115]
  v_mfma_f32_16x16x32_bf16 v[112:115], v[164:167], v[236:239], v[112:115]
  v_mfma_f32_16x16x32_bf16 v[112:115], v[168:171], v[232:235], v[112:115]
  s_add_u32 s75, s52, s77
  buffer_load_dwordx4 v[68:71], v1, s[44:47], s75 offen sc1
  v_mfma_f32_16x16x32_bf16 v[112:115], v[172:175], v[228:231], v[112:115]
  v_mfma_f32_16x16x32_bf16 v[112:115], v[176:179], v[224:227], v[112:115]
  v_mfma_f32_16x16x32_bf16 v[116:119], v[160:163], v[244:247], v[116:119]
  v_mfma_f32_16x16x32_bf16 v[116:119], v[164:167], v[240:243], v[116:119]
  s_add_u32 s75, s53, s77
  buffer_load_dwordx4 v[72:75], v1, s[44:47], s75 offen sc1
  v_mfma_f32_16x16x32_bf16 v[116:119], v[168:171], v[236:239], v[116:119]
  v_mfma_f32_16x16x32_bf16 v[116:119], v[172:175], v[232:235], v[116:119]
  v_mfma_f32_16x16x32_bf16 v[116:119], v[176:179], v[228:231], v[116:119]
  s_add_u32 s75, s54, s77
  buffer_load_dwordx4 v[76:79], v1, s[44:47], s75 offen sc1
  v_mfma_f32_16x16x32_bf16 v[116:119], v[180:183], v[224:227], v[116:119]
  v_mfma_f32_16x16x32_bf16 v[120:123], v[160:163], v[248:251], v[120:123]
  v_mfma_f32_16x16x32_bf16 v[120:123], v[164:167], v[244:247], v[120:123]
  v_mfma_f32_16x16x32_bf16 v[120:123], v[168:171], v[240:243], v[120:123]
  s_add_u32 s75, s55, s77
  buffer_load_dwordx4 v[80:83], v1, s[44:47], s75 offen sc1
  v_mfma_f32_16x16x32_bf16 v[120:123], v[172:175], v[236:239], v[120:123]
  v_mfma_f32_16x16x32_bf16 v[120:123], v[176:179], v[232:235], v[120:123]
  v_mfma_f32_16x16x32_bf16 v[120:123], v[180:183], v[228:231], v[120:123]
  v_mfma_f32_16x16x32_bf16 v[120:123], v[184:187], v[224:227], v[120:123]
  s_add_u32 s75, s56, s77
  buffer_load_dwordx4 v[84:87], v1, s[44:47], s75 offen sc1
  v_mfma_f32_16x16x32_bf16 v[124:127], v[160:163], v[252:255], v[124:127]
  v_mfma_f32_16x16x32_bf16 v[124:127], v[164:167], v[248:251], v[124:127]
  v_mfma_f32_16x16x32_bf16 v[124:127], v[168:171], v[244:247], v[124:127]
  s_add_u32 s75, s48, s78
  buffer_load_dwordx4 v[88:91], v1, s[44:47], s75 offen sc1
  v_mfma_f32_16x16x32_bf16 v[124:127], v[172:175], v[240:243], v[124:127]
  v_mfma_f32_16x16x32_bf16 v[124:127], v[176:179], v[236:239], v[124:127]
  v_mfma_f32_16x16x32_bf16 v[124:127], v[180:183], v[232:235], v[124:127]
  v_mfma_f32_16x16x32_bf16 v[124:127], v[184:187], v[228:231], v[124:127]
  s_add_u32 s75, s49, s78
  buffer_load_dwordx4 v[92:95], v1, s[44:47], s75 offen sc1
  v_mfma_f32_16x16x32_bf16 v[124:127], v[188:191], v[224:227], v[124:127]
  s_waitcnt vmcnt(19)
  v_mfma_f32_16x16x32_bf16 v[216:219], a[0:3], v[16:19], 0
  v_mfma_f32_16x16x32_bf16 v[220:223], a[4:7], v[16:19], 0
  s_lshl_b32 s85, s70, 1
  s_add_u32 s85, s85, 16932864
  v_mfma_f32_16x16x32_bf16 v[224:227], a[8:11], v[16:19], 0
  v_mfma_f32_16x16x32_bf16 v[228:231], a[12:15], v[16:19], 0
  v_cvt_pk_bf16_f32 v96, v96, v97
  v_cvt_pk_bf16_f32 v98, v98, v99
L_st6:
  s_cbranch_execz L_st4
  v_mov_b32 v97, v6
  v_mov_b32 v99, v6
  buffer_store_dwordx4 v[96:99], v1, s[44:47], s85 offen offset:0 sc1
  v_mfma_f32_16x16x32_bf16 v[232:235], a[16:19], v[16:19], 0
  s_waitcnt vmcnt(19)
  v_mfma_f32_16x16x32_bf16 v[216:219], a[20:23], v[20:23], v[216:219]
  v_cvt_pk_bf16_f32 v100, v100, v101
  v_cvt_pk_bf16_f32 v102, v102, v103
  v_mov_b32 v101, v6
  v_mov_b32 v103, v6
  buffer_store_dwordx4 v[100:103], v1, s[44:47], s85 offen offset:1024 sc1
  v_mfma_f32_16x16x32_bf16 v[220:223], a[24:27], v[20:23], v[220:223]
  v_mfma_f32_16x16x32_bf16 v[224:227], a[28:31], v[20:23], v[224:227]
  v_cvt_pk_bf16_f32 v104, v104, v105
  v_cvt_pk_bf16_f32 v106, v106, v107
  v_mov_b32 v105, v6
  v_mov_b32 v107, v6
  buffer_store_dwordx4 v[104:107], v1, s[44:47], s85 offen offset:2048 sc1
  v_mfma_f32_16x16x32_bf16 v[228:231], a[32:35], v[20:23], v[228:231]
  v_mfma_f32_16x16x32_bf16 v[232:235], a[36:39], v[20:23], v[232:235]
  v_cvt_pk_bf16_f32 v108, v108, v109
  v_cvt_pk_bf16_f32 v110, v110, v111
  v_mov_b32 v109, v6
  v_mov_b32 v111, v6
  buffer_store_dwordx4 v[108:111], v1, s[44:47], s85 offen offset:3072 sc1
  s_waitcnt vmcnt(21)
  v_mfma_f32_16x16x32_bf16 v[216:219], a[40:43], v[24:27], v[216:219]
  v_mfma_f32_16x16x32_bf16 v[220:223], a[44:47], v[24:27], v[220:223]
  v_cvt_pk_bf16_f32 v112, v112, v113
  v_cvt_pk_bf16_f32 v114, v114, v115
  v_mov_b32 v113, v6
  v_mov_b32 v115, v6
  s_add_u32 s85, s85, 4096
  buffer_store_dwordx4 v[112:115], v1, s[44:47], s85 offen offset:0 sc1
  v_mfma_f32_16x16x32_bf16 v[224:227], a[48:51], v[24:27], v[224:227]
  v_mfma_f32_16x16x32_bf16 v[228:231], a[52:55], v[24:27], v[228:231]
  v_cvt_pk_bf16_f32 v116, v116, v117
  v_cvt_pk_bf16_f32 v118, v118, v119
  v_mov_b32 v117, v6
  v_mov_b32 v119, v6
  buffer_store_dwordx4 v[116:119], v1, s[44:47], s85 offen offset:1024 sc1
  v_mfma_f32_16x16x32_bf16 v[232:235], a[56:59], v[24:27], v[232:235]
  s_waitcnt vmcnt(22)
  v_mfma_f32_16x16x32_bf16 v[216:219], a[60:63], v[28:31], v[216:219]
  v_cvt_pk_bf16_f32 v120, v120, v121
  v_cvt_pk_bf16_f32 v122, v122, v123
  v_mov_b32 v121, v6
  v_mov_b32 v123, v6
  buffer_store_dwordx4 v[120:123], v1, s[44:47], s85 offen offset:2048 sc1
  v_mfma_f32_16x16x32_bf16 v[220:223], a[64:67], v[28:31], v[220:223]
  v_mfma_f32_16x16x32_bf16 v[224:227], a[68:71], v[28:31], v[224:227]
  v_cvt_pk_bf16_f32 v124, v124, v125
  v_cvt_pk_bf16_f32 v126, v126, v127
  v_mov_b32 v125, v6
  v_mov_b32 v127, v6
  buffer_store_dwordx4 v[124:127], v1, s[44:47], s85 offen offset:3072 sc1
  v_mfma_f32_16x16x32_bf16 v[228:231], a[72:75], v[28:31], v[228:231]
  v_mfma_f32_16x16x32_bf16 v[232:235], a[76:79], v[28:31], v[232:235]
  s_mul_i32 s86, s6, 2560
  s_add_u32 s86, s86, 61440
  v_mov_b32 v10, s86
  v_lshl_add_u32 v10, v0, 3, v10
  s_waitcnt vmcnt(23)
  v_mfma_f32_16x16x32_bf16 v[216:219], a[80:83], v[32:35], v[216:219]
  v_mfma_f32_16x16x32_bf16 v[220:223], a[84:87], v[32:35], v[220:223]
  s_add_u32 s75, s50, s78
  buffer_load_dwordx4 v[96:99], v1, s[44:47], s75 offen sc1
  v_mfma_f32_16x16x32_bf16 v[224:227], a[88:91], v[32:35], v[224:227]
  v_mfma_f32_16x16x32_bf16 v[228:231], a[92:95], v[32:35], v[228:231]
  v_and_b32 v208, 15, v0
  v_lshrrev_b32 v209, 2, v208
  v_lshlrev_b32 v209, 1, v209
  v_and_b32 v210, 1, v208
  v_mfma_f32_16x16x32_bf16 v[232:235], a[96:99], v[32:35], v[232:235]
  s_waitcnt vmcnt(23)
  v_mfma_f32_16x16x32_bf16 v[216:219], a[100:103], v[36:39], v[216:219]
  s_add_u32 s75, s51, s78
  buffer_load_dwordx4 v[100:103], v1, s[44:47], s75 offen sc1
  v_mfma_f32_16x16x32_bf16 v[220:223], a[104:107], v[36:39], v[220:223]
  v_mfma_f32_16x16x32_bf16 v[224:227], a[108:111], v[36:39], v[224:227]
  v_or_b32 v209, v209, v210
  v_and_b32 v210, 2, v208
  v_lshl_add_u32 v208, v210, 4, v209
  v_mfma_f32_16x16x32_bf16 v[228:231], a[112:115], v[36:39], v[228:231]
  v_mfma_f32_16x16x32_bf16 v[232:235], a[116:119], v[36:39], v[232:235]
  s_add_u32 s75, s52, s78
  buffer_load_dwordx4 v[104:107], v1, s[44:47], s75 offen sc1
  s_waitcnt vmcnt(24)
  v_mfma_f32_16x16x32_bf16 v[216:219], a[120:123], v[40:43], v[216:219]
  v_mfma_f32_16x16x32_bf16 v[220:223], a[124:127], v[40:43], v[220:223]
  v_mul_u32_u24 v208, 160, v208
  v_lshrrev_b32 v209, 4, v0
  v_lshl_add_u32 v208, v209, 3, v208
  v_add_u32 v11, s87, v208
  v_mfma_f32_16x16x32_bf16 v[224:227], a[128:131], v[40:43], v[224:227]
  v_mfma_f32_16x16x32_bf16 v[228:231], a[132:135], v[40:43], v[228:231]
  s_add_u32 s75, s53, s78
  buffer_load_dwordx4 v[108:111], v1, s[44:47], s75 offen sc1
  v_mfma_f32_16x16x32_bf16 v[232:235], a[136:139], v[40:43], v[232:235]
  s_waitcnt vmcnt(24)
  v_mfma_f32_16x16x32_bf16 v[216:219], a[140:143], v[44:47], v[216:219]
  v_mfma_f32_16x16x32_bf16 v[220:223], a[144:147], v[44:47], v[220:223]
  v_mfma_f32_16x16x32_bf16 v[224:227], a[148:151], v[44:47], v[224:227]
  s_add_u32 s75, s54, s78
  buffer_load_dwordx4 v[112:115], v1, s[44:47], s75 offen sc1
  v_mfma_f32_16x16x32_bf16 v[228:231], a[152:155], v[44:47], v[228:231]
  v_mfma_f32_16x16x32_bf16 v[232:235], a[156:159], v[44:47], v[232:235]
  s_waitcnt vmcnt(24)
  v_mfma_f32_16x16x32_bf16 v[216:219], a[160:163], v[48:51], v[216:219]
  v_mfma_f32_16x16x32_bf16 v[220:223], a[164:167], v[48:51], v[220:223]
  s_add_u32 s75, s55, s78
  buffer_load_dwordx4 v[116:119], v1, s[44:47], s75 offen sc1
  v_mfma_f32_16x16x32_bf16 v[224:227], a[168:171], v[48:51], v[224:227]
  v_mfma_f32_16x16x32_bf16 v[228:231], a[172:175], v[48:51], v[228:231]
  v_mfma_f32_16x16x32_bf16 v[232:235], a[176:179], v[48:51], v[232:235]
  s_waitcnt vmcnt(24)
  v_mfma_f32_16x16x32_bf16 v[236:239], a[0:3], v[52:55], 0
  s_add_u32 s75, s56, s78
  buffer_load_dwordx4 v[120:123], v1, s[44:47], s75 offen sc1
  v_mfma_f32_16x16x32_bf16 v[240:243], a[4:7], v[52:55], 0
  v_mfma_f32_16x16x32_bf16 v[244:247], a[8:11], v[52:55], 0
  s_mul_i32 s84, s76, 15
  s_add_u32 s84, s84, 0
  v_add_u32 v8, s84, v1
  v_mfma_f32_16x16x32_bf16 v[248:251], a[12:15], v[52:55], 0
  v_mfma_f32_16x16x32_bf16 v[252:255], a[16:19], v[52:55], 0
  s_add_u32 s75, s48, s79
  buffer_load_dwordx4 v[124:127], v1, s[44:47], s75 offen sc1
  s_waitcnt vmcnt(25)
  v_mfma_f32_16x16x32_bf16 v[236:239], a[20:23], v[56:59], v[236:239]
  v_mfma_f32_16x16x32_bf16 v[240:243], a[24:27], v[56:59], v[240:243]
  ds_write_b128 v8, v[216:219] offset:0
  v_mfma_f32_16x16x32_bf16 v[244:247], a[28:31], v[56:59], v[244:247]
  v_mfma_f32_16x16x32_bf16 v[248:251], a[32:35], v[56:59], v[248:251]
  s_add_u32 s75, s49, s79
  buffer_load_dwordx4 v[128:131], v1, s[44:47], s75 offen sc1
  v_mfma_f32_16x16x32_bf16 v[252:255], a[36:39], v[56:59], v[252:255]
  s_waitcnt vmcnt(25)
  v_mfma_f32_16x16x32_bf16 v[236:239], a[40:43], v[60:63], v[236:239]
  ds_write_b128 v8, v[220:223] offset:1024
  v_mfma_f32_16x16x32_bf16 v[240:243], a[44:47], v[60:63], v[240:243]
  v_mfma_f32_16x16x32_bf16 v[244:247], a[48:51], v[60:63], v[244:247]
  s_add_u32 s75, s50, s79
  buffer_load_dwordx4 v[132:135], v1, s[44:47], s75 offen sc1
  v_mfma_f32_16x16x32_bf16 v[248:251], a[52:55], v[60:63], v[248:251]
  v_mfma_f32_16x16x32_bf16 v[252:255], a[56:59], v[60:63], v[252:255]
  ds_write_b128 v8, v[224:227] offset:2048
  s_waitcnt vmcnt(25)
  v_mfma_f32_16x16x32_bf16 v[236:239], a[60:63], v[64:67], v[236:239]
  v_mfma_f32_16x16x32_bf16 v[240:243], a[64:67], v[64:67], v[240:243]
  s_add_u32 s75, s51, s79
  buffer_load_dwordx4 v[136:139], v1, s[44:47], s75 offen sc1
  v_mfma_f32_16x16x32_bf16 v[244:247], a[68:71], v[64:67], v[244:247]
  v_mfma_f32_16x16x32_bf16 v[248:251], a[72:75], v[64:67], v[248:251]
  ds_write_b128 v8, v[228:231] offset:3072
  v_mfma_f32_16x16x32_bf16 v[252:255], a[76:79], v[64:67], v[252:255]
  s_waitcnt vmcnt(25)
  v_mfma_f32_16x16x32_bf16 v[236:239], a[80:83], v[68:71], v[236:239]
  s_add_u32 s75, s52, s79
  buffer_load_dwordx4 v[140:143], v1, s[44:47], s75 offen sc1
  v_mfma_f32_16x16x32_bf16 v[240:243], a[84:87], v[68:71], v[240:243]
  v_mfma_f32_16x16x32_bf16 v[244:247], a[88:91], v[68:71], v[244:247]
  ds_write_b128 v8, v[232:235] offset:4096
  v_mfma_f32_16x16x32_bf16 v[248:251], a[92:95], v[68:71], v[248:251]
  v_mfma_f32_16x16x32_bf16 v[252:255], a[96:99], v[68:71], v[252:255]
  s_add_u32 s75, s53, s79
  buffer_load_dwordx4 v[144:147], v1, s[44:47], s75 offen sc1
  s_waitcnt vmcnt(26)
  v_mfma_f32_16x16x32_bf16 v[236:239], a[100:103], v[72:75], v[236:239]
  v_mfma_f32_16x16x32_bf16 v[240:243], a[104:107], v[72:75], v[240:243]
  s_waitcnt vmcnt(63)
  ds_read_b64 v[16:17], v11 offset:0
  ds_read_b64 v[18:19], v11 offset:32
  ds_read_b64 v[20:21], v11 offset:64
  ds_read_b64 v[22:23], v11 offset:96
  ds_read_b64 v[24:25], v11 offset:128
  v_mfma_f32_16x16x32_bf16 v[244:247], a[108:111], v[72:75], v[244:247]
  v_mfma_f32_16x16x32_bf16 v[248:251], a[112:115], v[72:75], v[248:251]
  s_add_u32 s75, s54, s79
  buffer_load_dwordx4 v[148:151], v1, s[44:47], s75 offen sc1
  v_mfma_f32_16x16x32_bf16 v[252:255], a[116:119], v[72:75], v[252:255]
  s_waitcnt vmcnt(26)
  v_mfma_f32_16x16x32_bf16 v[236:239], a[120:123], v[76:79], v[236:239]
  v_lshrrev_b32 v3, 2, v0
  v_lshlrev_b32 v3, 13, v3
  v_mfma_f32_16x16x32_bf16 v[240:243], a[124:127], v[76:79], v[240:243]
  v_mfma_f32_16x16x32_bf16 v[244:247], a[128:131], v[76:79], v[244:247]
  s_add_u32 s75, s55, s79
  buffer_load_dwordx4 v[152:155], v1, s[44:47], s75 offen sc1
  v_mfma_f32_16x16x32_bf16 v[248:251], a[132:135], v[76:79], v[248:251]
  v_mfma_f32_16x16x32_bf16 v[252:255], a[136:139], v[76:79], v[252:255]
  v_and_b32 v4, 3, v0
  v_lshl_add_u32 v3, v4, 4, v3
  s_waitcnt vmcnt(26)
  v_mfma_f32_16x16x32_bf16 v[236:239], a[140:143], v[80:83], v[236:239]
  v_mfma_f32_16x16x32_bf16 v[240:243], a[144:147], v[80:83], v[240:243]
  s_add_u32 s75, s56, s79
  buffer_load_dwordx4 v[156:159], v1, s[44:47], s75 offen sc1
  v_mfma_f32_16x16x32_bf16 v[244:247], a[148:151], v[80:83], v[244:247]
  v_mfma_f32_16x16x32_bf16 v[248:251], a[152:155], v[80:83], v[248:251]
  s_mul_i32 s80, s5, 655360
  s_lshl_b32 s81, s4, 8
  s_add_u32 s80, s80, s81
  s_lshl_b32 s81, s6, 6
  v_mfma_f32_16x16x32_bf16 v[252:255], a[156:159], v[80:83], v[252:255]
  s_waitcnt vmcnt(26)
  v_mfma_f32_16x16x32_bf16 v[236:239], a[160:163], v[84:87], v[236:239]
  s_add_u32 s80, s80, s81
  s_add_u32 s80, s80, 16932864
  s_add_u32 s81, s80, 131072
  s_add_u32 s82, s81, 131072
  v_mfma_f32_16x16x32_bf16 v[240:243], a[164:167], v[84:87], v[240:243]
  v_mfma_f32_16x16x32_bf16 v[244:247], a[168:171], v[84:87], v[244:247]
  s_add_u32 s83, s82, 131072
  s_add_u32 s85, s83, 131072
  v_mfma_f32_16x16x32_bf16 v[248:251], a[172:175], v[84:87], v[248:251]
  v_mfma_f32_16x16x32_bf16 v[252:255], a[176:179], v[84:87], v[252:255]
  s_waitcnt lgkmcnt(0)
  v_lshlrev_b32 v196, 16, v16
  v_and_b32 v197, 0xffff0000, v16
  s_waitcnt vmcnt(25)
  v_mfma_f32_16x16x32_bf16 v[216:219], a[0:3], v[88:91], 0
  v_mfma_f32_16x16x32_bf16 v[220:223], a[4:7], v[88:91], 0
  v_mul_f32 v196, v12, v196
  v_mul_f32 v197, v12, v197
  v_mfma_f32_16x16x32_bf16 v[224:227], a[8:11], v[88:91], 0
  v_mfma_f32_16x16x32_bf16 v[228:231], a[12:15], v[88:91], 0
  v_lshlrev_b32 v198, 16, v17
  v_and_b32 v199, 0xffff0000, v17
  v_mfma_f32_16x16x32_bf16 v[232:235], a[16:19], v[88:91], 0
  s_waitcnt vmcnt(24)
  v_mfma_f32_16x16x32_bf16 v[216:219], a[20:23], v[92:95], v[216:219]
  s_mul_i32 s84, s77, 15
  s_add_u32 s84, s84, 5120
  v_add_u32 v8, s84, v1
  v_mfma_f32_16x16x32_bf16 v[220:223], a[24:27], v[92:95], v[220:223]
  v_mfma_f32_16x16x32_bf16 v[224:227], a[28:31], v[92:95], v[224:227]
  ds_write_b128 v8, v[236:239] offset:0
  v_mfma_f32_16x16x32_bf16 v[228:231], a[32:35], v[92:95], v[228:231]
  v_mfma_f32_16x16x32_bf16 v[232:235], a[36:39], v[92:95], v[232:235]
  ds_write_b128 v8, v[240:243] offset:1024
  s_waitcnt vmcnt(15)
  v_mfma_f32_16x16x32_bf16 v[216:219], a[40:43], v[96:99], v[216:219]
  v_mfma_f32_16x16x32_bf16 v[220:223], a[44:47], v[96:99], v[220:223]
  ds_write_b128 v8, v[244:247] offset:2048
  v_mfma_f32_16x16x32_bf16 v[224:227], a[48:51], v[96:99], v[224:227]
  v_mfma_f32_16x16x32_bf16 v[228:231], a[52:55], v[96:99], v[228:231]
  ds_write_b128 v8, v[248:251] offset:3072
  v_mfma_f32_16x16x32_bf16 v[232:235], a[56:59], v[96:99], v[232:235]
  s_waitcnt vmcnt(14)
  v_mfma_f32_16x16x32_bf16 v[216:219], a[60:63], v[100:103], v[216:219]
  ds_write_b128 v8, v[252:255] offset:4096
  v_mfma_f32_16x16x32_bf16 v[220:223], a[64:67], v[100:103], v[220:223]
  v_mfma_f32_16x16x32_bf16 v[224:227], a[68:71], v[100:103], v[224:227]
  v_mul_f32 v198, v12, v198
  v_mul_f32 v199, v12, v199
  v_mfma_f32_16x16x32_bf16 v[228:231], a[72:75], v[100:103], v[228:231]
  v_mfma_f32_16x16x32_bf16 v[232:235], a[76:79], v[100:103], v[232:235]
  v_lshlrev_b32 v200, 16, v18
  v_and_b32 v201, 0xffff0000, v18
  s_waitcnt vmcnt(13)
  v_mfma_f32_16x16x32_bf16 v[216:219], a[80:83], v[104:107], v[216:219]
  v_mfma_f32_16x16x32_bf16 v[220:223], a[84:87], v[104:107], v[220:223]
  v_mul_f32 v200, v12, v200
  v_mul_f32 v201, v12, v201
  v_mfma_f32_16x16x32_bf16 v[224:227], a[88:91], v[104:107], v[224:227]
  v_mfma_f32_16x16x32_bf16 v[228:231], a[92:95], v[104:107], v[228:231]
  v_lshlrev_b32 v202, 16, v19
  v_and_b32 v203, 0xffff0000, v19
  v_mfma_f32_16x16x32_bf16 v[232:235], a[96:99], v[104:107], v[232:235]
  s_waitcnt vmcnt(12)
  v_mfma_f32_16x16x32_bf16 v[216:219], a[100:103], v[108:111], v[216:219]
  v_mul_f32 v202, v12, v202
  v_mul_f32 v203, v12, v203
  v_mfma_f32_16x16x32_bf16 v[220:223], a[104:107], v[108:111], v[220:223]
  v_mfma_f32_16x16x32_bf16 v[224:227], a[108:111], v[108:111], v[224:227]
  v_lshlrev_b32 v204, 16, v20
  v_and_b32 v205, 0xffff0000, v20
  v_mfma_f32_16x16x32_bf16 v[228:231], a[112:115], v[108:111], v[228:231]
  v_mfma_f32_16x16x32_bf16 v[232:235], a[116:119], v[108:111], v[232:235]
  v_mul_f32 v204, v12, v204
  v_mul_f32 v205, v12, v205
  s_waitcnt vmcnt(11)
  v_mfma_f32_16x16x32_bf16 v[216:219], a[120:123], v[112:115], v[216:219]
  v_mfma_f32_16x16x32_bf16 v[220:223], a[124:127], v[112:115], v[220:223]
  v_lshlrev_b32 v206, 16, v21
  v_and_b32 v207, 0xffff0000, v21
  v_mfma_f32_16x16x32_bf16 v[224:227], a[128:131], v[112:115], v[224:227]
  v_mfma_f32_16x16x32_bf16 v[228:231], a[132:135], v[112:115], v[228:231]
  v_mul_f32 v206, v12, v206
  v_mul_f32 v207, v12, v207
  v_mfma_f32_16x16x32_bf16 v[232:235], a[136:139], v[112:115], v[232:235]
  s_waitcnt vmcnt(10)
  v_mfma_f32_16x16x32_bf16 v[216:219], a[140:143], v[116:119], v[216:219]
  v_lshlrev_b32 v208, 16, v22
  v_and_b32 v209, 0xffff0000, v22
  v_mfma_f32_16x16x32_bf16 v[220:223], a[144:147], v[116:119], v[220:223]
  v_mfma_f32_16x16x32_bf16 v[224:227], a[148:151], v[116:119], v[224:227]
  v_mul_f32 v208, v12, v208
  v_mul_f32 v209, v12, v209
  v_mfma_f32_16x16x32_bf16 v[228:231], a[152:155], v[116:119], v[228:231]
  v_mfma_f32_16x16x32_bf16 v[232:235], a[156:159], v[116:119], v[232:235]
  v_lshlrev_b32 v210, 16, v23
  v_and_b32 v211, 0xffff0000, v23
  s_waitcnt vmcnt(9)
  v_mfma_f32_16x16x32_bf16 v[216:219], a[160:163], v[120:123], v[216:219]
  v_mfma_f32_16x16x32_bf16 v[220:223], a[164:167], v[120:123], v[220:223]
  v_mul_f32 v210, v12, v210
  v_mul_f32 v211, v12, v211
  v_mfma_f32_16x16x32_bf16 v[224:227], a[168:171], v[120:123], v[224:227]
  v_mfma_f32_16x16x32_bf16 v[228:231], a[172:175], v[120:123], v[228:231]
  v_lshlrev_b32 v212, 16, v24
  v_and_b32 v213, 0xffff0000, v24
  v_mfma_f32_16x16x32_bf16 v[232:235], a[176:179], v[120:123], v[232:235]
  buffer_load_dwordx4 v[176:179], v3, s[44:47], s80 offen sc1
  buffer_load_dwordx4 v[180:183], v3, s[44:47], s81 offen sc1
  buffer_load_dwordx4 v[184:187], v3, s[44:47], s82 offen sc1
  buffer_load_dwordx4 v[188:191], v3, s[44:47], s83 offen sc1
  buffer_load_dwordx4 v[192:195], v3, s[44:47], s85 offen sc1
  s_waitcnt vmcnt(13)
  v_mfma_f32_16x16x32_bf16 v[236:239], a[0:3], v[124:127], 0
  v_mul_f32 v212, v12, v212
  v_mul_f32 v213, v12, v213
  v_mfma_f32_16x16x32_bf16 v[240:243], a[4:7], v[124:127], 0
  v_lshlrev_b32 v214, 16, v25
  v_and_b32 v215, 0xffff0000, v25
  v_mfma_f32_16x16x32_bf16 v[244:247], a[8:11], v[124:127], 0
  s_mul_i32 s84, s78, 15
  s_add_u32 s84, s84, 10240
  v_add_u32 v8, s84, v1
  v_mfma_f32_16x16x32_bf16 v[248:251], a[12:15], v[124:127], 0
  ds_write_b128 v8, v[216:219] offset:0
  v_mfma_f32_16x16x32_bf16 v[252:255], a[16:19], v[124:127], 0
  ds_write_b128 v8, v[220:223] offset:1024
  s_waitcnt vmcnt(12)
  v_mfma_f32_16x16x32_bf16 v[236:239], a[20:23], v[128:131], v[236:239]
  ds_write_b128 v8, v[224:227] offset:2048
  v_mfma_f32_16x16x32_bf16 v[240:243], a[24:27], v[128:131], v[240:243]
  ds_write_b128 v8, v[228:231] offset:3072
  v_mfma_f32_16x16x32_bf16 v[244:247], a[28:31], v[128:131], v[244:247]
  ds_write_b128 v8, v[232:235] offset:4096
  v_mfma_f32_16x16x32_bf16 v[248:251], a[32:35], v[128:131], v[248:251]
  v_mul_f32 v214, v12, v214
  v_mul_f32 v215, v12, v215
  v_mfma_f32_16x16x32_bf16 v[252:255], a[36:39], v[128:131], v[252:255]
  s_mul_i32 s84, s6, 15360
  s_waitcnt lgkmcnt(0)
  v_add_u32 v109, s84, v1
  s_barrier
  s_waitcnt vmcnt(11)
  v_mfma_f32_16x16x32_bf16 v[236:239], a[40:43], v[132:135], v[236:239]
  ds_read_b128 v[16:19], v109 offset:0
  ds_read_b128 v[20:23], v109 offset:1024
  v_mfma_f32_16x16x32_bf16 v[240:243], a[44:47], v[132:135], v[240:243]
  ds_read_b128 v[24:27], v109 offset:2048
  ds_read_b128 v[28:31], v109 offset:3072
  v_mfma_f32_16x16x32_bf16 v[244:247], a[48:51], v[132:135], v[244:247]
  ds_read_b128 v[32:35], v109 offset:4096
  ds_read_b128 v[36:39], v109 offset:5120
  v_mfma_f32_16x16x32_bf16 v[248:251], a[52:55], v[132:135], v[248:251]
  ds_read_b128 v[40:43], v109 offset:6144
  ds_read_b128 v[44:47], v109 offset:7168
  v_mfma_f32_16x16x32_bf16 v[252:255], a[56:59], v[132:135], v[252:255]
  ds_read_b128 v[48:51], v109 offset:8192
  ds_read_b128 v[52:55], v109 offset:9216
  s_waitcnt vmcnt(10)
  v_mfma_f32_16x16x32_bf16 v[236:239], a[60:63], v[136:139], v[236:239]
  ds_read_b128 v[56:59], v109 offset:10240
  ds_read_b128 v[60:63], v109 offset:11264
  v_mfma_f32_16x16x32_bf16 v[240:243], a[64:67], v[136:139], v[240:243]
  ds_read_b128 v[64:67], v109 offset:12288
  ds_read_b128 v[68:71], v109 offset:13312
  v_mfma_f32_16x16x32_bf16 v[244:247], a[68:71], v[136:139], v[244:247]
  ds_read_b128 v[72:75], v109 offset:14336
  v_mfma_f32_16x16x32_bf16 v[248:251], a[72:75], v[136:139], v[248:251]
  s_waitcnt lgkmcnt(14)
  v_mul_f32 v16, v14, v16
  v_mul_f32 v17, v14, v17
  v_mul_f32 v18, v14, v18
  v_mfma_f32_16x16x32_bf16 v[252:255], a[76:79], v[136:139], v[252:255]
  v_mul_f32 v19, v14, v19
  s_waitcnt lgkmcnt(13)
  v_mul_f32 v20, v14, v20
  v_mul_f32 v21, v14, v21
  s_waitcnt vmcnt(9)
  v_mfma_f32_16x16x32_bf16 v[236:239], a[80:83], v[140:143], v[236:239]
  v_mul_f32 v22, v14, v22
  v_mul_f32 v23, v14, v23
  s_waitcnt lgkmcnt(12)
  v_mul_f32 v24, v14, v24
  v_mfma_f32_16x16x32_bf16 v[240:243], a[84:87], v[140:143], v[240:243]
  v_mul_f32 v25, v14, v25
  v_mul_f32 v26, v14, v26
  v_mul_f32 v27, v14, v27
  v_mfma_f32_16x16x32_bf16 v[244:247], a[88:91], v[140:143], v[244:247]
  s_waitcnt lgkmcnt(11)
  v_mul_f32 v28, v14, v28
  v_mul_f32 v29, v14, v29
  v_mul_f32 v30, v14, v30
  v_mfma_f32_16x16x32_bf16 v[248:251], a[92:95], v[140:143], v[248:251]
  v_mul_f32 v31, v14, v31
  s_waitcnt lgkmcnt(10)
  v_mul_f32 v32, v14, v32
  v_mul_f32 v33, v14, v33
  v_mfma_f32_16x16x32_bf16 v[252:255], a[96:99], v[140:143], v[252:255]
  v_mul_f32 v34, v14, v34
  v_mul_f32 v35, v14, v35
  s_waitcnt lgkmcnt(9)
  v_fma_f32 v16, v36, v14, v16
  s_waitcnt vmcnt(8)
  v_mfma_f32_16x16x32_bf16 v[236:239], a[100:103], v[144:147], v[236:239]
  v_fma_f32 v17, v37, v14, v17
  v_fma_f32 v18, v38, v14, v18
  v_fma_f32 v19, v39, v14, v19
  v_mfma_f32_16x16x32_bf16 v[240:243], a[104:107], v[144:147], v[240:243]
  s_waitcnt lgkmcnt(8)
  v_fma_f32 v20, v40, v14, v20
  v_fma_f32 v21, v41, v14, v21
  v_fma_f32 v22, v42, v14, v22
  v_mfma_f32_16x16x32_bf16 v[244:247], a[108:111], v[144:147], v[244:247]
  v_fma_f32 v23, v43, v14, v23
  s_waitcnt lgkmcnt(7)
  v_fma_f32 v24, v44, v14, v24
  v_fma_f32 v25, v45, v14, v25
  v_mfma_f32_16x16x32_bf16 v[248:251], a[112:115], v[144:147], v[248:251]
  v_fma_f32 v26, v46, v14, v26
  v_fma_f32 v27, v47, v14, v27
  s_waitcnt lgkmcnt(6)
  v_fma_f32 v28, v48, v14, v28
  v_mfma_f32_16x16x32_bf16 v[252:255], a[116:119], v[144:147], v[252:255]
  v_fma_f32 v29, v49, v14, v29
  v_fma_f32 v30, v50, v14, v30
  v_fma_f32 v31, v51, v14, v31
  s_waitcnt vmcnt(7)
  v_mfma_f32_16x16x32_bf16 v[236:239], a[120:123], v[148:151], v[236:239]
  s_waitcnt lgkmcnt(5)
  v_fma_f32 v32, v52, v14, v32
  v_fma_f32 v33, v53, v14, v33
  v_fma_f32 v34, v54, v14, v34
  v_mfma_f32_16x16x32_bf16 v[240:243], a[124:127], v[148:151], v[240:243]
  v_fma_f32 v35, v55, v14, v35
  s_waitcnt lgkmcnt(4)
  v_fma_f32 v16, v56, v14, v16
  v_fma_f32 v17, v57, v14, v17
  v_mfma_f32_16x16x32_bf16 v[244:247], a[128:131], v[148:151], v[244:247]
  v_fma_f32 v18, v58, v14, v18
  v_fma_f32 v19, v59, v14, v19
  s_waitcnt lgkmcnt(3)
  v_fma_f32 v20, v60, v14, v20
  v_mfma_f32_16x16x32_bf16 v[248:251], a[132:135], v[148:151], v[248:251]
  v_fma_f32 v21, v61, v14, v21
  v_fma_f32 v22, v62, v14, v22
  v_fma_f32 v23, v63, v14, v23
  v_mfma_f32_16x16x32_bf16 v[252:255], a[136:139], v[148:151], v[252:255]
  s_waitcnt lgkmcnt(2)
  v_fma_f32 v24, v64, v14, v24
  v_fma_f32 v25, v65, v14, v25
  v_fma_f32 v26, v66, v14, v26
  s_waitcnt vmcnt(6)
  v_mfma_f32_16x16x32_bf16 v[236:239], a[140:143], v[152:155], v[236:239]
  v_fma_f32 v27, v67, v14, v27
  s_waitcnt lgkmcnt(1)
  v_fma_f32 v28, v68, v14, v28
  v_fma_f32 v29, v69, v14, v29
  v_mfma_f32_16x16x32_bf16 v[240:243], a[144:147], v[152:155], v[240:243]
  v_fma_f32 v30, v70, v14, v30
  v_fma_f32 v31, v71, v14, v31
  s_waitcnt lgkmcnt(0)
  v_fma_f32 v32, v72, v14, v32
  v_mfma_f32_16x16x32_bf16 v[244:247], a[148:151], v[152:155], v[244:247]
  v_fma_f32 v33, v73, v14, v33
  v_fma_f32 v34, v74, v14, v34
  v_fma_f32 v35, v75, v14, v35
  v_mfma_f32_16x16x32_bf16 v[248:251], a[152:155], v[152:155], v[248:251]
  s_waitcnt vmcnt(0)
  v_bitop3_b32 v179, v177, v179, v6 bitop3:0x7e
  v_bitop3_b32 v183, v181, v183, v6 bitop3:0x7e
  v_bitop3_b32 v187, v185, v187, v6 bitop3:0x7e
  v_mfma_f32_16x16x32_bf16 v[252:255], a[156:159], v[152:155], v[252:255]
  v_bitop3_b32 v191, v189, v191, v6 bitop3:0x7e
  v_bitop3_b32 v195, v193, v195, v6 bitop3:0x7e
  v_or3_b32 v4, v179, v183, v187
  s_waitcnt vmcnt(5)
  v_mfma_f32_16x16x32_bf16 v[236:239], a[160:163], v[156:159], v[236:239]
  v_or3_b32 v4, v4, v191, v195
  v_cmp_ne_u32 vcc, 0, v4
  s_cbranch_vccnz L_spin_Yb2
L_ret_Yb2:
  v_mov_b32 v177, v178
  v_mfma_f32_16x16x32_bf16 v[240:243], a[164:167], v[156:159], v[240:243]
  ds_write_b64 v10, v[176:177] offset:0
  v_mov_b32 v181, v182
  ds_write_b64 v10, v[180:181] offset:512
  v_mfma_f32_16x16x32_bf16 v[244:247], a[168:171], v[156:159], v[244:247]
  v_mov_b32 v185, v186
  ds_write_b64 v10, v[184:185] offset:1024
  v_mov_b32 v189, v190
  v_mfma_f32_16x16x32_bf16 v[248:251], a[172:175], v[156:159], v[248:251]
  ds_write_b64 v10, v[188:189] offset:1536
  v_mov_b32 v193, v194
  ds_write_b64 v10, v[192:193] offset:2048
  v_mfma_f32_16x16x32_bf16 v[252:255], a[176:179], v[156:159], v[252:255]
  ds_read_b64_tr_b16 v[96:97], v10 offset:0
  ds_read_b64_tr_b16 v[98:99], v10 offset:512
  ds_read_b64_tr_b16 v[100:101], v10 offset:1024
  ds_read_b64_tr_b16 v[102:103], v10 offset:1536
  ds_read_b64_tr_b16 v[104:105], v10 offset:2048
  s_waitcnt lgkmcnt(4)
  v_lshlrev_b32 v176, 16, v96
  v_and_b32 v177, 0xffff0000, v96
  v_fma_f32 v16, v176, v196, v16
  v_fma_f32 v17, v177, v197, v17
  v_lshlrev_b32 v178, 16, v97
  v_and_b32 v179, 0xffff0000, v97
  v_fma_f32 v18, v178, v198, v18
  v_fma_f32 v19, v179, v199, v19
  s_waitcnt lgkmcnt(3)
  v_lshlrev_b32 v180, 16, v98
  v_and_b32 v181, 0xffff0000, v98
  v_fma_f32 v20, v180, v200, v20
  v_fma_f32 v21, v181, v201, v21
  v_lshlrev_b32 v182, 16, v99
  v_and_b32 v183, 0xffff0000, v99
  v_fma_f32 v22, v182, v202, v22
  v_fma_f32 v23, v183, v203, v23
  s_waitcnt lgkmcnt(2)
  v_lshlrev_b32 v184, 16, v100
  v_and_b32 v185, 0xffff0000, v100
  v_fma_f32 v24, v184, v204, v24
  v_fma_f32 v25, v185, v205, v25
  v_lshlrev_b32 v186, 16, v101
  v_and_b32 v187, 0xffff0000, v101
  v_fma_f32 v26, v186, v206, v26
  v_fma_f32 v27, v187, v207, v27
  s_waitcnt lgkmcnt(1)
  v_lshlrev_b32 v188, 16, v102
  v_and_b32 v189, 0xffff0000, v102
  v_fma_f32 v28, v188, v208, v28
  v_fma_f32 v29, v189, v209, v29
  v_lshlrev_b32 v190, 16, v103
  v_and_b32 v191, 0xffff0000, v103
  v_fma_f32 v30, v190, v210, v30
  v_fma_f32 v31, v191, v211, v31
  s_waitcnt lgkmcnt(0)
  v_lshlrev_b32 v192, 16, v104
  v_and_b32 v193, 0xffff0000, v104
  v_fma_f32 v32, v192, v212, v32
  v_fma_f32 v33, v193, v213, v33
  v_lshlrev_b32 v194, 16, v105
  v_and_b32 v195, 0xffff0000, v105
  v_fma_f32 v34, v194, v214, v34
  v_fma_f32 v35, v195, v215, v35
  v_pk_fma_f32 v[16:17], v[236:237], v[14:15], v[16:17]
  v_pk_fma_f32 v[18:19], v[238:239], v[14:15], v[18:19]
  v_cvt_pk_bf16_f32 v96, v16, v17
  v_cvt_pk_bf16_f32 v97, v18, v19
  ds_write_b64 v11, v[96:97] offset:0
  v_pk_fma_f32 v[20:21], v[240:241], v[14:15], v[20:21]
  v_pk_fma_f32 v[22:23], v[242:243], v[14:15], v[22:23]
  v_cvt_pk_bf16_f32 v98, v20, v21
  v_cvt_pk_bf16_f32 v99, v22, v23
  ds_write_b64 v11, v[98:99] offset:32
  v_pk_fma_f32 v[24:25], v[244:245], v[14:15], v[24:25]
  v_pk_fma_f32 v[26:27], v[246:247], v[14:15], v[26:27]
  v_cvt_pk_bf16_f32 v100, v24, v25
  v_cvt_pk_bf16_f32 v101, v26, v27
  ds_write_b64 v11, v[100:101] offset:64
  v_pk_fma_f32 v[28:29], v[248:249], v[14:15], v[28:29]
  v_pk_fma_f32 v[30:31], v[250:251], v[14:15], v[30:31]
  v_cvt_pk_bf16_f32 v102, v28, v29
  v_cvt_pk_bf16_f32 v103, v30, v31
  ds_write_b64 v11, v[102:103] offset:96
  v_pk_fma_f32 v[32:33], v[252:253], v[14:15], v[32:33]
  v_pk_fma_f32 v[34:35], v[254:255], v[14:15], v[34:35]
  v_cvt_pk_bf16_f32 v104, v32, v33
  v_cvt_pk_bf16_f32 v105, v34, v35
  ds_write_b64 v11, v[104:105] offset:128
  v_add_u32 v8, s87, v1
  ds_read_b128 v[116:119], v8 offset:0
  ds_read_b128 v[120:123], v8 offset:640
  ds_read_b128 v[124:127], v8 offset:5120
  ds_read_b128 v[128:131], v8 offset:5760
  s_mov_b32 exec_lo, -1
  s_mov_b32 exec_hi, 0xff
  s_waitcnt lgkmcnt(3)
  s_mov_b32 s82, 0
  buffer_store_dwordx4 v[116:119], v2, s[40:43], s82 offen sc1
  s_waitcnt lgkmcnt(2)
  s_mov_b32 s82, 5120
  buffer_store_dwordx4 v[120:123], v2, s[40:43], s82 offen sc1
  s_waitcnt lgkmcnt(1)
  s_mov_b32 s82, 40960
  buffer_store_dwordx4 v[124:127], v2, s[40:43], s82 offen sc1
  s_waitcnt lgkmcnt(0)
  s_mov_b32 s82, 46080
  buffer_store_dwordx4 v[128:131], v2, s[40:43], s82 offen sc1
  s_or_b32 s84, s4, s6
  s_cmp_lg_u32 s84, 0
  s_cbranch_scc1 L_noecb2
  s_lshl_b32 s84, s5, 7
  s_add_u32 s84, s84, 16138240
  s_mov_b64 exec, 1
  buffer_store_dword v6, off, s[44:47], s84 sc1
  s_mov_b64 exec, -1
L_noecb2:
  s_or_b32 s84, s5, s6
  s_cmp_lg_u32 s84, 0
  s_cbranch_scc1 L_noerb2
  s_lshl_b32 s84, s4, 7
  s_add_u32 s84, s84, 16139264
  s_mov_b64 exec, 1
  buffer_store_dword v7, off, s[44:47], s84 sc1
  s_mov_b64 exec, -1
L_noerb2:
  s_endpgm
.p2align 12
L_i3:
L_st7:
  s_cbranch_execz L_hb2
  s_nop 7
  s_nop 3
  s_waitcnt vmcnt(8)
  v_cmp_ne_u32 vcc, s60, v5
  s_cbranch_vccnz L_spin_Ai3
L_ret_Ai3:
  s_barrier
  buffer_load_dwordx4 a[0:3], v1, s[44:47], s71 offen offset:0 sc1
  v_mfma_f32_16x16x32_bf16 v[16:19], v[88:91], v[120:123], v[16:19]
  ds_read_b128 v[112:115], v248 offset:0
  ds_read_b128 v[116:119], v249 offset:0
  v_mfma_f32_16x16x32_bf16 v[40:43], v[88:91], v[124:127], v[40:43]
  ds_read_b64_tr_b16 v[64:65], v242 offset:0
  ds_read_b64_tr_b16 v[66:67], v242 offset:1536
  v_mfma_f32_16x16x32_bf16 v[20:23], v[92:95], v[120:123], v[20:23]
  ds_read_b64_tr_b16 v[68:69], v243 offset:0
  ds_read_b64_tr_b16 v[70:71], v243 offset:1536
  buffer_load_dwordx4 a[4:7], v1, s[44:47], s71 offen offset:1024 sc1
  v_mfma_f32_16x16x32_bf16 v[44:47], v[92:95], v[124:127], v[44:47]
  ds_read_b64_tr_b16 v[72:73], v244 offset:0
  ds_read_b64_tr_b16 v[74:75], v244 offset:1536
  v_mfma_f32_16x16x32_bf16 v[24:27], v[96:99], v[120:123], v[24:27]
  ds_read_b64_tr_b16 v[76:77], v245 offset:0
  ds_read_b64_tr_b16 v[78:79], v245 offset:1536
  v_mfma_f32_16x16x32_bf16 v[48:51], v[96:99], v[124:127], v[48:51]
  ds_read_b64_tr_b16 v[80:81], v246 offset:0
  ds_read_b64_tr_b16 v[82:83], v246 offset:1536
  buffer_load_dwordx4 a[8:11], v1, s[44:47], s71 offen offset:2048 sc1
  v_mfma_f32_16x16x32_bf16 v[28:31], v[100:103], v[120:123], v[28:31]
  ds_read_b64_tr_b16 v[84:85], v247 offset:0
  ds_read_b64_tr_b16 v[86:87], v247 offset:1536
  v_mfma_f32_16x16x32_bf16 v[52:55], v[100:103], v[124:127], v[52:55]
  ds_read_b128 v[128:131], v252 offset:1024
  v_mfma_f32_16x16x32_bf16 v[32:35], v[104:107], v[120:123], v[32:35]
  buffer_load_dwordx4 a[12:15], v1, s[44:47], s71 offen offset:3072 sc1
  v_mfma_f32_16x16x32_bf16 v[56:59], v[104:107], v[124:127], v[56:59]
  v_mfma_f32_16x16x32_bf16 v[36:39], v[108:111], v[120:123], v[36:39]
  v_mfma_f32_16x16x32_bf16 v[60:63], v[108:111], v[124:127], v[60:63]
  v_mfma_f32_16x16x32_bf16 v[12:15], v[132:135], v[120:123], v[12:15]
  s_waitcnt lgkmcnt(0)
  s_add_u32 s74, s71, 4096
  s_add_u32 s71, s71, 5120
  buffer_load_dwordx4 a[16:19], v1, s[44:47], s74 offen sc1
  s_cmp_ge_u32 s71, s73
  s_cselect_b32 s74, 245760, 0
  s_sub_u32 s71, s71, s74
  v_mfma_f32_16x16x32_bf16 v[16:19], v[64:67], v[112:115], v[16:19]
  ds_read_b128 v[120:123], v250 offset:0
  ds_read_b128 v[124:127], v251 offset:0
  v_mfma_f32_16x16x32_bf16 v[40:43], v[64:67], v[116:119], v[40:43]
  ds_read_b64_tr_b16 v[88:89], v242 offset:12288
  ds_read_b64_tr_b16 v[90:91], v242 offset:13824
  v_mfma_f32_16x16x32_bf16 v[20:23], v[68:71], v[112:115], v[20:23]
  ds_read_b64_tr_b16 v[92:93], v243 offset:12288
  ds_read_b64_tr_b16 v[94:95], v243 offset:13824
  buffer_load_dwordx4 a[20:23], v1, s[44:47], s71 offen offset:0 sc1
  v_mfma_f32_16x16x32_bf16 v[44:47], v[68:71], v[116:119], v[44:47]
  ds_read_b64_tr_b16 v[96:97], v244 offset:12288
  ds_read_b64_tr_b16 v[98:99], v244 offset:13824
  v_mfma_f32_16x16x32_bf16 v[24:27], v[72:75], v[112:115], v[24:27]
  ds_read_b64_tr_b16 v[100:101], v245 offset:12288
  ds_read_b64_tr_b16 v[102:103], v245 offset:13824
  v_mfma_f32_16x16x32_bf16 v[48:51], v[72:75], v[116:119], v[48:51]
  ds_read_b64_tr_b16 v[104:105], v246 offset:12288
  ds_read_b64_tr_b16 v[106:107], v246 offset:13824
  buffer_load_dwordx4 a[24:27], v1, s[44:47], s71 offen offset:1024 sc1
  v_mfma_f32_16x16x32_bf16 v[28:31], v[76:79], v[112:115], v[28:31]
  ds_read_b64_tr_b16 v[108:109], v247 offset:12288
  ds_read_b64_tr_b16 v[110:111], v247 offset:13824
  v_mfma_f32_16x16x32_bf16 v[52:55], v[76:79], v[116:119], v[52:55]
  ds_read_b128 v[132:135], v252 offset:1088
  v_mfma_f32_16x16x32_bf16 v[32:35], v[80:83], v[112:115], v[32:35]
  buffer_load_dwordx4 a[28:31], v1, s[44:47], s71 offen offset:2048 sc1
  v_mfma_f32_16x16x32_bf16 v[56:59], v[80:83], v[116:119], v[56:59]
  v_mfma_f32_16x16x32_bf16 v[36:39], v[84:87], v[112:115], v[36:39]
  v_mfma_f32_16x16x32_bf16 v[60:63], v[84:87], v[116:119], v[60:63]
  v_mfma_f32_16x16x32_bf16 v[12:15], v[128:131], v[112:115], v[12:15]
  s_waitcnt lgkmcnt(0)
  s_waitcnt vmcnt(8)
  s_barrier
  buffer_load_dwordx4 a[32:35], v1, s[44:47], s71 offen offset:3072 sc1
  v_mfma_f32_16x16x32_bf16 v[16:19], v[88:91], v[120:123], v[16:19]
  ds_read_b128 v[112:115], v238 offset:0
  ds_read_b128 v[116:119], v239 offset:0
  v_mfma_f32_16x16x32_bf16 v[40:43], v[88:91], v[124:127], v[40:43]
  ds_read_b64_tr_b16 v[64:65], v232 offset:0
  ds_read_b64_tr_b16 v[66:67], v232 offset:1536
  s_add_u32 s74, s71, 4096
  s_add_u32 s71, s71, 5120
  buffer_load_dwordx4 a[36:39], v1, s[44:47], s74 offen sc1
  s_cmp_ge_u32 s71, s73
  s_cselect_b32 s74, 245760, 0
  s_sub_u32 s71, s71, s74
  v_mfma_f32_16x16x32_bf16 v[20:23], v[92:95], v[120:123], v[20:23]
  ds_read_b64_tr_b16 v[68:69], v233 offset:0
  ds_read_b64_tr_b16 v[70:71], v233 offset:1536
  v_mfma_f32_16x16x32_bf16 v[44:47], v[92:95], v[124:127], v[44:47]
  ds_read_b64_tr_b16 v[72:73], v234 offset:0
  ds_read_b64_tr_b16 v[74:75], v234 offset:1536
  v_mfma_f32_16x16x32_bf16 v[24:27], v[96:99], v[120:123], v[24:27]
  ds_read_b64_tr_b16 v[76:77], v235 offset:0
  ds_read_b64_tr_b16 v[78:79], v235 offset:1536
  buffer_load_dwordx4 a[40:43], v1, s[44:47], s71 offen offset:0 sc1
  v_mfma_f32_16x16x32_bf16 v[48:51], v[96:99], v[124:127], v[48:51]
  ds_read_b64_tr_b16 v[80:81], v236 offset:0
  ds_read_b64_tr_b16 v[82:83], v236 offset:1536
  v_mfma_f32_16x16x32_bf16 v[28:31], v[100:103], v[120:123], v[28:31]
  ds_read_b64_tr_b16 v[84:85], v237 offset:0
  ds_read_b64_tr_b16 v[86:87], v237 offset:1536
  buffer_load_dwordx4 a[44:47], v1, s[44:47], s71 offen offset:1024 sc1
  v_mfma_f32_16x16x32_bf16 v[52:55], v[100:103], v[124:127], v[52:55]
  ds_read_b128 v[128:131], v252 offset:1152
  v_mfma_f32_16x16x32_bf16 v[32:35], v[104:107], v[120:123], v[32:35]
  v_mfma_f32_16x16x32_bf16 v[56:59], v[104:107], v[124:127], v[56:59]
  buffer_load_dwordx4 a[48:51], v1, s[44:47], s71 offen offset:2048 sc1
  v_mfma_f32_16x16x32_bf16 v[36:39], v[108:111], v[120:123], v[36:39]
  v_mfma_f32_16x16x32_bf16 v[60:63], v[108:111], v[124:127], v[60:63]
  v_mfma_f32_16x16x32_bf16 v[12:15], v[132:135], v[120:123], v[12:15]
  s_waitcnt lgkmcnt(0)
  buffer_load_dwordx4 a[52:55], v1, s[44:47], s71 offen offset:3072 sc1
  v_mfma_f32_16x16x32_bf16 v[16:19], v[64:67], v[112:115], v[16:19]
  ds_read_b128 v[120:123], v240 offset:0
  ds_read_b128 v[124:127], v241 offset:0
  v_mfma_f32_16x16x32_bf16 v[40:43], v[64:67], v[116:119], v[40:43]
  ds_read_b64_tr_b16 v[88:89], v232 offset:12288
  ds_read_b64_tr_b16 v[90:91], v232 offset:13824
  s_add_u32 s74, s71, 4096
  s_add_u32 s71, s71, 5120
  buffer_load_dwordx4 a[56:59], v1, s[44:47], s74 offen sc1
  s_cmp_ge_u32 s71, s73
  s_cselect_b32 s74, 245760, 0
  s_sub_u32 s71, s71, s74
  v_mfma_f32_16x16x32_bf16 v[20:23], v[68:71], v[112:115], v[20:23]
  ds_read_b64_tr_b16 v[92:93], v233 offset:12288
  ds_read_b64_tr_b16 v[94:95], v233 offset:13824
  v_mfma_f32_16x16x32_bf16 v[44:47], v[68:71], v[116:119], v[44:47]
  ds_read_b64_tr_b16 v[96:97], v234 offset:12288
  ds_read_b64_tr_b16 v[98:99], v234 offset:13824
  v_mfma_f32_16x16x32_bf16 v[24:27], v[72:75], v[112:115], v[24:27]
  ds_read_b64_tr_b16 v[100:101], v235 offset:12288
  ds_read_b64_tr_b16 v[102:103], v235 offset:13824
  buffer_load_dwordx4 a[60:63], v1, s[44:47], s71 offen offset:0 sc1
  v_mfma_f32_16x16x32_bf16 v[48:51], v[72:75], v[116:119], v[48:51]
  ds_read_b64_tr_b16 v[104:105], v236 offset:12288
  ds_read_b64_tr_b16 v[106:107], v236 offset:13824
  v_mfma_f32_16x16x32_bf16 v[28:31], v[76:79], v[112:115], v[28:31]
  ds_read_b64_tr_b16 v[108:109], v237 offset:12288
  ds_read_b64_tr_b16 v[110:111], v237 offset:13824
  buffer_load_dwordx4 a[64:67], v1, s[44:47], s71 offen offset:1024 sc1
  v_mfma_f32_16x16x32_bf16 v[52:55], v[76:79], v[116:119], v[52:55]
  ds_read_b128 v[132:135], v252 offset:1216
  v_mfma_f32_16x16x32_bf16 v[32:35], v[80:83], v[112:115], v[32:35]
  v_mfma_f32_16x16x32_bf16 v[56:59], v[80:83], v[116:119], v[56:59]
  buffer_load_dwordx4 a[68:71], v1, s[44:47], s71 offen offset:2048 sc1
  v_mfma_f32_16x16x32_bf16 v[36:39], v[84:87], v[112:115], v[36:39]
  v_mfma_f32_16x16x32_bf16 v[60:63], v[84:87], v[116:119], v[60:63]
  v_mfma_f32_16x16x32_bf16 v[12:15], v[128:131], v[112:115], v[12:15]
  s_waitcnt lgkmcnt(0)
  s_barrier
  v_mul_u32_u24 v136, 205, v0
  v_lshrrev_b32 v136, 11, v136
  v_mul_u32_u24 v137, 10, v136
  v_mfma_f32_16x16x32_bf16 v[16:19], v[88:91], v[120:123], v[16:19]
  v_sub_u32 v137, v0, v137
  v_mul_u32_u24 v136, 1280, v136
  v_lshl_add_u32 v136, v137, 4, v136
  v_mfma_f32_16x16x32_bf16 v[40:43], v[88:91], v[124:127], v[40:43]
  s_mul_i32 s80, s4, 81920
  s_mul_i32 s81, s5, 160
  s_add_u32 s80, s80, s81
  s_mul_i32 s81, s6, 10240
  s_add_u32 s80, s80, s81
  v_mfma_f32_16x16x32_bf16 v[20:23], v[92:95], v[120:123], v[20:23]
  v_add_u32 v2, s80, v136
  s_mul_i32 s87, s6, 1280
  s_add_u32 s87, s87, 153472
  v_mfma_f32_16x16x32_bf16 v[44:47], v[92:95], v[124:127], v[44:47]
  s_mov_b32 exec_lo, -1
  s_mov_b32 exec_hi, 0xff
  s_add_u32 m0, s87, 0
  s_mov_b32 s82, 0
  buffer_load_dwordx4 v2, s[8:11], s82 offen lds
  s_mov_b64 exec, -1
  v_mfma_f32_16x16x32_bf16 v[24:27], v[96:99], v[120:123], v[24:27]
  s_mov_b32 exec_lo, -1
  s_mov_b32 exec_hi, 0xff
  s_add_u32 m0, s87, 640
  s_mov_b32 s82, 5120
  buffer_load_dwordx4 v2, s[8:11], s82 offen lds
  s_mov_b64 exec, -1
  v_mfma_f32_16x16x32_bf16 v[48:51], v[96:99], v[124:127], v[48:51]
  s_mov_b32 exec_lo, -1
  s_mov_b32 exec_hi, 0xff
  s_add_u32 m0, s87, 5120
  s_mov_b32 s82, 40960
  buffer_load_dwordx4 v2, s[8:11], s82 offen lds
  s_mov_b64 exec, -1
  v_mfma_f32_16x16x32_bf16 v[28:31], v[100:103], v[120:123], v[28:31]
  s_mov_b32 exec_lo, -1
  s_mov_b32 exec_hi, 0xff
  s_add_u32 m0, s87, 5760
  s_mov_b32 s82, 46080
  buffer_load_dwordx4 v2, s[8:11], s82 offen lds
  s_mov_b64 exec, -1
  v_mfma_f32_16x16x32_bf16 v[52:55], v[100:103], v[124:127], v[52:55]
  s_add_u32 s76, s6, 1
  s_and_b32 s76, s76, 3
  s_lshl_b32 s76, s76, 10
  v_mfma_f32_16x16x32_bf16 v[32:35], v[104:107], v[120:123], v[32:35]
  s_add_u32 s77, s6, 2
  s_and_b32 s77, s77, 3
  s_lshl_b32 s77, s77, 10
  v_mfma_f32_16x16x32_bf16 v[56:59], v[104:107], v[124:127], v[56:59]
  s_add_u32 s78, s6, 3
  s_and_b32 s78, s78, 3
  s_lshl_b32 s78, s78, 10
  v_mfma_f32_16x16x32_bf16 v[36:39], v[108:111], v[120:123], v[36:39]
  s_add_u32 s79, s6, 4
  s_and_b32 s79, s79, 3
  s_lshl_b32 s79, s79, 10
  v_mfma_f32_16x16x32_bf16 v[60:63], v[108:111], v[124:127], v[60:63]
  v_mfma_f32_16x16x32_bf16 v[12:15], v[132:135], v[120:123], v[12:15]
  s_mov_b32 s80, 0xbfb8aa3b
  s_mov_b32 s81, 0xbfb8aa3b
  s_mov_b32 s82, 1.0
  s_mov_b32 s83, 1.0
  s_and_b32 s85, s6, 1
  s_mul_i32 s85, s85, 12288
  s_add_u32 s85, s85, 73728
  s_add_u32 s84, s85, s79
  v_pk_mul_f32 v[64:65], v[16:17], s[80:81]
  v_pk_mul_f32 v[66:67], v[18:19], s[80:81]
  v_pk_mul_f32 v[68:69], v[20:21], s[80:81]
  v_pk_mul_f32 v[70:71], v[22:23], s[80:81]
  v_exp_f32 v64, v64
  v_exp_f32 v65, v65
  v_exp_f32 v66, v66
  v_exp_f32 v67, v67
  v_exp_f32 v68, v68
  v_exp_f32 v69, v69
  v_exp_f32 v70, v70
  v_exp_f32 v71, v71
  v_add_u32 v96, s84, v1
  v_xor_b32 v97, 1024, v96
  v_pk_add_f32 v[64:65], v[64:65], s[82:83]
  v_pk_add_f32 v[66:67], v[66:67], s[82:83]
  v_pk_add_f32 v[68:69], v[68:69], s[82:83]
  v_pk_add_f32 v[70:71], v[70:71], s[82:83]
  v_rcp_f32 v64, v64
  v_rcp_f32 v65, v65
  v_rcp_f32 v66, v66
  v_rcp_f32 v67, v67
  v_rcp_f32 v68, v68
  v_rcp_f32 v69, v69
  v_rcp_f32 v70, v70
  v_rcp_f32 v71, v71
  v_pk_mul_f32 v[64:65], v[64:65], v[16:17]
  v_pk_mul_f32 v[66:67], v[66:67], v[18:19]
  v_pk_mul_f32 v[68:69], v[68:69], v[20:21]
  v_pk_mul_f32 v[70:71], v[70:71], v[22:23]
  v_cvt_pk_bf16_f32 v72, v64, v65
  v_cvt_pk_bf16_f32 v73, v66, v67
  v_cvt_pk_bf16_f32 v74, v68, v69
  v_cvt_pk_bf16_f32 v75, v70, v71
  s_add_u32 s75, s97, 0
  buffer_store_dwordx4 v[72:75], v1, s[44:47], s75 offen sc1
  ds_write_b128 v96, v[72:75] offset:0
  v_pk_mul_f32 v[80:81], v[40:41], s[80:81]
  v_pk_mul_f32 v[82:83], v[42:43], s[80:81]
  v_pk_mul_f32 v[84:85], v[44:45], s[80:81]
  v_pk_mul_f32 v[86:87], v[46:47], s[80:81]
  v_exp_f32 v80, v80
  v_exp_f32 v81, v81
  v_exp_f32 v82, v82
  v_exp_f32 v83, v83
  v_exp_f32 v84, v84
  v_exp_f32 v85, v85
  v_exp_f32 v86, v86
  v_exp_f32 v87, v87
  v_pk_add_f32 v[80:81], v[80:81], s[82:83]
  v_pk_add_f32 v[82:83], v[82:83], s[82:83]
  v_pk_add_f32 v[84:85], v[84:85], s[82:83]
  v_pk_add_f32 v[86:87], v[86:87], s[82:83]
  v_rcp_f32 v80, v80
  v_rcp_f32 v81, v81
  v_rcp_f32 v82, v82
  v_rcp_f32 v83, v83
  v_rcp_f32 v84, v84
  v_rcp_f32 v85, v85
  v_rcp_f32 v86, v86
  v_rcp_f32 v87, v87
  v_pk_mul_f32 v[80:81], v[80:81], v[40:41]
  v_pk_mul_f32 v[82:83], v[82:83], v[42:43]
  v_pk_mul_f32 v[84:85], v[84:85], v[44:45]
  v_pk_mul_f32 v[86:87], v[86:87], v[46:47]
  v_cvt_pk_bf16_f32 v88, v80, v81
  v_cvt_pk_bf16_f32 v89, v82, v83
  v_cvt_pk_bf16_f32 v90, v84, v85
  v_cvt_pk_bf16_f32 v91, v86, v87
  s_add_u32 s75, s98, 0
  buffer_store_dwordx4 v[88:91], v1, s[44:47], s75 offen sc1
  ds_write_b128 v97, v[88:91] offset:0
  v_pk_mul_f32 v[64:65], v[24:25], s[80:81]
  v_pk_mul_f32 v[66:67], v[26:27], s[80:81]
  v_pk_mul_f32 v[68:69], v[28:29], s[80:81]
  v_pk_mul_f32 v[70:71], v[30:31], s[80:81]
  v_exp_f32 v64, v64
  v_exp_f32 v65, v65
  v_exp_f32 v66, v66
  v_exp_f32 v67, v67
  v_exp_f32 v68, v68
  v_exp_f32 v69, v69
  v_exp_f32 v70, v70
  v_exp_f32 v71, v71
  v_pk_add_f32 v[64:65], v[64:65], s[82:83]
  v_pk_add_f32 v[66:67], v[66:67], s[82:83]
  v_pk_add_f32 v[68:69], v[68:69], s[82:83]
  v_pk_add_f32 v[70:71], v[70:71], s[82:83]
  v_rcp_f32 v64, v64
  v_rcp_f32 v65, v65
  v_rcp_f32 v66, v66
  v_rcp_f32 v67, v67
  v_rcp_f32 v68, v68
  v_rcp_f32 v69, v69
  v_rcp_f32 v70, v70
  v_rcp_f32 v71, v71
  v_pk_mul_f32 v[64:65], v[64:65], v[24:25]
  v_pk_mul_f32 v[66:67], v[66:67], v[26:27]
  v_pk_mul_f32 v[68:69], v[68:69], v[28:29]
  v_pk_mul_f32 v[70:71], v[70:71], v[30:31]
  v_cvt_pk_bf16_f32 v72, v64, v65
  v_cvt_pk_bf16_f32 v73, v66, v67
  v_cvt_pk_bf16_f32 v74, v68, v69
  v_cvt_pk_bf16_f32 v75, v70, v71
  s_add_u32 s75, s97, 4096
  buffer_store_dwordx4 v[72:75], v1, s[44:47], s75 offen sc1
  ds_write_b128 v96, v[72:75] offset:4096
  v_pk_mul_f32 v[80:81], v[48:49], s[80:81]
  v_pk_mul_f32 v[82:83], v[50:51], s[80:81]
  v_pk_mul_f32 v[84:85], v[52:53], s[80:81]
  buffer_load_dwordx4 a[72:75], v1, s[44:47], s71 offen offset:3072 sc1
  v_pk_mul_f32 v[86:87], v[54:55], s[80:81]
  v_exp_f32 v80, v80
  v_exp_f32 v81, v81
  v_exp_f32 v82, v82
  v_exp_f32 v83, v83
  v_exp_f32 v84, v84
  v_exp_f32 v85, v85
  s_add_u32 s74, s71, 4096
  s_add_u32 s71, s71, 5120
  buffer_load_dwordx4 a[76:79], v1, s[44:47], s74 offen sc1
  s_cmp_ge_u32 s71, s73
  s_cselect_b32 s74, 245760, 0
  s_sub_u32 s71, s71, s74
  v_exp_f32 v86, v86
  v_exp_f32 v87, v87
  v_pk_add_f32 v[80:81], v[80:81], s[82:83]
  v_pk_add_f32 v[82:83], v[82:83], s[82:83]
  v_pk_add_f32 v[84:85], v[84:85], s[82:83]
  v_pk_add_f32 v[86:87], v[86:87], s[82:83]
  v_rcp_f32 v80, v80
  buffer_load_dwordx4 a[80:83], v1, s[44:47], s71 offen offset:0 sc1
  v_rcp_f32 v81, v81
  v_rcp_f32 v82, v82
  v_rcp_f32 v83, v83
  v_rcp_f32 v84, v84
  v_rcp_f32 v85, v85
  v_rcp_f32 v86, v86
  v_rcp_f32 v87, v87
  buffer_load_dwordx4 a[84:87], v1, s[44:47], s71 offen offset:1024 sc1
  v_pk_mul_f32 v[80:81], v[80:81], v[48:49]
  v_pk_mul_f32 v[82:83], v[82:83], v[50:51]
  v_pk_mul_f32 v[84:85], v[84:85], v[52:53]
  v_pk_mul_f32 v[86:87], v[86:87], v[54:55]
  v_cvt_pk_bf16_f32 v88, v80, v81
  v_cvt_pk_bf16_f32 v89, v82, v83
  v_cvt_pk_bf16_f32 v90, v84, v85
  v_cvt_pk_bf16_f32 v91, v86, v87
  s_add_u32 s75, s98, 4096
  buffer_store_dwordx4 v[88:91], v1, s[44:47], s75 offen sc1
  ds_write_b128 v97, v[88:91] offset:4096
  v_pk_mul_f32 v[64:65], v[32:33], s[80:81]
  v_pk_mul_f32 v[66:67], v[34:35], s[80:81]
  v_pk_mul_f32 v[68:69], v[36:37], s[80:81]
  buffer_load_dwordx4 a[88:91], v1, s[44:47], s71 offen offset:2048 sc1
  v_pk_mul_f32 v[70:71], v[38:39], s[80:81]
  v_exp_f32 v64, v64
  v_exp_f32 v65, v65
  v_exp_f32 v66, v66
  v_exp_f32 v67, v67
  v_exp_f32 v68, v68
  v_exp_f32 v69, v69
  buffer_load_dwordx4 a[92:95], v1, s[44:47], s71 offen offset:3072 sc1
  v_exp_f32 v70, v70
  v_exp_f32 v71, v71
  v_pk_add_f32 v[64:65], v[64:65], s[82:83]
  v_pk_add_f32 v[66:67], v[66:67], s[82:83]
  v_pk_add_f32 v[68:69], v[68:69], s[82:83]
  v_pk_add_f32 v[70:71], v[70:71], s[82:83]
  v_rcp_f32 v64, v64
  s_add_u32 s74, s71, 4096
  s_add_u32 s71, s71, 5120
  buffer_load_dwordx4 a[96:99], v1, s[44:47], s74 offen sc1
  s_cmp_ge_u32 s71, s73
  s_cselect_b32 s74, 245760, 0
  s_sub_u32 s71, s71, s74
  v_rcp_f32 v65, v65
  v_rcp_f32 v66, v66
  v_rcp_f32 v67, v67
  v_rcp_f32 v68, v68
  v_rcp_f32 v69, v69
  v_rcp_f32 v70, v70
  v_rcp_f32 v71, v71
  buffer_load_dwordx4 a[100:103], v1, s[44:47], s71 offen offset:0 sc1
  v_pk_mul_f32 v[64:65], v[64:65], v[32:33]
  v_pk_mul_f32 v[66:67], v[66:67], v[34:35]
  v_pk_mul_f32 v[68:69], v[68:69], v[36:37]
  v_pk_mul_f32 v[70:71], v[70:71], v[38:39]
  v_cvt_pk_bf16_f32 v72, v64, v65
  v_cvt_pk_bf16_f32 v73, v66, v67
  v_cvt_pk_bf16_f32 v74, v68, v69
  v_cvt_pk_bf16_f32 v75, v70, v71
  s_add_u32 s75, s97, 8192
  buffer_store_dwordx4 v[72:75], v1, s[44:47], s75 offen sc1
  ds_write_b128 v96, v[72:75] offset:8192
  v_pk_mul_f32 v[80:81], v[56:57], s[80:81]
  v_pk_mul_f32 v[82:83], v[58:59], s[80:81]
  v_pk_mul_f32 v[84:85], v[60:61], s[80:81]
  buffer_load_dwordx4 a[104:107], v1, s[44:47], s71 offen offset:1024 sc1
  v_pk_mul_f32 v[86:87], v[62:63], s[80:81]
  v_exp_f32 v80, v80
  v_exp_f32 v81, v81
  v_exp_f32 v82, v82
  v_exp_f32 v83, v83
  v_exp_f32 v84, v84
  v_exp_f32 v85, v85
  buffer_load_dwordx4 a[108:111], v1, s[44:47], s71 offen offset:2048 sc1
  v_exp_f32 v86, v86
  v_exp_f32 v87, v87
  v_pk_add_f32 v[80:81], v[80:81], s[82:83]
  v_pk_add_f32 v[82:83], v[82:83], s[82:83]
  v_pk_add_f32 v[84:85], v[84:85], s[82:83]
  v_pk_add_f32 v[86:87], v[86:87], s[82:83]
  v_rcp_f32 v80, v80
  buffer_load_dwordx4 a[112:115], v1, s[44:47], s71 offen offset:3072 sc1
  v_rcp_f32 v81, v81
  v_rcp_f32 v82, v82
  v_rcp_f32 v83, v83
  v_rcp_f32 v84, v84
  v_rcp_f32 v85, v85
  v_rcp_f32 v86, v86
  v_rcp_f32 v87, v87
  s_add_u32 s74, s71, 4096
  s_add_u32 s71, s71, 5120
  buffer_load_dwordx4 a[116:119], v1, s[44:47], s74 offen sc1
  s_cmp_ge_u32 s71, s73
  s_cselect_b32 s74, 245760, 0
  s_sub_u32 s71, s71, s74
  v_pk_mul_f32 v[80:81], v[80:81], v[56:57]
  v_pk_mul_f32 v[82:83], v[82:83], v[58:59]
  v_pk_mul_f32 v[84:85], v[84:85], v[60:61]
  v_pk_mul_f32 v[86:87], v[86:87], v[62:63]
  v_cvt_pk_bf16_f32 v88, v80, v81
  v_cvt_pk_bf16_f32 v89, v82, v83
  v_cvt_pk_bf16_f32 v90, v84, v85
  v_cvt_pk_bf16_f32 v91, v86, v87
  s_add_u32 s75, s98, 8192
  buffer_store_dwordx4 v[88:91], v1, s[44:47], s75 offen sc1
  ds_write_b128 v97, v[88:91] offset:8192
  v_cvt_pk_bf16_f32 v12, v12, v12
  v_lshlrev_b32 v12, 16, v12
  v_mul_f32 v12, 0xbfb8aa3b, v12
  v_exp_f32 v12, v12
  s_nop 0
  v_add_f32 v12, 1.0, v12
  v_rcp_f32 v12, v12
  s_nop 0
  v_cvt_pk_bf16_f32 v12, v12, v12
  v_lshlrev_b32 v12, 16, v12
  v_sub_f32 v14, 1.0, v12
  v_cvt_pk_bf16_f32 v14, v14, v14
  v_lshlrev_b32 v14, 16, v14
  v_mov_b32 v13, v12
  v_mov_b32 v15, v14
  s_lshl_b32 s84, s4, 7
  s_lshl_b32 s86, s5, 4
  s_add_u32 s84, s84, s86
  s_lshl_b32 s86, s6, 2
  s_add_u32 s84, s84, s86
  s_lshl_b32 s84, s84, 6
  s_add_u32 s84, s84, 16408576
  s_mul_i32 s86, s6, 2560
  s_add_u32 s86, s86, 61440
  v_mov_b32 v10, s86
  v_lshl_add_u32 v10, v0, 3, v10
  v_and_b32 v208, 15, v0
  v_lshrrev_b32 v209, 2, v208
  v_lshlrev_b32 v209, 1, v209
  v_and_b32 v210, 1, v208
  v_or_b32 v209, v209, v210
  v_and_b32 v210, 2, v208
  v_lshl_add_u32 v208, v210, 4, v209
  v_mul_u32_u24 v208, 160, v208
  v_lshrrev_b32 v209, 4, v0
  v_lshl_add_u32 v208, v209, 3, v208
  v_add_u32 v11, s87, v208
  s_mov_b32 s85, 73728
  s_add_u32 s86, s85, s76
  v_add_u32 v160, s86, v1
  s_add_u32 s86, s85, s77
  v_add_u32 v161, s86, v1
  s_add_u32 s86, s85, s78
  v_add_u32 v162, s86, v1
  s_add_u32 s86, s85, s79
  v_add_u32 v163, s86, v1
  s_waitcnt lgkmcnt(0)
  s_barrier
  ds_read_b128 v[16:19], v160 offset:0
  ds_read_b128 v[20:23], v161 offset:0
  ds_read_b128 v[24:27], v162 offset:0
  ds_read_b128 v[28:31], v163 offset:0
  ds_read_b128 v[32:35], v160 offset:4096
  ds_read_b128 v[36:39], v161 offset:4096
  ds_read_b128 v[40:43], v162 offset:4096
  ds_read_b128 v[44:47], v163 offset:4096
  s_waitcnt vmcnt(35) lgkmcnt(4)
  v_mfma_f32_16x16x32_bf16 v[176:179], a[0:3], v[16:19], 0
  ds_read_b128 v[48:51], v160 offset:8192
  v_mfma_f32_16x16x32_bf16 v[180:183], a[4:7], v[16:19], 0
  ds_read_b128 v[52:55], v161 offset:8192
  buffer_load_dwordx4 a[120:123], v1, s[44:47], s71 offen offset:0 sc1
  v_mfma_f32_16x16x32_bf16 v[184:187], a[8:11], v[16:19], 0
  ds_read_b128 v[56:59], v162 offset:8192
  v_mfma_f32_16x16x32_bf16 v[188:191], a[12:15], v[16:19], 0
  ds_read_b128 v[60:63], v163 offset:8192
  buffer_load_dwordx4 a[124:127], v1, s[44:47], s71 offen offset:1024 sc1
  v_mfma_f32_16x16x32_bf16 v[192:195], a[16:19], v[16:19], 0
  v_mfma_f32_16x16x32_bf16 v[196:199], a[0:3], v[20:23], 0
  buffer_load_dwordx4 a[128:131], v1, s[44:47], s71 offen offset:2048 sc1
  v_mfma_f32_16x16x32_bf16 v[200:203], a[4:7], v[20:23], 0
  v_mfma_f32_16x16x32_bf16 v[204:207], a[8:11], v[20:23], 0
  buffer_load_dwordx4 a[132:135], v1, s[44:47], s71 offen offset:3072 sc1
  v_mfma_f32_16x16x32_bf16 v[208:211], a[12:15], v[20:23], 0
  v_mfma_f32_16x16x32_bf16 v[212:215], a[16:19], v[20:23], 0
  s_add_u32 s74, s71, 4096
  s_add_u32 s71, s71, 5120
  buffer_load_dwordx4 a[136:139], v1, s[44:47], s74 offen sc1
  s_cmp_ge_u32 s71, s73
  s_cselect_b32 s74, 245760, 0
  s_sub_u32 s71, s71, s74
  v_mfma_f32_16x16x32_bf16 v[216:219], a[0:3], v[24:27], 0
  v_mfma_f32_16x16x32_bf16 v[220:223], a[4:7], v[24:27], 0
  buffer_load_dwordx4 a[140:143], v1, s[44:47], s71 offen offset:0 sc1
  v_mfma_f32_16x16x32_bf16 v[224:227], a[8:11], v[24:27], 0
  v_mfma_f32_16x16x32_bf16 v[228:231], a[12:15], v[24:27], 0
  buffer_load_dwordx4 a[144:147], v1, s[44:47], s71 offen offset:1024 sc1
  v_mfma_f32_16x16x32_bf16 v[232:235], a[16:19], v[24:27], 0
  v_mfma_f32_16x16x32_bf16 v[236:239], a[0:3], v[28:31], 0
  buffer_load_dwordx4 a[148:151], v1, s[44:47], s71 offen offset:2048 sc1
  v_mfma_f32_16x16x32_bf16 v[240:243], a[4:7], v[28:31], 0
  v_mfma_f32_16x16x32_bf16 v[244:247], a[8:11], v[28:31], 0
  buffer_load_dwordx4 a[152:155], v1, s[44:47], s71 offen offset:3072 sc1
  v_mfma_f32_16x16x32_bf16 v[248:251], a[12:15], v[28:31], 0
  v_mfma_f32_16x16x32_bf16 v[252:255], a[16:19], v[28:31], 0
  s_add_u32 s74, s71, 4096
  s_add_u32 s71, s71, 5120
  buffer_load_dwordx4 a[156:159], v1, s[44:47], s74 offen sc1
  s_cmp_ge_u32 s71, s73
  s_cselect_b32 s74, 245760, 0
  s_sub_u32 s71, s71, s74
  s_waitcnt vmcnt(40) lgkmcnt(4)
  s_waitcnt vmcnt(10)
  s_mov_b64 exec, 1
  buffer_store_dword v7, off, s[44:47], s84 sc1
  s_mov_b64 exec, -1
  v_mfma_f32_16x16x32_bf16 v[176:179], a[20:23], v[32:35], v[176:179]
  ds_read_b128 v[64:67], v160 offset:12288
  v_mfma_f32_16x16x32_bf16 v[180:183], a[24:27], v[32:35], v[180:183]
  ds_read_b128 v[68:71], v161 offset:12288
  buffer_load_dwordx4 a[160:163], v1, s[44:47], s71 offen offset:0 sc1
  v_mfma_f32_16x16x32_bf16 v[184:187], a[28:31], v[32:35], v[184:187]
  ds_read_b128 v[72:75], v162 offset:12288
  v_mfma_f32_16x16x32_bf16 v[188:191], a[32:35], v[32:35], v[188:191]
  ds_read_b128 v[76:79], v163 offset:12288
  buffer_load_dwordx4 a[164:167], v1, s[44:47], s71 offen offset:1024 sc1
  v_mfma_f32_16x16x32_bf16 v[192:195], a[36:39], v[32:35], v[192:195]
  v_mfma_f32_16x16x32_bf16 v[196:199], a[20:23], v[36:39], v[196:199]
  buffer_load_dwordx4 a[168:171], v1, s[44:47], s71 offen offset:2048 sc1
  v_mfma_f32_16x16x32_bf16 v[200:203], a[24:27], v[36:39], v[200:203]
  v_mfma_f32_16x16x32_bf16 v[204:207], a[28:31], v[36:39], v[204:207]
  buffer_load_dwordx4 a[172:175], v1, s[44:47], s71 offen offset:3072 sc1
  v_mfma_f32_16x16x32_bf16 v[208:211], a[32:35], v[36:39], v[208:211]
  v_mfma_f32_16x16x32_bf16 v[212:215], a[36:39], v[36:39], v[212:215]
  s_add_u32 s74, s71, 4096
  s_add_u32 s71, s71, 5120
  buffer_load_dwordx4 a[176:179], v1, s[44:47], s74 offen sc1
  s_cmp_ge_u32 s71, s73
  s_cselect_b32 s74, 245760, 0
  s_sub_u32 s71, s71, s74
  v_mfma_f32_16x16x32_bf16 v[216:219], a[20:23], v[40:43], v[216:219]
  v_mfma_f32_16x16x32_bf16 v[220:223], a[24:27], v[40:43], v[220:223]
  buffer_load_dwordx4 a[180:183], v1, s[44:47], s71 offen offset:0 sc1
  v_mfma_f32_16x16x32_bf16 v[224:227], a[28:31], v[40:43], v[224:227]
  v_mfma_f32_16x16x32_bf16 v[228:231], a[32:35], v[40:43], v[228:231]
  buffer_load_dwordx4 a[184:187], v1, s[44:47], s71 offen offset:1024 sc1
  v_mfma_f32_16x16x32_bf16 v[232:235], a[36:39], v[40:43], v[232:235]
  v_mfma_f32_16x16x32_bf16 v[236:239], a[20:23], v[44:47], v[236:239]
  buffer_load_dwordx4 a[188:191], v1, s[44:47], s71 offen offset:2048 sc1
  v_mfma_f32_16x16x32_bf16 v[240:243], a[24:27], v[44:47], v[240:243]
  v_mfma_f32_16x16x32_bf16 v[244:247], a[28:31], v[44:47], v[244:247]
  buffer_load_dwordx4 a[192:195], v1, s[44:47], s71 offen offset:3072 sc1
  v_mfma_f32_16x16x32_bf16 v[248:251], a[32:35], v[44:47], v[248:251]
  v_mfma_f32_16x16x32_bf16 v[252:255], a[36:39], v[44:47], v[252:255]
  s_add_u32 s74, s71, 4096
L_st8:
  s_cbranch_execz L_hb2
  s_add_u32 s71, s71, 5120
  buffer_load_dwordx4 a[196:199], v1, s[44:47], s74 offen sc1
  s_cmp_ge_u32 s71, s73
  s_cselect_b32 s74, 245760, 0
  s_sub_u32 s71, s71, s74
  s_waitcnt vmcnt(46) lgkmcnt(4)
  v_mfma_f32_16x16x32_bf16 v[176:179], a[40:43], v[48:51], v[176:179]
  ds_read_b128 v[80:83], v160 offset:16384
  v_mfma_f32_16x16x32_bf16 v[180:183], a[44:47], v[48:51], v[180:183]
  ds_read_b128 v[84:87], v161 offset:16384
  buffer_load_dwordx4 a[200:203], v1, s[44:47], s71 offen offset:0 sc1
  v_mfma_f32_16x16x32_bf16 v[184:187], a[48:51], v[48:51], v[184:187]
  ds_read_b128 v[88:91], v162 offset:16384
  v_mfma_f32_16x16x32_bf16 v[188:191], a[52:55], v[48:51], v[188:191]
  ds_read_b128 v[92:95], v163 offset:16384
  buffer_load_dwordx4 a[204:207], v1, s[44:47], s71 offen offset:1024 sc1
  v_mfma_f32_16x16x32_bf16 v[192:195], a[56:59], v[48:51], v[192:195]
  v_mfma_f32_16x16x32_bf16 v[196:199], a[40:43], v[52:55], v[196:199]
  buffer_load_dwordx4 a[208:211], v1, s[44:47], s71 offen offset:2048 sc1
  v_mfma_f32_16x16x32_bf16 v[200:203], a[44:47], v[52:55], v[200:203]
  v_mfma_f32_16x16x32_bf16 v[204:207], a[48:51], v[52:55], v[204:207]
  buffer_load_dwordx4 a[212:215], v1, s[44:47], s71 offen offset:3072 sc1
  v_mfma_f32_16x16x32_bf16 v[208:211], a[52:55], v[52:55], v[208:211]
  v_mfma_f32_16x16x32_bf16 v[212:215], a[56:59], v[52:55], v[212:215]
  s_add_u32 s74, s71, 4096
  s_add_u32 s71, s71, 5120
  buffer_load_dwordx4 a[216:219], v1, s[44:47], s74 offen sc1
  s_cmp_ge_u32 s71, s73
  s_cselect_b32 s74, 245760, 0
  s_sub_u32 s71, s71, s74
  v_mfma_f32_16x16x32_bf16 v[216:219], a[40:43], v[56:59], v[216:219]
  v_mfma_f32_16x16x32_bf16 v[220:223], a[44:47], v[56:59], v[220:223]
  buffer_load_dwordx4 a[220:223], v1, s[44:47], s71 offen offset:0 sc1
  v_mfma_f32_16x16x32_bf16 v[224:227], a[48:51], v[56:59], v[224:227]
  v_mfma_f32_16x16x32_bf16 v[228:231], a[52:55], v[56:59], v[228:231]
  buffer_load_dwordx4 a[224:227], v1, s[44:47], s71 offen offset:1024 sc1
  v_mfma_f32_16x16x32_bf16 v[232:235], a[56:59], v[56:59], v[232:235]
  v_mfma_f32_16x16x32_bf16 v[236:239], a[40:43], v[60:63], v[236:239]
  buffer_load_dwordx4 a[228:231], v1, s[44:47], s71 offen offset:2048 sc1
  v_mfma_f32_16x16x32_bf16 v[240:243], a[44:47], v[60:63], v[240:243]
  v_mfma_f32_16x16x32_bf16 v[244:247], a[48:51], v[60:63], v[244:247]
  buffer_load_dwordx4 a[232:235], v1, s[44:47], s71 offen offset:3072 sc1
  v_mfma_f32_16x16x32_bf16 v[248:251], a[52:55], v[60:63], v[248:251]
  v_mfma_f32_16x16x32_bf16 v[252:255], a[56:59], v[60:63], v[252:255]
  s_add_u32 s74, s71, 4096
  s_add_u32 s71, s71, 5120
  buffer_load_dwordx4 a[236:239], v1, s[44:47], s74 offen sc1
  s_cmp_ge_u32 s71, s73
  s_cselect_b32 s74, 245760, 0
  s_sub_u32 s71, s71, s74
  s_waitcnt vmcnt(44) lgkmcnt(4)
  v_mfma_f32_16x16x32_bf16 v[176:179], a[60:63], v[64:67], v[176:179]
  ds_read_b128 v[96:99], v160 offset:20480
  v_mfma_f32_16x16x32_bf16 v[180:183], a[64:67], v[64:67], v[180:183]
  ds_read_b128 v[100:103], v161 offset:20480
  buffer_load_dwordx4 a[0:3], v1, s[44:47], s71 offen offset:0 sc1
  v_mfma_f32_16x16x32_bf16 v[184:187], a[68:71], v[64:67], v[184:187]
  ds_read_b128 v[104:107], v162 offset:20480
  v_mfma_f32_16x16x32_bf16 v[188:191], a[72:75], v[64:67], v[188:191]
  ds_read_b128 v[108:111], v163 offset:20480
  buffer_load_dwordx4 a[4:7], v1, s[44:47], s71 offen offset:1024 sc1
  v_mfma_f32_16x16x32_bf16 v[192:195], a[76:79], v[64:67], v[192:195]
  v_mfma_f32_16x16x32_bf16 v[196:199], a[60:63], v[68:71], v[196:199]
  buffer_load_dwordx4 a[8:11], v1, s[44:47], s71 offen offset:2048 sc1
  v_mfma_f32_16x16x32_bf16 v[200:203], a[64:67], v[68:71], v[200:203]
  v_mfma_f32_16x16x32_bf16 v[204:207], a[68:71], v[68:71], v[204:207]
  buffer_load_dwordx4 a[12:15], v1, s[44:47], s71 offen offset:3072 sc1
  v_mfma_f32_16x16x32_bf16 v[208:211], a[72:75], v[68:71], v[208:211]
  v_mfma_f32_16x16x32_bf16 v[212:215], a[76:79], v[68:71], v[212:215]
  s_add_u32 s74, s71, 4096
  s_add_u32 s71, s71, 5120
  buffer_load_dwordx4 a[16:19], v1, s[44:47], s74 offen sc1
  s_cmp_ge_u32 s71, s73
  s_cselect_b32 s74, 245760, 0
  s_sub_u32 s71, s71, s74
  v_mfma_f32_16x16x32_bf16 v[216:219], a[60:63], v[72:75], v[216:219]
  v_mfma_f32_16x16x32_bf16 v[220:223], a[64:67], v[72:75], v[220:223]
  buffer_load_dwordx4 a[20:23], v1, s[44:47], s71 offen offset:0 sc1
  v_mfma_f32_16x16x32_bf16 v[224:227], a[68:71], v[72:75], v[224:227]
  v_mfma_f32_16x16x32_bf16 v[228:231], a[72:75], v[72:75], v[228:231]
  buffer_load_dwordx4 a[24:27], v1, s[44:47], s71 offen offset:1024 sc1
  v_mfma_f32_16x16x32_bf16 v[232:235], a[76:79], v[72:75], v[232:235]
  v_mfma_f32_16x16x32_bf16 v[236:239], a[60:63], v[76:79], v[236:239]
  buffer_load_dwordx4 a[28:31], v1, s[44:47], s71 offen offset:2048 sc1
  v_mfma_f32_16x16x32_bf16 v[240:243], a[64:67], v[76:79], v[240:243]
  v_mfma_f32_16x16x32_bf16 v[244:247], a[68:71], v[76:79], v[244:247]
  buffer_load_dwordx4 a[32:35], v1, s[44:47], s71 offen offset:3072 sc1
  v_mfma_f32_16x16x32_bf16 v[248:251], a[72:75], v[76:79], v[248:251]
  v_mfma_f32_16x16x32_bf16 v[252:255], a[76:79], v[76:79], v[252:255]
  s_add_u32 s74, s71, 4096
  s_add_u32 s71, s71, 5120
  buffer_load_dwordx4 a[36:39], v1, s[44:47], s74 offen sc1
  s_cmp_ge_u32 s71, s73
  s_cselect_b32 s74, 245760, 0
  s_sub_u32 s71, s71, s74
  s_waitcnt vmcnt(48) lgkmcnt(4)
  v_mov_b32 v5, v7
  s_mov_b32 exec_lo, 0xff
  s_mov_b32 exec_hi, 0
  buffer_load_dword v5, v3, s[44:47], 0 offen sc1
  s_mov_b64 exec, -1
  v_mfma_f32_16x16x32_bf16 v[176:179], a[80:83], v[80:83], v[176:179]
  v_mfma_f32_16x16x32_bf16 v[180:183], a[84:87], v[80:83], v[180:183]
  buffer_load_dwordx4 a[40:43], v1, s[44:47], s71 offen offset:0 sc1
  v_mfma_f32_16x16x32_bf16 v[184:187], a[88:91], v[80:83], v[184:187]
  v_mfma_f32_16x16x32_bf16 v[188:191], a[92:95], v[80:83], v[188:191]
  buffer_load_dwordx4 a[44:47], v1, s[44:47], s71 offen offset:1024 sc1
  v_mfma_f32_16x16x32_bf16 v[192:195], a[96:99], v[80:83], v[192:195]
  v_mfma_f32_16x16x32_bf16 v[196:199], a[80:83], v[84:87], v[196:199]
  buffer_load_dwordx4 a[48:51], v1, s[44:47], s71 offen offset:2048 sc1
  v_mfma_f32_16x16x32_bf16 v[200:203], a[84:87], v[84:87], v[200:203]
  v_mfma_f32_16x16x32_bf16 v[204:207], a[88:91], v[84:87], v[204:207]
  buffer_load_dwordx4 a[52:55], v1, s[44:47], s71 offen offset:3072 sc1
  v_mfma_f32_16x16x32_bf16 v[208:211], a[92:95], v[84:87], v[208:211]
  v_mfma_f32_16x16x32_bf16 v[212:215], a[96:99], v[84:87], v[212:215]
  s_add_u32 s74, s71, 4096
  s_add_u32 s71, s71, 5120
  buffer_load_dwordx4 a[56:59], v1, s[44:47], s74 offen sc1
  s_cmp_ge_u32 s71, s73
  s_cselect_b32 s74, 245760, 0
  s_sub_u32 s71, s71, s74
  v_mfma_f32_16x16x32_bf16 v[216:219], a[80:83], v[88:91], v[216:219]
  v_mfma_f32_16x16x32_bf16 v[220:223], a[84:87], v[88:91], v[220:223]
  buffer_load_dwordx4 a[60:63], v1, s[44:47], s71 offen offset:0 sc1
  v_mfma_f32_16x16x32_bf16 v[224:227], a[88:91], v[88:91], v[224:227]
  v_mfma_f32_16x16x32_bf16 v[228:231], a[92:95], v[88:91], v[228:231]
  buffer_load_dwordx4 a[64:67], v1, s[44:47], s71 offen offset:1024 sc1
  v_mfma_f32_16x16x32_bf16 v[232:235], a[96:99], v[88:91], v[232:235]
  v_mfma_f32_16x16x32_bf16 v[236:239], a[80:83], v[92:95], v[236:239]
  buffer_load_dwordx4 a[68:71], v1, s[44:47], s71 offen offset:2048 sc1
  v_mfma_f32_16x16x32_bf16 v[240:243], a[84:87], v[92:95], v[240:243]
  v_mfma_f32_16x16x32_bf16 v[244:247], a[88:91], v[92:95], v[244:247]
  buffer_load_dwordx4 a[72:75], v1, s[44:47], s71 offen offset:3072 sc1
  v_mfma_f32_16x16x32_bf16 v[248:251], a[92:95], v[92:95], v[248:251]
  v_mfma_f32_16x16x32_bf16 v[252:255], a[96:99], v[92:95], v[252:255]
  s_add_u32 s74, s71, 4096
  s_add_u32 s71, s71, 5120
  buffer_load_dwordx4 a[76:79], v1, s[44:47], s74 offen sc1
  s_cmp_ge_u32 s71, s73
  s_cselect_b32 s74, 245760, 0
  s_sub_u32 s71, s71, s74
  s_waitcnt vmcnt(53) lgkmcnt(0)
  s_waitcnt vmcnt(10)
  v_cmp_ne_u32 vcc, s61, v5
  s_cbranch_vccnz L_spin_Bi3
L_ret_Bi3:
  v_mfma_f32_16x16x32_bf16 v[176:179], a[100:103], v[96:99], v[176:179]
  v_mfma_f32_16x16x32_bf16 v[180:183], a[104:107], v[96:99], v[180:183]
  s_add_u32 s75, s48, s76
  buffer_load_dwordx4 v[112:115], v1, s[44:47], s75 offen sc1
  v_mfma_f32_16x16x32_bf16 v[184:187], a[108:111], v[96:99], v[184:187]
  v_mfma_f32_16x16x32_bf16 v[188:191], a[112:115], v[96:99], v[188:191]
  s_add_u32 s75, s48, s77
  buffer_load_dwordx4 v[116:119], v1, s[44:47], s75 offen sc1
  v_mfma_f32_16x16x32_bf16 v[192:195], a[116:119], v[96:99], v[192:195]
  v_mfma_f32_16x16x32_bf16 v[196:199], a[100:103], v[100:103], v[196:199]
  s_add_u32 s75, s48, s78
  buffer_load_dwordx4 v[120:123], v1, s[44:47], s75 offen sc1
  v_mfma_f32_16x16x32_bf16 v[200:203], a[104:107], v[100:103], v[200:203]
  v_mfma_f32_16x16x32_bf16 v[204:207], a[108:111], v[100:103], v[204:207]
  s_add_u32 s75, s48, s79
  buffer_load_dwordx4 v[124:127], v1, s[44:47], s75 offen sc1
  s_add_u32 s48, s48, 4096
  s_cmp_eq_u32 s48, s59
  s_cselect_b32 s48, s58, s48
  v_mfma_f32_16x16x32_bf16 v[208:211], a[112:115], v[100:103], v[208:211]
  v_mfma_f32_16x16x32_bf16 v[212:215], a[116:119], v[100:103], v[212:215]
  s_add_u32 s75, s48, s76
  buffer_load_dwordx4 v[128:131], v1, s[44:47], s75 offen sc1
  v_mfma_f32_16x16x32_bf16 v[216:219], a[100:103], v[104:107], v[216:219]
  v_mfma_f32_16x16x32_bf16 v[220:223], a[104:107], v[104:107], v[220:223]
  s_add_u32 s75, s48, s77
  buffer_load_dwordx4 v[132:135], v1, s[44:47], s75 offen sc1
  v_mfma_f32_16x16x32_bf16 v[224:227], a[108:111], v[104:107], v[224:227]
  v_mfma_f32_16x16x32_bf16 v[228:231], a[112:115], v[104:107], v[228:231]
  s_add_u32 s75, s48, s78
  buffer_load_dwordx4 v[136:139], v1, s[44:47], s75 offen sc1
  v_mfma_f32_16x16x32_bf16 v[232:235], a[116:119], v[104:107], v[232:235]
  v_mfma_f32_16x16x32_bf16 v[236:239], a[100:103], v[108:111], v[236:239]
  s_add_u32 s75, s48, s79
  buffer_load_dwordx4 v[140:143], v1, s[44:47], s75 offen sc1
  s_add_u32 s48, s48, 4096
  s_cmp_eq_u32 s48, s59
  s_cselect_b32 s48, s58, s48
  v_mfma_f32_16x16x32_bf16 v[240:243], a[104:107], v[108:111], v[240:243]
  v_mfma_f32_16x16x32_bf16 v[244:247], a[108:111], v[108:111], v[244:247]
  s_add_u32 s75, s48, s76
  buffer_load_dwordx4 v[144:147], v1, s[44:47], s75 offen sc1
  v_mfma_f32_16x16x32_bf16 v[248:251], a[112:115], v[108:111], v[248:251]
  v_mfma_f32_16x16x32_bf16 v[252:255], a[116:119], v[108:111], v[252:255]
  s_add_u32 s75, s48, s77
  buffer_load_dwordx4 v[148:151], v1, s[44:47], s75 offen sc1
  s_add_u32 s75, s48, s78
  buffer_load_dwordx4 v[152:155], v1, s[44:47], s75 offen sc1
  s_add_u32 s75, s48, s79
  buffer_load_dwordx4 v[156:159], v1, s[44:47], s75 offen sc1
  s_add_u32 s48, s48, 4096
  s_cmp_eq_u32 s48, s59
  s_cselect_b32 s48, s58, s48
  s_add_u32 s75, s48, s76
  buffer_load_dwordx4 v[160:163], v1, s[44:47], s75 offen sc1
  s_add_u32 s75, s48, s77
  buffer_load_dwordx4 v[164:167], v1, s[44:47], s75 offen sc1
  s_add_u32 s75, s48, s78
  buffer_load_dwordx4 v[168:171], v1, s[44:47], s75 offen sc1
  s_add_u32 s75, s48, s79
  buffer_load_dwordx4 v[172:175], v1, s[44:47], s75 offen sc1
  s_add_u32 s48, s48, 4096
  s_cmp_eq_u32 s48, s59
  s_cselect_b32 s48, s58, s48
  s_waitcnt vmcnt(15)
  v_mfma_f32_16x16x32_bf16 v[176:179], a[120:123], v[112:115], v[176:179]
  v_mfma_f32_16x16x32_bf16 v[180:183], a[124:127], v[112:115], v[180:183]
  buffer_load_dwordx4 a[80:83], v1, s[44:47], s71 offen offset:0 sc1
  v_mfma_f32_16x16x32_bf16 v[184:187], a[128:131], v[112:115], v[184:187]
  v_mfma_f32_16x16x32_bf16 v[188:191], a[132:135], v[112:115], v[188:191]
  s_add_u32 s75, s48, s76
  buffer_load_dwordx4 v[16:19], v1, s[44:47], s75 offen sc1
  v_mfma_f32_16x16x32_bf16 v[192:195], a[136:139], v[112:115], v[192:195]
  s_waitcnt vmcnt(16)
  v_mfma_f32_16x16x32_bf16 v[196:199], a[120:123], v[116:119], v[196:199]
  buffer_load_dwordx4 a[84:87], v1, s[44:47], s71 offen offset:1024 sc1
  v_mfma_f32_16x16x32_bf16 v[200:203], a[124:127], v[116:119], v[200:203]
  v_mfma_f32_16x16x32_bf16 v[204:207], a[128:131], v[116:119], v[204:207]
  s_add_u32 s75, s48, s77
  buffer_load_dwordx4 v[20:23], v1, s[44:47], s75 offen sc1
  v_mfma_f32_16x16x32_bf16 v[208:211], a[132:135], v[116:119], v[208:211]
  v_mfma_f32_16x16x32_bf16 v[212:215], a[136:139], v[116:119], v[212:215]
  buffer_load_dwordx4 a[88:91], v1, s[44:47], s71 offen offset:2048 sc1
  s_waitcnt vmcnt(18)
  v_mfma_f32_16x16x32_bf16 v[216:219], a[120:123], v[120:123], v[216:219]
  v_mfma_f32_16x16x32_bf16 v[220:223], a[124:127], v[120:123], v[220:223]
  s_add_u32 s75, s48, s78
  buffer_load_dwordx4 v[24:27], v1, s[44:47], s75 offen sc1
  v_mfma_f32_16x16x32_bf16 v[224:227], a[128:131], v[120:123], v[224:227]
  v_mfma_f32_16x16x32_bf16 v[228:231], a[132:135], v[120:123], v[228:231]
  buffer_load_dwordx4 a[92:95], v1, s[44:47], s71 offen offset:3072 sc1
  v_mfma_f32_16x16x32_bf16 v[232:235], a[136:139], v[120:123], v[232:235]
  s_waitcnt vmcnt(19)
  v_mfma_f32_16x16x32_bf16 v[236:239], a[120:123], v[124:127], v[236:239]
  s_add_u32 s75, s48, s79
  buffer_load_dwordx4 v[28:31], v1, s[44:47], s75 offen sc1
  s_add_u32 s48, s48, 4096
  s_cmp_eq_u32 s48, s59
  s_cselect_b32 s48, s58, s48
  v_mfma_f32_16x16x32_bf16 v[240:243], a[124:127], v[124:127], v[240:243]
  v_mfma_f32_16x16x32_bf16 v[244:247], a[128:131], v[124:127], v[244:247]
  s_add_u32 s74, s71, 4096
  s_add_u32 s71, s71, 5120
  buffer_load_dwordx4 a[96:99], v1, s[44:47], s74 offen sc1
  s_cmp_ge_u32 s71, s73
  s_cselect_b32 s74, 245760, 0
  s_sub_u32 s71, s71, s74
  v_mfma_f32_16x16x32_bf16 v[248:251], a[132:135], v[124:127], v[248:251]
  v_mfma_f32_16x16x32_bf16 v[252:255], a[136:139], v[124:127], v[252:255]
  s_add_u32 s75, s48, s76
  buffer_load_dwordx4 v[32:35], v1, s[44:47], s75 offen sc1
  s_waitcnt vmcnt(21)
  v_mfma_f32_16x16x32_bf16 v[176:179], a[140:143], v[128:131], v[176:179]
  v_mfma_f32_16x16x32_bf16 v[180:183], a[144:147], v[128:131], v[180:183]
  buffer_load_dwordx4 a[100:103], v1, s[44:47], s71 offen offset:0 sc1
  v_mfma_f32_16x16x32_bf16 v[184:187], a[148:151], v[128:131], v[184:187]
  v_mfma_f32_16x16x32_bf16 v[188:191], a[152:155], v[128:131], v[188:191]
  s_add_u32 s75, s48, s77
  buffer_load_dwordx4 v[36:39], v1, s[44:47], s75 offen sc1
  v_mfma_f32_16x16x32_bf16 v[192:195], a[156:159], v[128:131], v[192:195]
  s_waitcnt vmcnt(22)
  v_mfma_f32_16x16x32_bf16 v[196:199], a[140:143], v[132:135], v[196:199]
  buffer_load_dwordx4 a[104:107], v1, s[44:47], s71 offen offset:1024 sc1
  v_mfma_f32_16x16x32_bf16 v[200:203], a[144:147], v[132:135], v[200:203]
  v_mfma_f32_16x16x32_bf16 v[204:207], a[148:151], v[132:135], v[204:207]
  s_add_u32 s75, s48, s78
  buffer_load_dwordx4 v[40:43], v1, s[44:47], s75 offen sc1
  v_mfma_f32_16x16x32_bf16 v[208:211], a[152:155], v[132:135], v[208:211]
  v_mfma_f32_16x16x32_bf16 v[212:215], a[156:159], v[132:135], v[212:215]
  buffer_load_dwordx4 a[108:111], v1, s[44:47], s71 offen offset:2048 sc1
  s_waitcnt vmcnt(24)
  v_mfma_f32_16x16x32_bf16 v[216:219], a[140:143], v[136:139], v[216:219]
  v_mfma_f32_16x16x32_bf16 v[220:223], a[144:147], v[136:139], v[220:223]
  s_add_u32 s75, s48, s79
  buffer_load_dwordx4 v[44:47], v1, s[44:47], s75 offen sc1
  s_add_u32 s48, s48, 4096
  s_cmp_eq_u32 s48, s59
  s_cselect_b32 s48, s58, s48
  v_mfma_f32_16x16x32_bf16 v[224:227], a[148:151], v[136:139], v[224:227]
  v_mfma_f32_16x16x32_bf16 v[228:231], a[152:155], v[136:139], v[228:231]
  buffer_load_dwordx4 a[112:115], v1, s[44:47], s71 offen offset:3072 sc1
  v_mfma_f32_16x16x32_bf16 v[232:235], a[156:159], v[136:139], v[232:235]
  s_waitcnt vmcnt(25)
  v_mfma_f32_16x16x32_bf16 v[236:239], a[140:143], v[140:143], v[236:239]
  s_add_u32 s75, s48, s76
  buffer_load_dwordx4 v[48:51], v1, s[44:47], s75 offen sc1
  v_mfma_f32_16x16x32_bf16 v[240:243], a[144:147], v[140:143], v[240:243]
  v_mfma_f32_16x16x32_bf16 v[244:247], a[148:151], v[140:143], v[244:247]
  s_add_u32 s74, s71, 4096
  s_add_u32 s71, s71, 5120
  buffer_load_dwordx4 a[116:119], v1, s[44:47], s74 offen sc1
  s_cmp_ge_u32 s71, s73
  s_cselect_b32 s74, 245760, 0
  s_sub_u32 s71, s71, s74
  v_mfma_f32_16x16x32_bf16 v[248:251], a[152:155], v[140:143], v[248:251]
  v_mfma_f32_16x16x32_bf16 v[252:255], a[156:159], v[140:143], v[252:255]
  s_add_u32 s75, s48, s77
  buffer_load_dwordx4 v[52:55], v1, s[44:47], s75 offen sc1
  s_waitcnt vmcnt(27)
  v_mfma_f32_16x16x32_bf16 v[176:179], a[160:163], v[144:147], v[176:179]
  v_mfma_f32_16x16x32_bf16 v[180:183], a[164:167], v[144:147], v[180:183]
  v_mfma_f32_16x16x32_bf16 v[184:187], a[168:171], v[144:147], v[184:187]
  v_mfma_f32_16x16x32_bf16 v[188:191], a[172:175], v[144:147], v[188:191]
  s_add_u32 s75, s48, s78
  buffer_load_dwordx4 v[56:59], v1, s[44:47], s75 offen sc1
  v_mfma_f32_16x16x32_bf16 v[192:195], a[176:179], v[144:147], v[192:195]
  s_waitcnt vmcnt(27)
  v_mfma_f32_16x16x32_bf16 v[196:199], a[160:163], v[148:151], v[196:199]
  v_mfma_f32_16x16x32_bf16 v[200:203], a[164:167], v[148:151], v[200:203]
  v_mfma_f32_16x16x32_bf16 v[204:207], a[168:171], v[148:151], v[204:207]
  s_add_u32 s75, s48, s79
  buffer_load_dwordx4 v[60:63], v1, s[44:47], s75 offen sc1
  s_add_u32 s48, s48, 4096
  s_cmp_eq_u32 s48, s59
  s_cselect_b32 s48, s58, s48
  v_mfma_f32_16x16x32_bf16 v[208:211], a[172:175], v[148:151], v[208:211]
  v_mfma_f32_16x16x32_bf16 v[212:215], a[176:179], v[148:151], v[212:215]
  s_waitcnt vmcnt(27)
  v_mfma_f32_16x16x32_bf16 v[216:219], a[160:163], v[152:155], v[216:219]
  v_mfma_f32_16x16x32_bf16 v[220:223], a[164:167], v[152:155], v[220:223]
  s_add_u32 s75, s48, s76
  buffer_load_dwordx4 v[64:67], v1, s[44:47], s75 offen sc1
  v_mfma_f32_16x16x32_bf16 v[224:227], a[168:171], v[152:155], v[224:227]
  v_mfma_f32_16x16x32_bf16 v[228:231], a[172:175], v[152:155], v[228:231]
  v_mfma_f32_16x16x32_bf16 v[232:235], a[176:179], v[152:155], v[232:235]
  s_waitcnt vmcnt(27)
  v_mfma_f32_16x16x32_bf16 v[236:239], a[160:163], v[156:159], v[236:239]
  s_add_u32 s75, s48, s77
  buffer_load_dwordx4 v[68:71], v1, s[44:47], s75 offen sc1
  v_mfma_f32_16x16x32_bf16 v[240:243], a[164:167], v[156:159], v[240:243]
  v_mfma_f32_16x16x32_bf16 v[244:247], a[168:171], v[156:159], v[244:247]
  v_mfma_f32_16x16x32_bf16 v[248:251], a[172:175], v[156:159], v[248:251]
  v_mfma_f32_16x16x32_bf16 v[252:255], a[176:179], v[156:159], v[252:255]
  s_add_u32 s75, s48, s78
  buffer_load_dwordx4 v[72:75], v1, s[44:47], s75 offen sc1
  s_waitcnt vmcnt(28)
  v_mfma_f32_16x16x32_bf16 v[176:179], a[180:183], v[160:163], v[176:179]
  v_mfma_f32_16x16x32_bf16 v[180:183], a[184:187], v[160:163], v[180:183]
  v_mfma_f32_16x16x32_bf16 v[184:187], a[188:191], v[160:163], v[184:187]
  v_mfma_f32_16x16x32_bf16 v[188:191], a[192:195], v[160:163], v[188:191]
  s_add_u32 s75, s48, s79
  buffer_load_dwordx4 v[76:79], v1, s[44:47], s75 offen sc1
  s_add_u32 s48, s48, 4096
  s_cmp_eq_u32 s48, s59
  s_cselect_b32 s48, s58, s48
  v_mfma_f32_16x16x32_bf16 v[192:195], a[196:199], v[160:163], v[192:195]
  s_waitcnt vmcnt(28)
  v_mfma_f32_16x16x32_bf16 v[196:199], a[180:183], v[164:167], v[196:199]
  v_mfma_f32_16x16x32_bf16 v[200:203], a[184:187], v[164:167], v[200:203]
  v_mfma_f32_16x16x32_bf16 v[204:207], a[188:191], v[164:167], v[204:207]
  s_add_u32 s75, s48, s76
  buffer_load_dwordx4 v[80:83], v1, s[44:47], s75 offen sc1
  v_mfma_f32_16x16x32_bf16 v[208:211], a[192:195], v[164:167], v[208:211]
  v_mfma_f32_16x16x32_bf16 v[212:215], a[196:199], v[164:167], v[212:215]
  s_waitcnt vmcnt(28)
  v_mfma_f32_16x16x32_bf16 v[216:219], a[180:183], v[168:171], v[216:219]
  v_mfma_f32_16x16x32_bf16 v[220:223], a[184:187], v[168:171], v[220:223]
  s_add_u32 s75, s48, s77
  buffer_load_dwordx4 v[84:87], v1, s[44:47], s75 offen sc1
  v_mfma_f32_16x16x32_bf16 v[224:227], a[188:191], v[168:171], v[224:227]
  v_mfma_f32_16x16x32_bf16 v[228:231], a[192:195], v[168:171], v[228:231]
  v_mfma_f32_16x16x32_bf16 v[232:235], a[196:199], v[168:171], v[232:235]
  s_waitcnt vmcnt(28)
  v_mfma_f32_16x16x32_bf16 v[236:239], a[180:183], v[172:175], v[236:239]
  s_add_u32 s75, s48, s78
  buffer_load_dwordx4 v[88:91], v1, s[44:47], s75 offen sc1
  v_mfma_f32_16x16x32_bf16 v[240:243], a[184:187], v[172:175], v[240:243]
  v_mfma_f32_16x16x32_bf16 v[244:247], a[188:191], v[172:175], v[244:247]
  v_mfma_f32_16x16x32_bf16 v[248:251], a[192:195], v[172:175], v[248:251]
  v_mfma_f32_16x16x32_bf16 v[252:255], a[196:199], v[172:175], v[252:255]
  s_add_u32 s75, s48, s79
  buffer_load_dwordx4 v[92:95], v1, s[44:47], s75 offen sc1
  s_add_u32 s48, s48, 4096
  s_cmp_eq_u32 s48, s59
  s_cselect_b32 s48, s58, s48
  s_waitcnt vmcnt(28)
  v_mfma_f32_16x16x32_bf16 v[176:179], a[200:203], v[16:19], v[176:179]
  v_mfma_f32_16x16x32_bf16 v[180:183], a[204:207], v[16:19], v[180:183]
  v_mfma_f32_16x16x32_bf16 v[184:187], a[208:211], v[16:19], v[184:187]
  v_mfma_f32_16x16x32_bf16 v[188:191], a[212:215], v[16:19], v[188:191]
  s_add_u32 s75, s48, s76
  buffer_load_dwordx4 v[96:99], v1, s[44:47], s75 offen sc1
  v_mfma_f32_16x16x32_bf16 v[192:195], a[216:219], v[16:19], v[192:195]
  s_waitcnt vmcnt(27)
  v_mfma_f32_16x16x32_bf16 v[196:199], a[200:203], v[20:23], v[196:199]
  v_mfma_f32_16x16x32_bf16 v[200:203], a[204:207], v[20:23], v[200:203]
  v_mfma_f32_16x16x32_bf16 v[204:207], a[208:211], v[20:23], v[204:207]
  s_add_u32 s75, s48, s77
  buffer_load_dwordx4 v[100:103], v1, s[44:47], s75 offen sc1
  v_mfma_f32_16x16x32_bf16 v[208:211], a[212:215], v[20:23], v[208:211]
  v_mfma_f32_16x16x32_bf16 v[212:215], a[216:219], v[20:23], v[212:215]
  s_waitcnt vmcnt(26)
  v_mfma_f32_16x16x32_bf16 v[216:219], a[200:203], v[24:27], v[216:219]
  v_mfma_f32_16x16x32_bf16 v[220:223], a[204:207], v[24:27], v[220:223]
  s_add_u32 s75, s48, s78
  buffer_load_dwordx4 v[104:107], v1, s[44:47], s75 offen sc1
  v_mfma_f32_16x16x32_bf16 v[224:227], a[208:211], v[24:27], v[224:227]
  v_mfma_f32_16x16x32_bf16 v[228:231], a[212:215], v[24:27], v[228:231]
  v_mfma_f32_16x16x32_bf16 v[232:235], a[216:219], v[24:27], v[232:235]
  s_waitcnt vmcnt(25)
  v_mfma_f32_16x16x32_bf16 v[236:239], a[200:203], v[28:31], v[236:239]
  s_add_u32 s75, s48, s79
  buffer_load_dwordx4 v[108:111], v1, s[44:47], s75 offen sc1
  s_add_u32 s48, s48, 4096
  s_cmp_eq_u32 s48, s59
  s_cselect_b32 s48, s58, s48
  v_mfma_f32_16x16x32_bf16 v[240:243], a[204:207], v[28:31], v[240:243]
  v_mfma_f32_16x16x32_bf16 v[244:247], a[208:211], v[28:31], v[244:247]
  v_mfma_f32_16x16x32_bf16 v[248:251], a[212:215], v[28:31], v[248:251]
  v_mfma_f32_16x16x32_bf16 v[252:255], a[216:219], v[28:31], v[252:255]
  s_add_u32 s75, s48, s76
  buffer_load_dwordx4 v[112:115], v1, s[44:47], s75 offen sc1
  s_waitcnt vmcnt(25)
  v_mfma_f32_16x16x32_bf16 v[176:179], a[220:223], v[32:35], v[176:179]
  v_mfma_f32_16x16x32_bf16 v[180:183], a[224:227], v[32:35], v[180:183]
  v_mfma_f32_16x16x32_bf16 v[184:187], a[228:231], v[32:35], v[184:187]
  v_mfma_f32_16x16x32_bf16 v[188:191], a[232:235], v[32:35], v[188:191]
  s_add_u32 s75, s48, s77
  buffer_load_dwordx4 v[116:119], v1, s[44:47], s75 offen sc1
  v_mfma_f32_16x16x32_bf16 v[192:195], a[236:239], v[32:35], v[192:195]
  s_waitcnt vmcnt(24)
  v_mfma_f32_16x16x32_bf16 v[196:199], a[220:223], v[36:39], v[196:199]
  v_mfma_f32_16x16x32_bf16 v[200:203], a[224:227], v[36:39], v[200:203]
  v_mfma_f32_16x16x32_bf16 v[204:207], a[228:231], v[36:39], v[204:207]
  s_add_u32 s75, s48, s78
  buffer_load_dwordx4 v[120:123], v1, s[44:47], s75 offen sc1
  v_mfma_f32_16x16x32_bf16 v[208:211], a[232:235], v[36:39], v[208:211]
  v_mfma_f32_16x16x32_bf16 v[212:215], a[236:239], v[36:39], v[212:215]
  s_waitcnt vmcnt(23)
  v_mfma_f32_16x16x32_bf16 v[216:219], a[220:223], v[40:43], v[216:219]
  v_mfma_f32_16x16x32_bf16 v[220:223], a[224:227], v[40:43], v[220:223]
  s_add_u32 s75, s48, s79
  buffer_load_dwordx4 v[124:127], v1, s[44:47], s75 offen sc1
  s_add_u32 s48, s48, 4096
  s_cmp_eq_u32 s48, s59
  s_cselect_b32 s48, s58, s48
  v_mfma_f32_16x16x32_bf16 v[224:227], a[228:231], v[40:43], v[224:227]
  v_mfma_f32_16x16x32_bf16 v[228:231], a[232:235], v[40:43], v[228:231]
  v_mfma_f32_16x16x32_bf16 v[232:235], a[236:239], v[40:43], v[232:235]
  s_waitcnt vmcnt(22)
  v_mfma_f32_16x16x32_bf16 v[236:239], a[220:223], v[44:47], v[236:239]
  s_add_u32 s75, s48, s76
  buffer_load_dwordx4 v[128:131], v1, s[44:47], s75 offen sc1
  v_mfma_f32_16x16x32_bf16 v[240:243], a[224:227], v[44:47], v[240:243]
  v_mfma_f32_16x16x32_bf16 v[244:247], a[228:231], v[44:47], v[244:247]
  v_mfma_f32_16x16x32_bf16 v[248:251], a[232:235], v[44:47], v[248:251]
  v_mfma_f32_16x16x32_bf16 v[252:255], a[236:239], v[44:47], v[252:255]
  s_add_u32 s75, s48, s77
  buffer_load_dwordx4 v[132:135], v1, s[44:47], s75 offen sc1
  s_waitcnt vmcnt(22)
  v_mfma_f32_16x16x32_bf16 v[176:179], a[0:3], v[48:51], v[176:179]
  v_mfma_f32_16x16x32_bf16 v[180:183], a[4:7], v[48:51], v[180:183]
  v_mfma_f32_16x16x32_bf16 v[184:187], a[8:11], v[48:51], v[184:187]
  v_mfma_f32_16x16x32_bf16 v[188:191], a[12:15], v[48:51], v[188:191]
  s_add_u32 s75, s48, s78
  buffer_load_dwordx4 v[136:139], v1, s[44:47], s75 offen sc1
  v_mfma_f32_16x16x32_bf16 v[192:195], a[16:19], v[48:51], v[192:195]
  s_waitcnt vmcnt(21)
  v_mfma_f32_16x16x32_bf16 v[196:199], a[0:3], v[52:55], v[196:199]
  v_mfma_f32_16x16x32_bf16 v[200:203], a[4:7], v[52:55], v[200:203]
  v_mfma_f32_16x16x32_bf16 v[204:207], a[8:11], v[52:55], v[204:207]
  s_add_u32 s75, s48, s79
  buffer_load_dwordx4 v[140:143], v1, s[44:47], s75 offen sc1
  s_add_u32 s48, s48, 4096
  s_cmp_eq_u32 s48, s59
  s_cselect_b32 s48, s58, s48
  v_mfma_f32_16x16x32_bf16 v[208:211], a[12:15], v[52:55], v[208:211]
  v_mfma_f32_16x16x32_bf16 v[212:215], a[16:19], v[52:55], v[212:215]
  s_waitcnt vmcnt(21)
  v_mfma_f32_16x16x32_bf16 v[216:219], a[0:3], v[56:59], v[216:219]
  v_mfma_f32_16x16x32_bf16 v[220:223], a[4:7], v[56:59], v[220:223]
  v_mfma_f32_16x16x32_bf16 v[224:227], a[8:11], v[56:59], v[224:227]
  v_mfma_f32_16x16x32_bf16 v[228:231], a[12:15], v[56:59], v[228:231]
  v_mfma_f32_16x16x32_bf16 v[232:235], a[16:19], v[56:59], v[232:235]
  s_waitcnt vmcnt(20)
  v_mfma_f32_16x16x32_bf16 v[236:239], a[0:3], v[60:63], v[236:239]
  v_mfma_f32_16x16x32_bf16 v[240:243], a[4:7], v[60:63], v[240:243]
  v_mfma_f32_16x16x32_bf16 v[244:247], a[8:11], v[60:63], v[244:247]
  v_mfma_f32_16x16x32_bf16 v[248:251], a[12:15], v[60:63], v[248:251]
  v_mfma_f32_16x16x32_bf16 v[252:255], a[16:19], v[60:63], v[252:255]
  s_waitcnt vmcnt(19)
  v_mfma_f32_16x16x32_bf16 v[176:179], a[20:23], v[64:67], v[176:179]
  v_mfma_f32_16x16x32_bf16 v[180:183], a[24:27], v[64:67], v[180:183]
  v_mfma_f32_16x16x32_bf16 v[184:187], a[28:31], v[64:67], v[184:187]
  v_mfma_f32_16x16x32_bf16 v[188:191], a[32:35], v[64:67], v[188:191]
  v_mfma_f32_16x16x32_bf16 v[192:195], a[36:39], v[64:67], v[192:195]
  s_waitcnt vmcnt(18)
  v_mfma_f32_16x16x32_bf16 v[196:199], a[20:23], v[68:71], v[196:199]
  v_mfma_f32_16x16x32_bf16 v[200:203], a[24:27], v[68:71], v[200:203]
  v_mfma_f32_16x16x32_bf16 v[204:207], a[28:31], v[68:71], v[204:207]
  v_mfma_f32_16x16x32_bf16 v[208:211], a[32:35], v[68:71], v[208:211]
  v_mfma_f32_16x16x32_bf16 v[212:215], a[36:39], v[68:71], v[212:215]
  s_waitcnt vmcnt(17)
  v_mfma_f32_16x16x32_bf16 v[216:219], a[20:23], v[72:75], v[216:219]
  v_mfma_f32_16x16x32_bf16 v[220:223], a[24:27], v[72:75], v[220:223]
  v_mfma_f32_16x16x32_bf16 v[224:227], a[28:31], v[72:75], v[224:227]
  v_mfma_f32_16x16x32_bf16 v[228:231], a[32:35], v[72:75], v[228:231]
  v_mfma_f32_16x16x32_bf16 v[232:235], a[36:39], v[72:75], v[232:235]
  s_waitcnt vmcnt(16)
  v_mfma_f32_16x16x32_bf16 v[236:239], a[20:23], v[76:79], v[236:239]
  v_mfma_f32_16x16x32_bf16 v[240:243], a[24:27], v[76:79], v[240:243]
  v_mfma_f32_16x16x32_bf16 v[244:247], a[28:31], v[76:79], v[244:247]
  v_mfma_f32_16x16x32_bf16 v[248:251], a[32:35], v[76:79], v[248:251]
  v_mfma_f32_16x16x32_bf16 v[252:255], a[36:39], v[76:79], v[252:255]
  s_waitcnt vmcnt(15)
  v_mfma_f32_16x16x32_bf16 v[176:179], a[40:43], v[80:83], v[176:179]
  v_mfma_f32_16x16x32_bf16 v[180:183], a[44:47], v[80:83], v[180:183]
  v_mfma_f32_16x16x32_bf16 v[184:187], a[48:51], v[80:83], v[184:187]
  v_mfma_f32_16x16x32_bf16 v[188:191], a[52:55], v[80:83], v[188:191]
  v_mfma_f32_16x16x32_bf16 v[192:195], a[56:59], v[80:83], v[192:195]
  s_waitcnt vmcnt(14)
  v_mfma_f32_16x16x32_bf16 v[196:199], a[40:43], v[84:87], v[196:199]
  v_mfma_f32_16x16x32_bf16 v[200:203], a[44:47], v[84:87], v[200:203]
  v_mfma_f32_16x16x32_bf16 v[204:207], a[48:51], v[84:87], v[204:207]
  v_mfma_f32_16x16x32_bf16 v[208:211], a[52:55], v[84:87], v[208:211]
  v_mfma_f32_16x16x32_bf16 v[212:215], a[56:59], v[84:87], v[212:215]
  s_waitcnt vmcnt(13)
  v_mfma_f32_16x16x32_bf16 v[216:219], a[40:43], v[88:91], v[216:219]
  v_mfma_f32_16x16x32_bf16 v[220:223], a[44:47], v[88:91], v[220:223]
  v_mfma_f32_16x16x32_bf16 v[224:227], a[48:51], v[88:91], v[224:227]
  v_mfma_f32_16x16x32_bf16 v[228:231], a[52:55], v[88:91], v[228:231]
  v_mfma_f32_16x16x32_bf16 v[232:235], a[56:59], v[88:91], v[232:235]
  s_waitcnt vmcnt(12)
  v_mfma_f32_16x16x32_bf16 v[236:239], a[40:43], v[92:95], v[236:239]
  v_mfma_f32_16x16x32_bf16 v[240:243], a[44:47], v[92:95], v[240:243]
  v_mfma_f32_16x16x32_bf16 v[244:247], a[48:51], v[92:95], v[244:247]
  v_mfma_f32_16x16x32_bf16 v[248:251], a[52:55], v[92:95], v[248:251]
  v_mfma_f32_16x16x32_bf16 v[252:255], a[56:59], v[92:95], v[252:255]
  s_waitcnt vmcnt(11)
  v_mfma_f32_16x16x32_bf16 v[176:179], a[60:63], v[96:99], v[176:179]
  v_mfma_f32_16x16x32_bf16 v[180:183], a[64:67], v[96:99], v[180:183]
  v_mfma_f32_16x16x32_bf16 v[184:187], a[68:71], v[96:99], v[184:187]
  v_mfma_f32_16x16x32_bf16 v[188:191], a[72:75], v[96:99], v[188:191]
  v_mfma_f32_16x16x32_bf16 v[192:195], a[76:79], v[96:99], v[192:195]
  s_waitcnt vmcnt(10)
  v_mfma_f32_16x16x32_bf16 v[196:199], a[60:63], v[100:103], v[196:199]
  v_mfma_f32_16x16x32_bf16 v[200:203], a[64:67], v[100:103], v[200:203]
  v_mfma_f32_16x16x32_bf16 v[204:207], a[68:71], v[100:103], v[204:207]
  v_mfma_f32_16x16x32_bf16 v[208:211], a[72:75], v[100:103], v[208:211]
  v_mfma_f32_16x16x32_bf16 v[212:215], a[76:79], v[100:103], v[212:215]
  s_waitcnt vmcnt(9)
  v_mfma_f32_16x16x32_bf16 v[216:219], a[60:63], v[104:107], v[216:219]
  v_mfma_f32_16x16x32_bf16 v[220:223], a[64:67], v[104:107], v[220:223]
  v_mfma_f32_16x16x32_bf16 v[224:227], a[68:71], v[104:107], v[224:227]
  v_mfma_f32_16x16x32_bf16 v[228:231], a[72:75], v[104:107], v[228:231]
  v_mfma_f32_16x16x32_bf16 v[232:235], a[76:79], v[104:107], v[232:235]
  s_waitcnt vmcnt(8)
  v_mfma_f32_16x16x32_bf16 v[236:239], a[60:63], v[108:111], v[236:239]
  v_mfma_f32_16x16x32_bf16 v[240:243], a[64:67], v[108:111], v[240:243]
  v_mfma_f32_16x16x32_bf16 v[244:247], a[68:71], v[108:111], v[244:247]
  v_mfma_f32_16x16x32_bf16 v[248:251], a[72:75], v[108:111], v[248:251]
  v_mfma_f32_16x16x32_bf16 v[252:255], a[76:79], v[108:111], v[252:255]
  s_waitcnt vmcnt(7)
  v_mfma_f32_16x16x32_bf16 v[176:179], a[80:83], v[112:115], v[176:179]
  v_mfma_f32_16x16x32_bf16 v[180:183], a[84:87], v[112:115], v[180:183]
  v_mfma_f32_16x16x32_bf16 v[184:187], a[88:91], v[112:115], v[184:187]
  v_mfma_f32_16x16x32_bf16 v[188:191], a[92:95], v[112:115], v[188:191]
  v_mfma_f32_16x16x32_bf16 v[192:195], a[96:99], v[112:115], v[192:195]
  s_waitcnt vmcnt(6)
  v_mfma_f32_16x16x32_bf16 v[196:199], a[80:83], v[116:119], v[196:199]
  v_mfma_f32_16x16x32_bf16 v[200:203], a[84:87], v[116:119], v[200:203]
  v_mfma_f32_16x16x32_bf16 v[204:207], a[88:91], v[116:119], v[204:207]
  v_mfma_f32_16x16x32_bf16 v[208:211], a[92:95], v[116:119], v[208:211]
  v_mfma_f32_16x16x32_bf16 v[212:215], a[96:99], v[116:119], v[212:215]
  s_waitcnt vmcnt(5)
  v_mfma_f32_16x16x32_bf16 v[216:219], a[80:83], v[120:123], v[216:219]
  v_mfma_f32_16x16x32_bf16 v[220:223], a[84:87], v[120:123], v[220:223]
  v_mfma_f32_16x16x32_bf16 v[224:227], a[88:91], v[120:123], v[224:227]
  v_mfma_f32_16x16x32_bf16 v[228:231], a[92:95], v[120:123], v[228:231]
  v_mfma_f32_16x16x32_bf16 v[232:235], a[96:99], v[120:123], v[232:235]
  s_waitcnt vmcnt(4)
  v_mfma_f32_16x16x32_bf16 v[236:239], a[80:83], v[124:127], v[236:239]
  v_mfma_f32_16x16x32_bf16 v[240:243], a[84:87], v[124:127], v[240:243]
  v_mfma_f32_16x16x32_bf16 v[244:247], a[88:91], v[124:127], v[244:247]
  v_mfma_f32_16x16x32_bf16 v[248:251], a[92:95], v[124:127], v[248:251]
  v_mfma_f32_16x16x32_bf16 v[252:255], a[96:99], v[124:127], v[252:255]
  s_waitcnt vmcnt(3)
  v_mfma_f32_16x16x32_bf16 v[176:179], a[100:103], v[128:131], v[176:179]
  v_mfma_f32_16x16x32_bf16 v[180:183], a[104:107], v[128:131], v[180:183]
L_st9:
  s_cbranch_execz L_st7
  v_mfma_f32_16x16x32_bf16 v[184:187], a[108:111], v[128:131], v[184:187]
  v_mfma_f32_16x16x32_bf16 v[188:191], a[112:115], v[128:131], v[188:191]
  v_mfma_f32_16x16x32_bf16 v[192:195], a[116:119], v[128:131], v[192:195]
  s_waitcnt vmcnt(2)
  v_mfma_f32_16x16x32_bf16 v[196:199], a[100:103], v[132:135], v[196:199]
  s_mul_i32 s84, s76, 15
  s_add_u32 s84, s84, 0
  v_add_u32 v8, s84, v1
  v_mfma_f32_16x16x32_bf16 v[200:203], a[104:107], v[132:135], v[200:203]
  ds_write_b128 v8, v[176:179] offset:0
  ds_write_b128 v8, v[180:183] offset:1024
  v_mfma_f32_16x16x32_bf16 v[204:207], a[108:111], v[132:135], v[204:207]
  ds_write_b128 v8, v[184:187] offset:2048
  ds_write_b128 v8, v[188:191] offset:3072
  v_mfma_f32_16x16x32_bf16 v[208:211], a[112:115], v[132:135], v[208:211]
  ds_write_b128 v8, v[192:195] offset:4096
  v_mfma_f32_16x16x32_bf16 v[212:215], a[116:119], v[132:135], v[212:215]
  s_waitcnt vmcnt(1)
  v_mfma_f32_16x16x32_bf16 v[216:219], a[100:103], v[136:139], v[216:219]
  s_mul_i32 s84, s77, 15
  s_add_u32 s84, s84, 5120
  v_add_u32 v8, s84, v1
  v_mfma_f32_16x16x32_bf16 v[220:223], a[104:107], v[136:139], v[220:223]
  ds_write_b128 v8, v[196:199] offset:0
  ds_write_b128 v8, v[200:203] offset:1024
  v_mfma_f32_16x16x32_bf16 v[224:227], a[108:111], v[136:139], v[224:227]
  ds_write_b128 v8, v[204:207] offset:2048
  ds_write_b128 v8, v[208:211] offset:3072
  v_mfma_f32_16x16x32_bf16 v[228:231], a[112:115], v[136:139], v[228:231]
  ds_write_b128 v8, v[212:215] offset:4096
  v_mfma_f32_16x16x32_bf16 v[232:235], a[116:119], v[136:139], v[232:235]
  s_waitcnt vmcnt(0)
  v_mfma_f32_16x16x32_bf16 v[236:239], a[100:103], v[140:143], v[236:239]
  s_mul_i32 s84, s78, 15
  s_add_u32 s84, s84, 10240
  v_add_u32 v8, s84, v1
  v_mfma_f32_16x16x32_bf16 v[240:243], a[104:107], v[140:143], v[240:243]
  ds_write_b128 v8, v[216:219] offset:0
  ds_write_b128 v8, v[220:223] offset:1024
  v_mfma_f32_16x16x32_bf16 v[244:247], a[108:111], v[140:143], v[244:247]
  ds_write_b128 v8, v[224:227] offset:2048
  ds_write_b128 v8, v[228:231] offset:3072
  v_mfma_f32_16x16x32_bf16 v[248:251], a[112:115], v[140:143], v[248:251]
  ds_write_b128 v8, v[232:235] offset:4096
  v_mfma_f32_16x16x32_bf16 v[252:255], a[116:119], v[140:143], v[252:255]
  s_waitcnt vmcnt(63)
  ds_read_b64 v[96:97], v11 offset:0
  ds_read_b64 v[98:99], v11 offset:32
  ds_read_b64 v[100:101], v11 offset:64
  ds_read_b64 v[102:103], v11 offset:96
  ds_read_b64 v[104:105], v11 offset:128
  v_lshrrev_b32 v3, 2, v0
  v_lshlrev_b32 v3, 13, v3
  v_and_b32 v4, 3, v0
  v_lshl_add_u32 v3, v4, 4, v3
  s_mul_i32 s80, s5, 655360
  s_lshl_b32 s81, s4, 8
  s_add_u32 s80, s80, s81
  s_lshl_b32 s81, s6, 6
  s_add_u32 s80, s80, s81
  s_add_u32 s80, s80, 16932864
  s_add_u32 s81, s80, 131072
  s_add_u32 s82, s81, 131072
  s_add_u32 s83, s82, 131072
  s_add_u32 s85, s83, 131072
  s_mul_i32 s84, s6, 15360
  s_waitcnt lgkmcnt(0)
  v_add_u32 v109, s84, v1
  s_barrier
  buffer_load_dwordx4 v[16:19], v3, s[44:47], s80 offen sc1
  buffer_load_dwordx4 v[20:23], v3, s[44:47], s81 offen sc1
  buffer_load_dwordx4 v[24:27], v3, s[44:47], s82 offen sc1
  buffer_load_dwordx4 v[28:31], v3, s[44:47], s83 offen sc1
  buffer_load_dwordx4 v[32:35], v3, s[44:47], s85 offen sc1
  ds_read_b128 v[176:179], v109 offset:0
  ds_read_b128 v[180:183], v109 offset:1024
  ds_read_b128 v[184:187], v109 offset:2048
  ds_read_b128 v[188:191], v109 offset:3072
  ds_read_b128 v[192:195], v109 offset:4096
  ds_read_b128 v[196:199], v109 offset:5120
  ds_read_b128 v[200:203], v109 offset:6144
  ds_read_b128 v[204:207], v109 offset:7168
  ds_read_b128 v[208:211], v109 offset:8192
  ds_read_b128 v[212:215], v109 offset:9216
  ds_read_b128 v[216:219], v109 offset:10240
  ds_read_b128 v[220:223], v109 offset:11264
  ds_read_b128 v[224:227], v109 offset:12288
  ds_read_b128 v[228:231], v109 offset:13312
  ds_read_b128 v[232:235], v109 offset:14336
  v_lshlrev_b32 v112, 16, v96
  v_and_b32 v113, 0xffff0000, v96
  v_mul_f32 v112, v12, v112
  v_mul_f32 v113, v12, v113
  v_lshlrev_b32 v114, 16, v97
  v_and_b32 v115, 0xffff0000, v97
  v_mul_f32 v114, v12, v114
  v_mul_f32 v115, v12, v115
  v_lshlrev_b32 v116, 16, v98
  v_and_b32 v117, 0xffff0000, v98
  v_mul_f32 v116, v12, v116
  v_mul_f32 v117, v12, v117
  v_lshlrev_b32 v118, 16, v99
  v_and_b32 v119, 0xffff0000, v99
  v_mul_f32 v118, v12, v118
  v_mul_f32 v119, v12, v119
  v_lshlrev_b32 v120, 16, v100
  v_and_b32 v121, 0xffff0000, v100
  v_mul_f32 v120, v12, v120
  v_mul_f32 v121, v12, v121
  v_lshlrev_b32 v122, 16, v101
  v_and_b32 v123, 0xffff0000, v101
  v_mul_f32 v122, v12, v122
  v_mul_f32 v123, v12, v123
  v_lshlrev_b32 v124, 16, v102
  v_and_b32 v125, 0xffff0000, v102
  v_mul_f32 v124, v12, v124
  v_mul_f32 v125, v12, v125
  v_lshlrev_b32 v126, 16, v103
  v_and_b32 v127, 0xffff0000, v103
  v_mul_f32 v126, v12, v126
  v_mul_f32 v127, v12, v127
  v_lshlrev_b32 v128, 16, v104
  v_and_b32 v129, 0xffff0000, v104
  v_mul_f32 v128, v12, v128
  v_mul_f32 v129, v12, v129
  v_lshlrev_b32 v130, 16, v105
  v_and_b32 v131, 0xffff0000, v105
  v_mul_f32 v130, v12, v130
  v_mul_f32 v131, v12, v131
  s_waitcnt lgkmcnt(14)
  v_pk_mul_f32 v[176:177], v[176:177], v[14:15]
  v_pk_mul_f32 v[178:179], v[178:179], v[14:15]
  s_waitcnt lgkmcnt(13)
  v_pk_mul_f32 v[180:181], v[180:181], v[14:15]
  v_pk_mul_f32 v[182:183], v[182:183], v[14:15]
  s_waitcnt lgkmcnt(12)
  v_pk_mul_f32 v[184:185], v[184:185], v[14:15]
  v_pk_mul_f32 v[186:187], v[186:187], v[14:15]
  s_waitcnt lgkmcnt(11)
  v_pk_mul_f32 v[188:189], v[188:189], v[14:15]
  v_pk_mul_f32 v[190:191], v[190:191], v[14:15]
  s_waitcnt lgkmcnt(10)
  v_pk_mul_f32 v[192:193], v[192:193], v[14:15]
  v_pk_mul_f32 v[194:195], v[194:195], v[14:15]
  s_waitcnt lgkmcnt(9)
  v_pk_fma_f32 v[176:177], v[196:197], v[14:15], v[176:177]
  v_pk_fma_f32 v[178:179], v[198:199], v[14:15], v[178:179]
  s_waitcnt lgkmcnt(8)
  v_pk_fma_f32 v[180:181], v[200:201], v[14:15], v[180:181]
  v_pk_fma_f32 v[182:183], v[202:203], v[14:15], v[182:183]
  s_waitcnt lgkmcnt(7)
  v_pk_fma_f32 v[184:185], v[204:205], v[14:15], v[184:185]
  v_pk_fma_f32 v[186:187], v[206:207], v[14:15], v[186:187]
  s_waitcnt lgkmcnt(6)
  v_pk_fma_f32 v[188:189], v[208:209], v[14:15], v[188:189]
  v_pk_fma_f32 v[190:191], v[210:211], v[14:15], v[190:191]
  s_waitcnt lgkmcnt(5)
  v_pk_fma_f32 v[192:193], v[212:213], v[14:15], v[192:193]
  v_pk_fma_f32 v[194:195], v[214:215], v[14:15], v[194:195]
  s_waitcnt lgkmcnt(4)
  v_pk_fma_f32 v[176:177], v[216:217], v[14:15], v[176:177]
  v_pk_fma_f32 v[178:179], v[218:219], v[14:15], v[178:179]
  s_waitcnt lgkmcnt(3)
  v_pk_fma_f32 v[180:181], v[220:221], v[14:15], v[180:181]
  v_pk_fma_f32 v[182:183], v[222:223], v[14:15], v[182:183]
  s_waitcnt lgkmcnt(2)
  v_pk_fma_f32 v[184:185], v[224:225], v[14:15], v[184:185]
  v_pk_fma_f32 v[186:187], v[226:227], v[14:15], v[186:187]
  s_waitcnt lgkmcnt(1)
  v_pk_fma_f32 v[188:189], v[228:229], v[14:15], v[188:189]
  v_pk_fma_f32 v[190:191], v[230:231], v[14:15], v[190:191]
  s_waitcnt lgkmcnt(0)
  v_pk_fma_f32 v[192:193], v[232:233], v[14:15], v[192:193]
  v_pk_fma_f32 v[194:195], v[234:235], v[14:15], v[194:195]
  s_waitcnt vmcnt(0)
  v_bitop3_b32 v19, v17, v19, v6 bitop3:0x7e
  v_bitop3_b32 v23, v21, v23, v6 bitop3:0x7e
  v_bitop3_b32 v27, v25, v27, v6 bitop3:0x7e
  v_bitop3_b32 v31, v29, v31, v6 bitop3:0x7e
  v_bitop3_b32 v35, v33, v35, v6 bitop3:0x7e
  v_or3_b32 v4, v19, v23, v27
  v_or3_b32 v4, v4, v31, v35
  v_cmp_ne_u32 vcc, 0, v4
  s_cbranch_vccnz L_spin_Yi3
L_ret_Yi3:
  v_mov_b32 v17, v18
  ds_write_b64 v10, v[16:17] offset:0
  v_mov_b32 v21, v22
  ds_write_b64 v10, v[20:21] offset:512
  v_mov_b32 v25, v26
  ds_write_b64 v10, v[24:25] offset:1024
  v_mov_b32 v29, v30
  ds_write_b64 v10, v[28:29] offset:1536
  v_mov_b32 v33, v34
  ds_write_b64 v10, v[32:33] offset:2048
  ds_read_b64_tr_b16 v[96:97], v10 offset:0
  ds_read_b64_tr_b16 v[98:99], v10 offset:512
  ds_read_b64_tr_b16 v[100:101], v10 offset:1024
  ds_read_b64_tr_b16 v[102:103], v10 offset:1536
  ds_read_b64_tr_b16 v[104:105], v10 offset:2048
  v_pk_fma_f32 v[176:177], v[236:237], v[14:15], v[176:177]
  v_pk_fma_f32 v[178:179], v[238:239], v[14:15], v[178:179]
  v_pk_fma_f32 v[180:181], v[240:241], v[14:15], v[180:181]
  v_pk_fma_f32 v[182:183], v[242:243], v[14:15], v[182:183]
  v_pk_fma_f32 v[184:185], v[244:245], v[14:15], v[184:185]
  v_pk_fma_f32 v[186:187], v[246:247], v[14:15], v[186:187]
  v_pk_fma_f32 v[188:189], v[248:249], v[14:15], v[188:189]
  v_pk_fma_f32 v[190:191], v[250:251], v[14:15], v[190:191]
  v_pk_fma_f32 v[192:193], v[252:253], v[14:15], v[192:193]
  v_pk_fma_f32 v[194:195], v[254:255], v[14:15], v[194:195]
  s_waitcnt lgkmcnt(4)
  v_lshlrev_b32 v16, 16, v96
  v_and_b32 v17, 0xffff0000, v96
  v_fma_f32 v176, v16, v112, v176
  v_fma_f32 v177, v17, v113, v177
  v_lshlrev_b32 v18, 16, v97
  v_and_b32 v19, 0xffff0000, v97
  v_fma_f32 v178, v18, v114, v178
  v_fma_f32 v179, v19, v115, v179
  s_waitcnt lgkmcnt(3)
  v_lshlrev_b32 v20, 16, v98
  v_and_b32 v21, 0xffff0000, v98
  v_fma_f32 v180, v20, v116, v180
  v_fma_f32 v181, v21, v117, v181
  v_lshlrev_b32 v22, 16, v99
  v_and_b32 v23, 0xffff0000, v99
  v_fma_f32 v182, v22, v118, v182
  v_fma_f32 v183, v23, v119, v183
  s_waitcnt lgkmcnt(2)
  v_lshlrev_b32 v24, 16, v100
  v_and_b32 v25, 0xffff0000, v100
  v_fma_f32 v184, v24, v120, v184
  v_fma_f32 v185, v25, v121, v185
  v_lshlrev_b32 v26, 16, v101
  v_and_b32 v27, 0xffff0000, v101
  v_fma_f32 v186, v26, v122, v186
  v_fma_f32 v187, v27, v123, v187
  s_waitcnt lgkmcnt(1)
  v_lshlrev_b32 v28, 16, v102
  v_and_b32 v29, 0xffff0000, v102
  v_fma_f32 v188, v28, v124, v188
  v_fma_f32 v189, v29, v125, v189
  v_lshlrev_b32 v30, 16, v103
  v_and_b32 v31, 0xffff0000, v103
  v_fma_f32 v190, v30, v126, v190
  v_fma_f32 v191, v31, v127, v191
  s_waitcnt lgkmcnt(0)
  v_lshlrev_b32 v32, 16, v104
  v_and_b32 v33, 0xffff0000, v104
  v_fma_f32 v192, v32, v128, v192
  v_fma_f32 v193, v33, v129, v193
  v_lshlrev_b32 v34, 16, v105
  v_and_b32 v35, 0xffff0000, v105
  v_fma_f32 v194, v34, v130, v194
  v_fma_f32 v195, v35, v131, v195
  v_cvt_pk_bf16_f32 v96, v176, v177
  v_cvt_pk_bf16_f32 v97, v178, v179
  ds_write_b64 v11, v[96:97] offset:0
  v_cvt_pk_bf16_f32 v98, v180, v181
  v_cvt_pk_bf16_f32 v99, v182, v183
  ds_write_b64 v11, v[98:99] offset:32
  v_cvt_pk_bf16_f32 v100, v184, v185
  v_cvt_pk_bf16_f32 v101, v186, v187
  ds_write_b64 v11, v[100:101] offset:64
  v_cvt_pk_bf16_f32 v102, v188, v189
  v_cvt_pk_bf16_f32 v103, v190, v191
  ds_write_b64 v11, v[102:103] offset:96
  v_cvt_pk_bf16_f32 v104, v192, v193
  v_cvt_pk_bf16_f32 v105, v194, v195
  ds_write_b64 v11, v[104:105] offset:128
  v_add_u32 v8, s87, v1
  ds_read_b128 v[116:119], v8 offset:0
  ds_read_b128 v[120:123], v8 offset:640
  ds_read_b128 v[124:127], v8 offset:5120
  ds_read_b128 v[128:131], v8 offset:5760
  s_mov_b32 exec_lo, -1
  s_mov_b32 exec_hi, 0xff
  s_waitcnt lgkmcnt(3)
  s_mov_b32 s82, 0
  buffer_store_dwordx4 v[116:119], v2, s[40:43], s82 offen sc1
  s_waitcnt lgkmcnt(2)
  s_mov_b32 s82, 5120
  buffer_store_dwordx4 v[120:123], v2, s[40:43], s82 offen sc1
  s_waitcnt lgkmcnt(1)
  s_mov_b32 s82, 40960
  buffer_store_dwordx4 v[124:127], v2, s[40:43], s82 offen sc1
  s_waitcnt lgkmcnt(0)
  s_mov_b32 s82, 46080
  buffer_store_dwordx4 v[128:131], v2, s[40:43], s82 offen sc1
  s_endpgm
.p2align 12
L_i2:
L_st10:
  s_cbranch_execz L_hb2
  s_nop 7
  s_nop 3
  s_waitcnt vmcnt(8)
  v_cmp_ne_u32 vcc, s60, v5
  s_cbranch_vccnz L_spin_Ai2
L_ret_Ai2:
  s_barrier
  buffer_load_dwordx4 a[0:3], v1, s[44:47], s71 offen offset:0 sc1
  v_mfma_f32_16x16x32_bf16 v[16:19], v[88:91], v[120:123], v[16:19]
  ds_read_b128 v[112:115], v248 offset:0
  ds_read_b128 v[116:119], v249 offset:0
  v_mfma_f32_16x16x32_bf16 v[40:43], v[88:91], v[124:127], v[40:43]
  ds_read_b64_tr_b16 v[64:65], v242 offset:0
  ds_read_b64_tr_b16 v[66:67], v242 offset:1536
  v_mfma_f32_16x16x32_bf16 v[20:23], v[92:95], v[120:123], v[20:23]
  ds_read_b64_tr_b16 v[68:69], v243 offset:0
  ds_read_b64_tr_b16 v[70:71], v243 offset:1536
  buffer_load_dwordx4 a[4:7], v1, s[44:47], s71 offen offset:1024 sc1
  v_mfma_f32_16x16x32_bf16 v[44:47], v[92:95], v[124:127], v[44:47]
  ds_read_b64_tr_b16 v[72:73], v244 offset:0
  ds_read_b64_tr_b16 v[74:75], v244 offset:1536
  v_mfma_f32_16x16x32_bf16 v[24:27], v[96:99], v[120:123], v[24:27]
  ds_read_b64_tr_b16 v[76:77], v245 offset:0
  ds_read_b64_tr_b16 v[78:79], v245 offset:1536
  v_mfma_f32_16x16x32_bf16 v[48:51], v[96:99], v[124:127], v[48:51]
  ds_read_b64_tr_b16 v[80:81], v246 offset:0
  ds_read_b64_tr_b16 v[82:83], v246 offset:1536
  buffer_load_dwordx4 a[8:11], v1, s[44:47], s71 offen offset:2048 sc1
  v_mfma_f32_16x16x32_bf16 v[28:31], v[100:103], v[120:123], v[28:31]
  ds_read_b64_tr_b16 v[84:85], v247 offset:0
  ds_read_b64_tr_b16 v[86:87], v247 offset:1536
  v_mfma_f32_16x16x32_bf16 v[52:55], v[100:103], v[124:127], v[52:55]
  ds_read_b128 v[128:131], v252 offset:1024
  v_mfma_f32_16x16x32_bf16 v[32:35], v[104:107], v[120:123], v[32:35]
  buffer_load_dwordx4 a[12:15], v1, s[44:47], s71 offen offset:3072 sc1
  v_mfma_f32_16x16x32_bf16 v[56:59], v[104:107], v[124:127], v[56:59]
  v_mfma_f32_16x16x32_bf16 v[36:39], v[108:111], v[120:123], v[36:39]
  v_mfma_f32_16x16x32_bf16 v[60:63], v[108:111], v[124:127], v[60:63]
  v_mfma_f32_16x16x32_bf16 v[12:15], v[132:135], v[120:123], v[12:15]
  s_waitcnt lgkmcnt(0)
  s_add_u32 s74, s71, 4096
  s_add_u32 s71, s71, 5120
  buffer_load_dwordx4 a[16:19], v1, s[44:47], s74 offen sc1
  s_cmp_ge_u32 s71, s73
  s_cselect_b32 s74, 245760, 0
  s_sub_u32 s71, s71, s74
  v_mfma_f32_16x16x32_bf16 v[16:19], v[64:67], v[112:115], v[16:19]
  ds_read_b128 v[120:123], v250 offset:0
  ds_read_b128 v[124:127], v251 offset:0
  v_mfma_f32_16x16x32_bf16 v[40:43], v[64:67], v[116:119], v[40:43]
  ds_read_b64_tr_b16 v[88:89], v242 offset:12288
  ds_read_b64_tr_b16 v[90:91], v242 offset:13824
  v_mfma_f32_16x16x32_bf16 v[20:23], v[68:71], v[112:115], v[20:23]
  ds_read_b64_tr_b16 v[92:93], v243 offset:12288
  ds_read_b64_tr_b16 v[94:95], v243 offset:13824
  buffer_load_dwordx4 a[20:23], v1, s[44:47], s71 offen offset:0 sc1
  v_mfma_f32_16x16x32_bf16 v[44:47], v[68:71], v[116:119], v[44:47]
  ds_read_b64_tr_b16 v[96:97], v244 offset:12288
  ds_read_b64_tr_b16 v[98:99], v244 offset:13824
  v_mfma_f32_16x16x32_bf16 v[24:27], v[72:75], v[112:115], v[24:27]
  ds_read_b64_tr_b16 v[100:101], v245 offset:12288
  ds_read_b64_tr_b16 v[102:103], v245 offset:13824
  v_mfma_f32_16x16x32_bf16 v[48:51], v[72:75], v[116:119], v[48:51]
  ds_read_b64_tr_b16 v[104:105], v246 offset:12288
  ds_read_b64_tr_b16 v[106:107], v246 offset:13824
  buffer_load_dwordx4 a[24:27], v1, s[44:47], s71 offen offset:1024 sc1
  v_mfma_f32_16x16x32_bf16 v[28:31], v[76:79], v[112:115], v[28:31]
  ds_read_b64_tr_b16 v[108:109], v247 offset:12288
  ds_read_b64_tr_b16 v[110:111], v247 offset:13824
  v_mfma_f32_16x16x32_bf16 v[52:55], v[76:79], v[116:119], v[52:55]
  ds_read_b128 v[132:135], v252 offset:1088
  v_mfma_f32_16x16x32_bf16 v[32:35], v[80:83], v[112:115], v[32:35]
  buffer_load_dwordx4 a[28:31], v1, s[44:47], s71 offen offset:2048 sc1
  v_mfma_f32_16x16x32_bf16 v[56:59], v[80:83], v[116:119], v[56:59]
  v_mfma_f32_16x16x32_bf16 v[36:39], v[84:87], v[112:115], v[36:39]
  v_mfma_f32_16x16x32_bf16 v[60:63], v[84:87], v[116:119], v[60:63]
  v_mfma_f32_16x16x32_bf16 v[12:15], v[128:131], v[112:115], v[12:15]
  s_waitcnt lgkmcnt(0)
  s_waitcnt vmcnt(8)
  s_barrier
  buffer_load_dwordx4 a[32:35], v1, s[44:47], s71 offen offset:3072 sc1
  v_mfma_f32_16x16x32_bf16 v[16:19], v[88:91], v[120:123], v[16:19]
  ds_read_b128 v[112:115], v238 offset:0
  ds_read_b128 v[116:119], v239 offset:0
  v_mfma_f32_16x16x32_bf16 v[40:43], v[88:91], v[124:127], v[40:43]
  ds_read_b64_tr_b16 v[64:65], v232 offset:0
  ds_read_b64_tr_b16 v[66:67], v232 offset:1536
  s_add_u32 s74, s71, 4096
  s_add_u32 s71, s71, 5120
  buffer_load_dwordx4 a[36:39], v1, s[44:47], s74 offen sc1
  s_cmp_ge_u32 s71, s73
  s_cselect_b32 s74, 245760, 0
  s_sub_u32 s71, s71, s74
  v_mfma_f32_16x16x32_bf16 v[20:23], v[92:95], v[120:123], v[20:23]
  ds_read_b64_tr_b16 v[68:69], v233 offset:0
  ds_read_b64_tr_b16 v[70:71], v233 offset:1536
  v_mfma_f32_16x16x32_bf16 v[44:47], v[92:95], v[124:127], v[44:47]
  ds_read_b64_tr_b16 v[72:73], v234 offset:0
  ds_read_b64_tr_b16 v[74:75], v234 offset:1536
  v_mfma_f32_16x16x32_bf16 v[24:27], v[96:99], v[120:123], v[24:27]
  ds_read_b64_tr_b16 v[76:77], v235 offset:0
  ds_read_b64_tr_b16 v[78:79], v235 offset:1536
  buffer_load_dwordx4 a[40:43], v1, s[44:47], s71 offen offset:0 sc1
  v_mfma_f32_16x16x32_bf16 v[48:51], v[96:99], v[124:127], v[48:51]
  ds_read_b64_tr_b16 v[80:81], v236 offset:0
  ds_read_b64_tr_b16 v[82:83], v236 offset:1536
  v_mfma_f32_16x16x32_bf16 v[28:31], v[100:103], v[120:123], v[28:31]
  ds_read_b64_tr_b16 v[84:85], v237 offset:0
  ds_read_b64_tr_b16 v[86:87], v237 offset:1536
  buffer_load_dwordx4 a[44:47], v1, s[44:47], s71 offen offset:1024 sc1
  v_mfma_f32_16x16x32_bf16 v[52:55], v[100:103], v[124:127], v[52:55]
  ds_read_b128 v[128:131], v252 offset:1152
  v_mfma_f32_16x16x32_bf16 v[32:35], v[104:107], v[120:123], v[32:35]
  v_mfma_f32_16x16x32_bf16 v[56:59], v[104:107], v[124:127], v[56:59]
  buffer_load_dwordx4 a[48:51], v1, s[44:47], s71 offen offset:2048 sc1
  v_mfma_f32_16x16x32_bf16 v[36:39], v[108:111], v[120:123], v[36:39]
  v_mfma_f32_16x16x32_bf16 v[60:63], v[108:111], v[124:127], v[60:63]
  v_mfma_f32_16x16x32_bf16 v[12:15], v[132:135], v[120:123], v[12:15]
  s_waitcnt lgkmcnt(0)
  buffer_load_dwordx4 a[52:55], v1, s[44:47], s71 offen offset:3072 sc1
  v_mfma_f32_16x16x32_bf16 v[16:19], v[64:67], v[112:115], v[16:19]
  ds_read_b128 v[120:123], v240 offset:0
  ds_read_b128 v[124:127], v241 offset:0
  v_mfma_f32_16x16x32_bf16 v[40:43], v[64:67], v[116:119], v[40:43]
  ds_read_b64_tr_b16 v[88:89], v232 offset:12288
  ds_read_b64_tr_b16 v[90:91], v232 offset:13824
  s_add_u32 s74, s71, 4096
  s_add_u32 s71, s71, 5120
  buffer_load_dwordx4 a[56:59], v1, s[44:47], s74 offen sc1
  s_cmp_eq_u32 s6, 2
  s_cselect_b32 s74, 76800, 0
  s_add_u32 s71, s71, s74
  s_cmp_ge_u32 s71, s73
  s_cselect_b32 s74, 245760, 0
  s_sub_u32 s71, s71, s74
  v_mfma_f32_16x16x32_bf16 v[20:23], v[68:71], v[112:115], v[20:23]
  ds_read_b64_tr_b16 v[92:93], v233 offset:12288
  ds_read_b64_tr_b16 v[94:95], v233 offset:13824
  v_mfma_f32_16x16x32_bf16 v[44:47], v[68:71], v[116:119], v[44:47]
  ds_read_b64_tr_b16 v[96:97], v234 offset:12288
  ds_read_b64_tr_b16 v[98:99], v234 offset:13824
  v_mfma_f32_16x16x32_bf16 v[24:27], v[72:75], v[112:115], v[24:27]
  ds_read_b64_tr_b16 v[100:101], v235 offset:12288
  ds_read_b64_tr_b16 v[102:103], v235 offset:13824
  buffer_load_dwordx4 a[60:63], v1, s[44:47], s71 offen offset:0 sc1
  v_mfma_f32_16x16x32_bf16 v[48:51], v[72:75], v[116:119], v[48:51]
  ds_read_b64_tr_b16 v[104:105], v236 offset:12288
  ds_read_b64_tr_b16 v[106:107], v236 offset:13824
  v_mfma_f32_16x16x32_bf16 v[28:31], v[76:79], v[112:115], v[28:31]
  ds_read_b64_tr_b16 v[108:109], v237 offset:12288
  ds_read_b64_tr_b16 v[110:111], v237 offset:13824
  buffer_load_dwordx4 a[64:67], v1, s[44:47], s71 offen offset:1024 sc1
  v_mfma_f32_16x16x32_bf16 v[52:55], v[76:79], v[116:119], v[52:55]
  ds_read_b128 v[132:135], v252 offset:1216
  v_mfma_f32_16x16x32_bf16 v[32:35], v[80:83], v[112:115], v[32:35]
  v_mfma_f32_16x16x32_bf16 v[56:59], v[80:83], v[116:119], v[56:59]
  buffer_load_dwordx4 a[68:71], v1, s[44:47], s71 offen offset:2048 sc1
  v_mfma_f32_16x16x32_bf16 v[36:39], v[84:87], v[112:115], v[36:39]
  v_mfma_f32_16x16x32_bf16 v[60:63], v[84:87], v[116:119], v[60:63]
  v_mfma_f32_16x16x32_bf16 v[12:15], v[128:131], v[112:115], v[12:15]
  s_waitcnt lgkmcnt(0)
  s_barrier
  v_mul_u32_u24 v136, 205, v0
  v_lshrrev_b32 v136, 11, v136
  v_mul_u32_u24 v137, 10, v136
  v_mfma_f32_16x16x32_bf16 v[16:19], v[88:91], v[120:123], v[16:19]
  v_sub_u32 v137, v0, v137
  v_mul_u32_u24 v136, 1280, v136
  v_lshl_add_u32 v136, v137, 4, v136
  v_mfma_f32_16x16x32_bf16 v[40:43], v[88:91], v[124:127], v[40:43]
  s_mul_i32 s80, s4, 81920
  s_mul_i32 s81, s5, 160
  s_add_u32 s80, s80, s81
  s_mul_i32 s81, s6, 10240
  s_add_u32 s80, s80, s81
  v_mfma_f32_16x16x32_bf16 v[20:23], v[92:95], v[120:123], v[20:23]
  v_add_u32 v2, s80, v136
  s_mul_i32 s87, s6, 1280
  s_add_u32 s87, s87, 153472
  v_mfma_f32_16x16x32_bf16 v[44:47], v[92:95], v[124:127], v[44:47]
  s_mov_b32 exec_lo, -1
  s_mov_b32 exec_hi, 0xff
  s_add_u32 m0, s87, 0
  s_mov_b32 s82, 0
  buffer_load_dwordx4 v2, s[8:11], s82 offen lds
  s_mov_b64 exec, -1
  v_mfma_f32_16x16x32_bf16 v[24:27], v[96:99], v[120:123], v[24:27]
  s_mov_b32 exec_lo, -1
  s_mov_b32 exec_hi, 0xff
  s_add_u32 m0, s87, 640
  s_mov_b32 s82, 5120
  buffer_load_dwordx4 v2, s[8:11], s82 offen lds
  s_mov_b64 exec, -1
  v_mfma_f32_16x16x32_bf16 v[48:51], v[96:99], v[124:127], v[48:51]
  s_mov_b32 exec_lo, -1
  s_mov_b32 exec_hi, 0xff
  s_add_u32 m0, s87, 5120
  s_mov_b32 s82, 40960
  buffer_load_dwordx4 v2, s[8:11], s82 offen lds
  s_mov_b64 exec, -1
  v_mfma_f32_16x16x32_bf16 v[28:31], v[100:103], v[120:123], v[28:31]
  s_mov_b32 exec_lo, -1
  s_mov_b32 exec_hi, 0xff
  s_add_u32 m0, s87, 5760
  s_mov_b32 s82, 46080
  buffer_load_dwordx4 v2, s[8:11], s82 offen lds
  s_mov_b64 exec, -1
  v_mfma_f32_16x16x32_bf16 v[52:55], v[100:103], v[124:127], v[52:55]
  s_add_u32 s76, s6, 1
  s_and_b32 s76, s76, 3
  s_lshl_b32 s76, s76, 10
  v_mfma_f32_16x16x32_bf16 v[32:35], v[104:107], v[120:123], v[32:35]
  s_add_u32 s77, s6, 2
  s_and_b32 s77, s77, 3
  s_lshl_b32 s77, s77, 10
  v_mfma_f32_16x16x32_bf16 v[56:59], v[104:107], v[124:127], v[56:59]
  s_add_u32 s78, s6, 3
  s_and_b32 s78, s78, 3
  s_lshl_b32 s78, s78, 10
  v_mfma_f32_16x16x32_bf16 v[36:39], v[108:111], v[120:123], v[36:39]
  s_add_u32 s79, s6, 4
  s_and_b32 s79, s79, 3
  s_lshl_b32 s79, s79, 10
  v_mfma_f32_16x16x32_bf16 v[60:63], v[108:111], v[124:127], v[60:63]
  v_mfma_f32_16x16x32_bf16 v[12:15], v[132:135], v[120:123], v[12:15]
  s_mov_b32 s80, 0xbfb8aa3b
  s_mov_b32 s81, 0xbfb8aa3b
  s_mov_b32 s82, 1.0
  s_mov_b32 s83, 1.0
  s_and_b32 s85, s6, 1
  s_mul_i32 s85, s85, 12288
  s_add_u32 s85, s85, 73728
  s_add_u32 s84, s85, s79
  v_pk_mul_f32 v[64:65], v[16:17], s[80:81]
  v_pk_mul_f32 v[66:67], v[18:19], s[80:81]
  v_pk_mul_f32 v[68:69], v[20:21], s[80:81]
  v_pk_mul_f32 v[70:71], v[22:23], s[80:81]
  v_exp_f32 v64, v64
  v_exp_f32 v65, v65
  v_exp_f32 v66, v66
  v_exp_f32 v67, v67
  v_exp_f32 v68, v68
  v_exp_f32 v69, v69
  v_exp_f32 v70, v70
  v_exp_f32 v71, v71
  v_add_u32 v96, s84, v1
  v_xor_b32 v97, 1024, v96
  v_pk_add_f32 v[64:65], v[64:65], s[82:83]
  v_pk_add_f32 v[66:67], v[66:67], s[82:83]
  v_pk_add_f32 v[68:69], v[68:69], s[82:83]
  v_pk_add_f32 v[70:71], v[70:71], s[82:83]
  v_rcp_f32 v64, v64
  v_rcp_f32 v65, v65
  v_rcp_f32 v66, v66
  v_rcp_f32 v67, v67
  v_rcp_f32 v68, v68
  v_rcp_f32 v69, v69
  v_rcp_f32 v70, v70
  v_rcp_f32 v71, v71
  v_pk_mul_f32 v[64:65], v[64:65], v[16:17]
  v_pk_mul_f32 v[66:67], v[66:67], v[18:19]
  v_pk_mul_f32 v[68:69], v[68:69], v[20:21]
  v_pk_mul_f32 v[70:71], v[70:71], v[22:23]
  v_cvt_pk_bf16_f32 v72, v64, v65
  v_cvt_pk_bf16_f32 v73, v66, v67
  v_cvt_pk_bf16_f32 v74, v68, v69
  v_cvt_pk_bf16_f32 v75, v70, v71
  s_add_u32 s75, s97, 0
  buffer_store_dwordx4 v[72:75], v1, s[44:47], s75 offen sc1
  ds_write_b128 v96, v[72:75] offset:0
  v_pk_mul_f32 v[80:81], v[40:41], s[80:81]
  v_pk_mul_f32 v[82:83], v[42:43], s[80:81]
  v_pk_mul_f32 v[84:85], v[44:45], s[80:81]
  v_pk_mul_f32 v[86:87], v[46:47], s[80:81]
  v_exp_f32 v80, v80
  v_exp_f32 v81, v81
  v_exp_f32 v82, v82
  v_exp_f32 v83, v83
  v_exp_f32 v84, v84
  v_exp_f32 v85, v85
  v_exp_f32 v86, v86
  v_exp_f32 v87, v87
  v_pk_add_f32 v[80:81], v[80:81], s[82:83]
  v_pk_add_f32 v[82:83], v[82:83], s[82:83]
  v_pk_add_f32 v[84:85], v[84:85], s[82:83]
  v_pk_add_f32 v[86:87], v[86:87], s[82:83]
  v_rcp_f32 v80, v80
  v_rcp_f32 v81, v81
  v_rcp_f32 v82, v82
  v_rcp_f32 v83, v83
  v_rcp_f32 v84, v84
  v_rcp_f32 v85, v85
  v_rcp_f32 v86, v86
  v_rcp_f32 v87, v87
  v_pk_mul_f32 v[80:81], v[80:81], v[40:41]
  v_pk_mul_f32 v[82:83], v[82:83], v[42:43]
  v_pk_mul_f32 v[84:85], v[84:85], v[44:45]
  v_pk_mul_f32 v[86:87], v[86:87], v[46:47]
  v_cvt_pk_bf16_f32 v88, v80, v81
  v_cvt_pk_bf16_f32 v89, v82, v83
  v_cvt_pk_bf16_f32 v90, v84, v85
  v_cvt_pk_bf16_f32 v91, v86, v87
  s_add_u32 s75, s98, 0
  buffer_store_dwordx4 v[88:91], v1, s[44:47], s75 offen sc1
  ds_write_b128 v97, v[88:91] offset:0
  v_pk_mul_f32 v[64:65], v[24:25], s[80:81]
  v_pk_mul_f32 v[66:67], v[26:27], s[80:81]
  v_pk_mul_f32 v[68:69], v[28:29], s[80:81]
  v_pk_mul_f32 v[70:71], v[30:31], s[80:81]
  v_exp_f32 v64, v64
  v_exp_f32 v65, v65
  v_exp_f32 v66, v66
  v_exp_f32 v67, v67
  v_exp_f32 v68, v68
  v_exp_f32 v69, v69
  v_exp_f32 v70, v70
  v_exp_f32 v71, v71
  v_pk_add_f32 v[64:65], v[64:65], s[82:83]
  v_pk_add_f32 v[66:67], v[66:67], s[82:83]
  v_pk_add_f32 v[68:69], v[68:69], s[82:83]
  v_pk_add_f32 v[70:71], v[70:71], s[82:83]
  v_rcp_f32 v64, v64
  v_rcp_f32 v65, v65
  v_rcp_f32 v66, v66
  v_rcp_f32 v67, v67
  v_rcp_f32 v68, v68
  v_rcp_f32 v69, v69
  v_rcp_f32 v70, v70
  v_rcp_f32 v71, v71
  v_pk_mul_f32 v[64:65], v[64:65], v[24:25]
  v_pk_mul_f32 v[66:67], v[66:67], v[26:27]
  v_pk_mul_f32 v[68:69], v[68:69], v[28:29]
  v_pk_mul_f32 v[70:71], v[70:71], v[30:31]
  v_cvt_pk_bf16_f32 v72, v64, v65
  v_cvt_pk_bf16_f32 v73, v66, v67
  v_cvt_pk_bf16_f32 v74, v68, v69
  v_cvt_pk_bf16_f32 v75, v70, v71
  s_add_u32 s75, s97, 4096
  buffer_store_dwordx4 v[72:75], v1, s[44:47], s75 offen sc1
  ds_write_b128 v96, v[72:75] offset:4096
  v_pk_mul_f32 v[80:81], v[48:49], s[80:81]
  v_pk_mul_f32 v[82:83], v[50:51], s[80:81]
  v_pk_mul_f32 v[84:85], v[52:53], s[80:81]
  buffer_load_dwordx4 a[72:75], v1, s[44:47], s71 offen offset:3072 sc1
  v_pk_mul_f32 v[86:87], v[54:55], s[80:81]
  v_exp_f32 v80, v80
  v_exp_f32 v81, v81
  v_exp_f32 v82, v82
  v_exp_f32 v83, v83
  v_exp_f32 v84, v84
  v_exp_f32 v85, v85
  s_add_u32 s74, s71, 4096
  s_add_u32 s71, s71, 5120
  buffer_load_dwordx4 a[76:79], v1, s[44:47], s74 offen sc1
  s_cmp_ge_u32 s71, s73
  s_cselect_b32 s74, 245760, 0
  s_sub_u32 s71, s71, s74
  v_exp_f32 v86, v86
  v_exp_f32 v87, v87
  v_pk_add_f32 v[80:81], v[80:81], s[82:83]
  v_pk_add_f32 v[82:83], v[82:83], s[82:83]
  v_pk_add_f32 v[84:85], v[84:85], s[82:83]
  v_pk_add_f32 v[86:87], v[86:87], s[82:83]
  v_rcp_f32 v80, v80
  buffer_load_dwordx4 a[80:83], v1, s[44:47], s71 offen offset:0 sc1
  v_rcp_f32 v81, v81
  v_rcp_f32 v82, v82
  v_rcp_f32 v83, v83
  v_rcp_f32 v84, v84
  v_rcp_f32 v85, v85
  v_rcp_f32 v86, v86
  v_rcp_f32 v87, v87
  buffer_load_dwordx4 a[84:87], v1, s[44:47], s71 offen offset:1024 sc1
  v_pk_mul_f32 v[80:81], v[80:81], v[48:49]
  v_pk_mul_f32 v[82:83], v[82:83], v[50:51]
  v_pk_mul_f32 v[84:85], v[84:85], v[52:53]
  v_pk_mul_f32 v[86:87], v[86:87], v[54:55]
  v_cvt_pk_bf16_f32 v88, v80, v81
  v_cvt_pk_bf16_f32 v89, v82, v83
  v_cvt_pk_bf16_f32 v90, v84, v85
  v_cvt_pk_bf16_f32 v91, v86, v87
  s_add_u32 s75, s98, 4096
  buffer_store_dwordx4 v[88:91], v1, s[44:47], s75 offen sc1
  ds_write_b128 v97, v[88:91] offset:4096
  v_pk_mul_f32 v[64:65], v[32:33], s[80:81]
  v_pk_mul_f32 v[66:67], v[34:35], s[80:81]
  v_pk_mul_f32 v[68:69], v[36:37], s[80:81]
  buffer_load_dwordx4 a[88:91], v1, s[44:47], s71 offen offset:2048 sc1
  v_pk_mul_f32 v[70:71], v[38:39], s[80:81]
  v_exp_f32 v64, v64
  v_exp_f32 v65, v65
  v_exp_f32 v66, v66
  v_exp_f32 v67, v67
  v_exp_f32 v68, v68
  v_exp_f32 v69, v69
  buffer_load_dwordx4 a[92:95], v1, s[44:47], s71 offen offset:3072 sc1
  v_exp_f32 v70, v70
  v_exp_f32 v71, v71
  v_pk_add_f32 v[64:65], v[64:65], s[82:83]
  v_pk_add_f32 v[66:67], v[66:67], s[82:83]
  v_pk_add_f32 v[68:69], v[68:69], s[82:83]
  v_pk_add_f32 v[70:71], v[70:71], s[82:83]
  v_rcp_f32 v64, v64
  s_add_u32 s74, s71, 4096
  s_add_u32 s71, s71, 5120
  buffer_load_dwordx4 a[96:99], v1, s[44:47], s74 offen sc1
  s_cmp_ge_u32 s71, s73
  s_cselect_b32 s74, 245760, 0
  s_sub_u32 s71, s71, s74
  v_rcp_f32 v65, v65
  v_rcp_f32 v66, v66
  v_rcp_f32 v67, v67
  v_rcp_f32 v68, v68
  v_rcp_f32 v69, v69
  v_rcp_f32 v70, v70
  v_rcp_f32 v71, v71
  buffer_load_dwordx4 a[100:103], v1, s[44:47], s71 offen offset:0 sc1
  v_pk_mul_f32 v[64:65], v[64:65], v[32:33]
  v_pk_mul_f32 v[66:67], v[66:67], v[34:35]
  v_pk_mul_f32 v[68:69], v[68:69], v[36:37]
  v_pk_mul_f32 v[70:71], v[70:71], v[38:39]
  v_cvt_pk_bf16_f32 v72, v64, v65
  v_cvt_pk_bf16_f32 v73, v66, v67
  v_cvt_pk_bf16_f32 v74, v68, v69
  v_cvt_pk_bf16_f32 v75, v70, v71
  s_add_u32 s75, s97, 8192
  buffer_store_dwordx4 v[72:75], v1, s[44:47], s75 offen sc1
  ds_write_b128 v96, v[72:75] offset:8192
  v_pk_mul_f32 v[80:81], v[56:57], s[80:81]
  v_pk_mul_f32 v[82:83], v[58:59], s[80:81]
  v_pk_mul_f32 v[84:85], v[60:61], s[80:81]
  buffer_load_dwordx4 a[104:107], v1, s[44:47], s71 offen offset:1024 sc1
  v_pk_mul_f32 v[86:87], v[62:63], s[80:81]
  v_exp_f32 v80, v80
  v_exp_f32 v81, v81
  v_exp_f32 v82, v82
  v_exp_f32 v83, v83
  v_exp_f32 v84, v84
  v_exp_f32 v85, v85
  buffer_load_dwordx4 a[108:111], v1, s[44:47], s71 offen offset:2048 sc1
  v_exp_f32 v86, v86
  v_exp_f32 v87, v87
  v_pk_add_f32 v[80:81], v[80:81], s[82:83]
  v_pk_add_f32 v[82:83], v[82:83], s[82:83]
  v_pk_add_f32 v[84:85], v[84:85], s[82:83]
  v_pk_add_f32 v[86:87], v[86:87], s[82:83]
  v_rcp_f32 v80, v80
  buffer_load_dwordx4 a[112:115], v1, s[44:47], s71 offen offset:3072 sc1
  v_rcp_f32 v81, v81
  v_rcp_f32 v82, v82
  v_rcp_f32 v83, v83
  v_rcp_f32 v84, v84
  v_rcp_f32 v85, v85
  v_rcp_f32 v86, v86
  v_rcp_f32 v87, v87
  s_add_u32 s74, s71, 4096
  s_add_u32 s71, s71, 5120
  buffer_load_dwordx4 a[116:119], v1, s[44:47], s74 offen sc1
  s_cmp_ge_u32 s71, s73
  s_cselect_b32 s74, 245760, 0
  s_sub_u32 s71, s71, s74
  v_pk_mul_f32 v[80:81], v[80:81], v[56:57]
  v_pk_mul_f32 v[82:83], v[82:83], v[58:59]
  v_pk_mul_f32 v[84:85], v[84:85], v[60:61]
  v_pk_mul_f32 v[86:87], v[86:87], v[62:63]
  v_cvt_pk_bf16_f32 v88, v80, v81
  v_cvt_pk_bf16_f32 v89, v82, v83
  v_cvt_pk_bf16_f32 v90, v84, v85
  v_cvt_pk_bf16_f32 v91, v86, v87
  s_add_u32 s75, s98, 8192
  buffer_store_dwordx4 v[88:91], v1, s[44:47], s75 offen sc1
  ds_write_b128 v97, v[88:91] offset:8192
  v_cvt_pk_bf16_f32 v12, v12, v12
  v_lshlrev_b32 v12, 16, v12
  v_mul_f32 v12, 0xbfb8aa3b, v12
  v_exp_f32 v12, v12
  s_nop 0
  v_add_f32 v12, 1.0, v12
  v_rcp_f32 v12, v12
  s_nop 0
  v_cvt_pk_bf16_f32 v12, v12, v12
  v_lshlrev_b32 v12, 16, v12
  v_sub_f32 v14, 1.0, v12
  v_cvt_pk_bf16_f32 v14, v14, v14
  v_lshlrev_b32 v14, 16, v14
  v_mov_b32 v13, v12
  v_mov_b32 v15, v14
  s_lshl_b32 s84, s4, 7
  s_lshl_b32 s86, s5, 4
  s_add_u32 s84, s84, s86
  s_lshl_b32 s86, s6, 2
  s_add_u32 s84, s84, s86
  s_lshl_b32 s84, s84, 6
  s_add_u32 s84, s84, 16408576
  s_mul_i32 s86, s6, 2560
  s_add_u32 s86, s86, 61440
  v_mov_b32 v10, s86
  v_lshl_add_u32 v10, v0, 3, v10
  v_and_b32 v208, 15, v0
  v_lshrrev_b32 v209, 2, v208
  v_lshlrev_b32 v209, 1, v209
  v_and_b32 v210, 1, v208
  v_or_b32 v209, v209, v210
  v_and_b32 v210, 2, v208
  v_lshl_add_u32 v208, v210, 4, v209
  v_mul_u32_u24 v208, 160, v208
  v_lshrrev_b32 v209, 4, v0
  v_lshl_add_u32 v208, v209, 3, v208
  v_add_u32 v11, s87, v208
  s_add_u32 s86, s85, s76
  v_add_u32 v160, s86, v1
  s_add_u32 s86, s85, s77
  v_add_u32 v161, s86, v1
  s_add_u32 s86, s85, s78
  v_add_u32 v162, s86, v1
  s_add_u32 s86, s85, s79
  v_add_u32 v163, s86, v1
  s_waitcnt lgkmcnt(0)
  s_barrier
  ds_read_b128 v[16:19], v160 offset:0
  ds_read_b128 v[20:23], v161 offset:0
  ds_read_b128 v[24:27], v162 offset:0
  ds_read_b128 v[28:31], v163 offset:0
  ds_read_b128 v[32:35], v160 offset:4096
  ds_read_b128 v[36:39], v161 offset:4096
  ds_read_b128 v[40:43], v162 offset:4096
  ds_read_b128 v[44:47], v163 offset:4096
  s_waitcnt vmcnt(35) lgkmcnt(4)
  v_mfma_f32_16x16x32_bf16 v[176:179], a[0:3], v[16:19], 0
  ds_read_b128 v[48:51], v160 offset:8192
  v_mfma_f32_16x16x32_bf16 v[180:183], a[4:7], v[16:19], 0
  ds_read_b128 v[52:55], v161 offset:8192
  buffer_load_dwordx4 a[120:123], v1, s[44:47], s71 offen offset:0 sc1
  v_mfma_f32_16x16x32_bf16 v[184:187], a[8:11], v[16:19], 0
  ds_read_b128 v[56:59], v162 offset:8192
  v_mfma_f32_16x16x32_bf16 v[188:191], a[12:15], v[16:19], 0
  ds_read_b128 v[60:63], v163 offset:8192
  buffer_load_dwordx4 a[124:127], v1, s[44:47], s71 offen offset:1024 sc1
  v_mfma_f32_16x16x32_bf16 v[192:195], a[16:19], v[16:19], 0
  v_mfma_f32_16x16x32_bf16 v[196:199], a[0:3], v[20:23], 0
  buffer_load_dwordx4 a[128:131], v1, s[44:47], s71 offen offset:2048 sc1
  v_mfma_f32_16x16x32_bf16 v[200:203], a[4:7], v[20:23], 0
  v_mfma_f32_16x16x32_bf16 v[204:207], a[8:11], v[20:23], 0
  buffer_load_dwordx4 a[132:135], v1, s[44:47], s71 offen offset:3072 sc1
  v_mfma_f32_16x16x32_bf16 v[208:211], a[12:15], v[20:23], 0
  v_mfma_f32_16x16x32_bf16 v[212:215], a[16:19], v[20:23], 0
  s_add_u32 s74, s71, 4096
  s_add_u32 s71, s71, 5120
  buffer_load_dwordx4 a[136:139], v1, s[44:47], s74 offen sc1
  s_cmp_ge_u32 s71, s73
  s_cselect_b32 s74, 245760, 0
  s_sub_u32 s71, s71, s74
  v_mfma_f32_16x16x32_bf16 v[216:219], a[0:3], v[24:27], 0
  v_mfma_f32_16x16x32_bf16 v[220:223], a[4:7], v[24:27], 0
  buffer_load_dwordx4 a[140:143], v1, s[44:47], s71 offen offset:0 sc1
  v_mfma_f32_16x16x32_bf16 v[224:227], a[8:11], v[24:27], 0
  v_mfma_f32_16x16x32_bf16 v[228:231], a[12:15], v[24:27], 0
  buffer_load_dwordx4 a[144:147], v1, s[44:47], s71 offen offset:1024 sc1
  v_mfma_f32_16x16x32_bf16 v[232:235], a[16:19], v[24:27], 0
  v_mfma_f32_16x16x32_bf16 v[236:239], a[0:3], v[28:31], 0
  buffer_load_dwordx4 a[148:151], v1, s[44:47], s71 offen offset:2048 sc1
  v_mfma_f32_16x16x32_bf16 v[240:243], a[4:7], v[28:31], 0
  v_mfma_f32_16x16x32_bf16 v[244:247], a[8:11], v[28:31], 0
  buffer_load_dwordx4 a[152:155], v1, s[44:47], s71 offen offset:3072 sc1
  v_mfma_f32_16x16x32_bf16 v[248:251], a[12:15], v[28:31], 0
  v_mfma_f32_16x16x32_bf16 v[252:255], a[16:19], v[28:31], 0
  s_add_u32 s74, s71, 4096
  s_add_u32 s71, s71, 5120
  buffer_load_dwordx4 a[156:159], v1, s[44:47], s74 offen sc1
  s_cmp_ge_u32 s71, s73
  s_cselect_b32 s74, 245760, 0
  s_sub_u32 s71, s71, s74
  s_waitcnt vmcnt(40) lgkmcnt(4)
  s_waitcnt vmcnt(10)
  s_mov_b64 exec, 1
  buffer_store_dword v7, off, s[44:47], s84 sc1
  s_mov_b64 exec, -1
  v_mfma_f32_16x16x32_bf16 v[176:179], a[20:23], v[32:35], v[176:179]
  v_mfma_f32_16x16x32_bf16 v[180:183], a[24:27], v[32:35], v[180:183]
  buffer_load_dwordx4 a[160:163], v1, s[44:47], s71 offen offset:0 sc1
  v_mfma_f32_16x16x32_bf16 v[184:187], a[28:31], v[32:35], v[184:187]
  v_mfma_f32_16x16x32_bf16 v[188:191], a[32:35], v[32:35], v[188:191]
  buffer_load_dwordx4 a[164:167], v1, s[44:47], s71 offen offset:1024 sc1
  v_mfma_f32_16x16x32_bf16 v[192:195], a[36:39], v[32:35], v[192:195]
  v_mfma_f32_16x16x32_bf16 v[196:199], a[20:23], v[36:39], v[196:199]
  buffer_load_dwordx4 a[168:171], v1, s[44:47], s71 offen offset:2048 sc1
  v_mfma_f32_16x16x32_bf16 v[200:203], a[24:27], v[36:39], v[200:203]
  v_mfma_f32_16x16x32_bf16 v[204:207], a[28:31], v[36:39], v[204:207]
  buffer_load_dwordx4 a[172:175], v1, s[44:47], s71 offen offset:3072 sc1
  v_mfma_f32_16x16x32_bf16 v[208:211], a[32:35], v[36:39], v[208:211]
  v_mfma_f32_16x16x32_bf16 v[212:215], a[36:39], v[36:39], v[212:215]
  s_add_u32 s74, s71, 4096
  s_add_u32 s71, s71, 5120
  buffer_load_dwordx4 a[176:179], v1, s[44:47], s74 offen sc1
  s_cmp_ge_u32 s71, s73
  s_cselect_b32 s74, 245760, 0
  s_sub_u32 s71, s71, s74
  v_mfma_f32_16x16x32_bf16 v[216:219], a[20:23], v[40:43], v[216:219]
  v_mfma_f32_16x16x32_bf16 v[220:223], a[24:27], v[40:43], v[220:223]
  buffer_load_dwordx4 a[180:183], v1, s[44:47], s71 offen offset:0 sc1
  v_mfma_f32_16x16x32_bf16 v[224:227], a[28:31], v[40:43], v[224:227]
  v_mfma_f32_16x16x32_bf16 v[228:231], a[32:35], v[40:43], v[228:231]
  buffer_load_dwordx4 a[184:187], v1, s[44:47], s71 offen offset:1024 sc1
  v_mfma_f32_16x16x32_bf16 v[232:235], a[36:39], v[40:43], v[232:235]
  v_mfma_f32_16x16x32_bf16 v[236:239], a[20:23], v[44:47], v[236:239]
  buffer_load_dwordx4 a[188:191], v1, s[44:47], s71 offen offset:2048 sc1
  v_mfma_f32_16x16x32_bf16 v[240:243], a[24:27], v[44:47], v[240:243]
  v_mfma_f32_16x16x32_bf16 v[244:247], a[28:31], v[44:47], v[244:247]
  buffer_load_dwordx4 a[192:195], v1, s[44:47], s71 offen offset:3072 sc1
  v_mfma_f32_16x16x32_bf16 v[248:251], a[32:35], v[44:47], v[248:251]
  v_mfma_f32_16x16x32_bf16 v[252:255], a[36:39], v[44:47], v[252:255]
  s_add_u32 s74, s71, 4096
  s_add_u32 s71, s71, 5120
  buffer_load_dwordx4 a[196:199], v1, s[44:47], s74 offen sc1
  s_cmp_ge_u32 s71, s73
  s_cselect_b32 s74, 245760, 0
L_st11:
  s_cbranch_execz L_st0
  s_sub_u32 s71, s71, s74
  s_waitcnt vmcnt(46) lgkmcnt(0)
  v_mfma_f32_16x16x32_bf16 v[176:179], a[40:43], v[48:51], v[176:179]
  v_mfma_f32_16x16x32_bf16 v[180:183], a[44:47], v[48:51], v[180:183]
  buffer_load_dwordx4 a[200:203], v1, s[44:47], s71 offen offset:0 sc1
  v_mfma_f32_16x16x32_bf16 v[184:187], a[48:51], v[48:51], v[184:187]
  v_mfma_f32_16x16x32_bf16 v[188:191], a[52:55], v[48:51], v[188:191]
  buffer_load_dwordx4 a[204:207], v1, s[44:47], s71 offen offset:1024 sc1
  v_mfma_f32_16x16x32_bf16 v[192:195], a[56:59], v[48:51], v[192:195]
  v_mfma_f32_16x16x32_bf16 v[196:199], a[40:43], v[52:55], v[196:199]
  buffer_load_dwordx4 a[208:211], v1, s[44:47], s71 offen offset:2048 sc1
  v_mfma_f32_16x16x32_bf16 v[200:203], a[44:47], v[52:55], v[200:203]
  v_mfma_f32_16x16x32_bf16 v[204:207], a[48:51], v[52:55], v[204:207]
  buffer_load_dwordx4 a[212:215], v1, s[44:47], s71 offen offset:3072 sc1
  v_mfma_f32_16x16x32_bf16 v[208:211], a[52:55], v[52:55], v[208:211]
  v_mfma_f32_16x16x32_bf16 v[212:215], a[56:59], v[52:55], v[212:215]
  s_add_u32 s74, s71, 4096
  s_add_u32 s71, s71, 5120
  buffer_load_dwordx4 a[216:219], v1, s[44:47], s74 offen sc1
  s_cmp_ge_u32 s71, s73
  s_cselect_b32 s74, 245760, 0
  s_sub_u32 s71, s71, s74
  v_mfma_f32_16x16x32_bf16 v[216:219], a[40:43], v[56:59], v[216:219]
  v_mfma_f32_16x16x32_bf16 v[220:223], a[44:47], v[56:59], v[220:223]
  buffer_load_dwordx4 a[220:223], v1, s[44:47], s71 offen offset:0 sc1
  v_mfma_f32_16x16x32_bf16 v[224:227], a[48:51], v[56:59], v[224:227]
  v_mfma_f32_16x16x32_bf16 v[228:231], a[52:55], v[56:59], v[228:231]
  buffer_load_dwordx4 a[224:227], v1, s[44:47], s71 offen offset:1024 sc1
  v_mfma_f32_16x16x32_bf16 v[232:235], a[56:59], v[56:59], v[232:235]
  v_mfma_f32_16x16x32_bf16 v[236:239], a[40:43], v[60:63], v[236:239]
  buffer_load_dwordx4 a[228:231], v1, s[44:47], s71 offen offset:2048 sc1
  v_mfma_f32_16x16x32_bf16 v[240:243], a[44:47], v[60:63], v[240:243]
  v_mfma_f32_16x16x32_bf16 v[244:247], a[48:51], v[60:63], v[244:247]
  buffer_load_dwordx4 a[232:235], v1, s[44:47], s71 offen offset:3072 sc1
  v_mfma_f32_16x16x32_bf16 v[248:251], a[52:55], v[60:63], v[248:251]
  v_mfma_f32_16x16x32_bf16 v[252:255], a[56:59], v[60:63], v[252:255]
  s_add_u32 s74, s71, 4096
  s_add_u32 s71, s71, 5120
  buffer_load_dwordx4 a[236:239], v1, s[44:47], s74 offen sc1
  s_cmp_ge_u32 s71, s73
  s_cselect_b32 s74, 245760, 0
  s_sub_u32 s71, s71, s74
  s_waitcnt vmcnt(12)
  buffer_load_dwordx4 a[0:3], v1, s[44:47], s71 offen offset:0 sc1
  s_waitcnt vmcnt(12)
  buffer_load_dwordx4 a[4:7], v1, s[44:47], s71 offen offset:1024 sc1
  s_waitcnt vmcnt(12)
  buffer_load_dwordx4 a[8:11], v1, s[44:47], s71 offen offset:2048 sc1
  s_waitcnt vmcnt(12)
  buffer_load_dwordx4 a[12:15], v1, s[44:47], s71 offen offset:3072 sc1
  s_waitcnt vmcnt(12)
  s_add_u32 s74, s71, 4096
  s_add_u32 s71, s71, 5120
  buffer_load_dwordx4 a[16:19], v1, s[44:47], s74 offen sc1
  s_cmp_ge_u32 s71, s73
  s_cselect_b32 s74, 245760, 0
  s_sub_u32 s71, s71, s74
  v_mov_b32 v5, v7
  s_mov_b32 exec_lo, 0xff
  s_mov_b32 exec_hi, 0
  buffer_load_dword v5, v3, s[44:47], 0 offen sc1
  s_mov_b64 exec, -1
  s_waitcnt vmcnt(0)
  v_cmp_ne_u32 vcc, s61, v5
  s_cbranch_vccnz L_spin_Bi2
L_ret_Bi2:
  s_add_u32 s75, s48, s76
  buffer_load_dwordx4 v[64:67], v1, s[44:47], s75 offen sc1
  s_add_u32 s75, s48, s77
  buffer_load_dwordx4 v[68:71], v1, s[44:47], s75 offen sc1
  s_add_u32 s75, s48, s78
  buffer_load_dwordx4 v[72:75], v1, s[44:47], s75 offen sc1
  s_add_u32 s75, s48, s79
  buffer_load_dwordx4 v[76:79], v1, s[44:47], s75 offen sc1
  s_add_u32 s48, s48, 4096
  s_cmp_eq_u32 s48, s59
  s_cselect_b32 s48, s58, s48
  s_add_u32 s75, s48, s76
  buffer_load_dwordx4 v[80:83], v1, s[44:47], s75 offen sc1
  s_add_u32 s75, s48, s77
  buffer_load_dwordx4 v[84:87], v1, s[44:47], s75 offen sc1
  s_add_u32 s75, s48, s78
  buffer_load_dwordx4 v[88:91], v1, s[44:47], s75 offen sc1
  s_add_u32 s75, s48, s79
  buffer_load_dwordx4 v[92:95], v1, s[44:47], s75 offen sc1
  s_add_u32 s48, s48, 4096
  s_cmp_eq_u32 s48, s59
  s_cselect_b32 s48, s58, s48
  s_add_u32 s75, s48, s76
  buffer_load_dwordx4 v[96:99], v1, s[44:47], s75 offen sc1
  s_add_u32 s75, s48, s77
  buffer_load_dwordx4 v[100:103], v1, s[44:47], s75 offen sc1
  s_add_u32 s75, s48, s78
  buffer_load_dwordx4 v[104:107], v1, s[44:47], s75 offen sc1
  s_add_u32 s75, s48, s79
  buffer_load_dwordx4 v[108:111], v1, s[44:47], s75 offen sc1
  s_add_u32 s48, s48, 4096
  s_cmp_eq_u32 s48, s59
  s_cselect_b32 s48, s58, s48
  s_add_u32 s75, s48, s76
  buffer_load_dwordx4 v[112:115], v1, s[44:47], s75 offen sc1
  s_add_u32 s75, s48, s77
  buffer_load_dwordx4 v[116:119], v1, s[44:47], s75 offen sc1
  s_add_u32 s75, s48, s78
  buffer_load_dwordx4 v[120:123], v1, s[44:47], s75 offen sc1
  s_add_u32 s75, s48, s79
  buffer_load_dwordx4 v[124:127], v1, s[44:47], s75 offen sc1
  s_add_u32 s48, s48, 4096
  s_cmp_eq_u32 s48, s59
  s_cselect_b32 s48, s58, s48
  s_waitcnt vmcnt(15)
  v_mfma_f32_16x16x32_bf16 v[176:179], a[60:63], v[64:67], v[176:179]
  v_mfma_f32_16x16x32_bf16 v[180:183], a[64:67], v[64:67], v[180:183]
  buffer_load_dwordx4 a[20:23], v1, s[44:47], s71 offen offset:0 sc1
  v_mfma_f32_16x16x32_bf16 v[184:187], a[68:71], v[64:67], v[184:187]
  v_mfma_f32_16x16x32_bf16 v[188:191], a[72:75], v[64:67], v[188:191]
  s_add_u32 s75, s48, s76
  buffer_load_dwordx4 v[128:131], v1, s[44:47], s75 offen sc1
  v_mfma_f32_16x16x32_bf16 v[192:195], a[76:79], v[64:67], v[192:195]
  s_waitcnt vmcnt(16)
  v_mfma_f32_16x16x32_bf16 v[196:199], a[60:63], v[68:71], v[196:199]
  buffer_load_dwordx4 a[24:27], v1, s[44:47], s71 offen offset:1024 sc1
  v_mfma_f32_16x16x32_bf16 v[200:203], a[64:67], v[68:71], v[200:203]
  v_mfma_f32_16x16x32_bf16 v[204:207], a[68:71], v[68:71], v[204:207]
  s_add_u32 s75, s48, s77
  buffer_load_dwordx4 v[132:135], v1, s[44:47], s75 offen sc1
  v_mfma_f32_16x16x32_bf16 v[208:211], a[72:75], v[68:71], v[208:211]
  v_mfma_f32_16x16x32_bf16 v[212:215], a[76:79], v[68:71], v[212:215]
  buffer_load_dwordx4 a[28:31], v1, s[44:47], s71 offen offset:2048 sc1
  s_waitcnt vmcnt(18)
  v_mfma_f32_16x16x32_bf16 v[216:219], a[60:63], v[72:75], v[216:219]
  v_mfma_f32_16x16x32_bf16 v[220:223], a[64:67], v[72:75], v[220:223]
  s_add_u32 s75, s48, s78
  buffer_load_dwordx4 v[136:139], v1, s[44:47], s75 offen sc1
  v_mfma_f32_16x16x32_bf16 v[224:227], a[68:71], v[72:75], v[224:227]
  v_mfma_f32_16x16x32_bf16 v[228:231], a[72:75], v[72:75], v[228:231]
  buffer_load_dwordx4 a[32:35], v1, s[44:47], s71 offen offset:3072 sc1
  v_mfma_f32_16x16x32_bf16 v[232:235], a[76:79], v[72:75], v[232:235]
  s_waitcnt vmcnt(19)
  v_mfma_f32_16x16x32_bf16 v[236:239], a[60:63], v[76:79], v[236:239]
  s_add_u32 s75, s48, s79
  buffer_load_dwordx4 v[140:143], v1, s[44:47], s75 offen sc1
  s_add_u32 s48, s48, 4096
  s_cmp_eq_u32 s48, s59
  s_cselect_b32 s48, s58, s48
  v_mfma_f32_16x16x32_bf16 v[240:243], a[64:67], v[76:79], v[240:243]
  v_mfma_f32_16x16x32_bf16 v[244:247], a[68:71], v[76:79], v[244:247]
  s_add_u32 s74, s71, 4096
  s_add_u32 s71, s71, 5120
  buffer_load_dwordx4 a[36:39], v1, s[44:47], s74 offen sc1
  s_cmp_ge_u32 s71, s73
  s_cselect_b32 s74, 245760, 0
  s_sub_u32 s71, s71, s74
  v_mfma_f32_16x16x32_bf16 v[248:251], a[72:75], v[76:79], v[248:251]
  v_mfma_f32_16x16x32_bf16 v[252:255], a[76:79], v[76:79], v[252:255]
  s_add_u32 s75, s48, s76
  buffer_load_dwordx4 v[144:147], v1, s[44:47], s75 offen sc1
  s_waitcnt vmcnt(21)
  v_mfma_f32_16x16x32_bf16 v[176:179], a[80:83], v[80:83], v[176:179]
  v_mfma_f32_16x16x32_bf16 v[180:183], a[84:87], v[80:83], v[180:183]
  buffer_load_dwordx4 a[40:43], v1, s[44:47], s71 offen offset:0 sc1
  v_mfma_f32_16x16x32_bf16 v[184:187], a[88:91], v[80:83], v[184:187]
  v_mfma_f32_16x16x32_bf16 v[188:191], a[92:95], v[80:83], v[188:191]
  s_add_u32 s75, s48, s77
  buffer_load_dwordx4 v[148:151], v1, s[44:47], s75 offen sc1
  v_mfma_f32_16x16x32_bf16 v[192:195], a[96:99], v[80:83], v[192:195]
  s_waitcnt vmcnt(22)
  v_mfma_f32_16x16x32_bf16 v[196:199], a[80:83], v[84:87], v[196:199]
  buffer_load_dwordx4 a[44:47], v1, s[44:47], s71 offen offset:1024 sc1
  v_mfma_f32_16x16x32_bf16 v[200:203], a[84:87], v[84:87], v[200:203]
  v_mfma_f32_16x16x32_bf16 v[204:207], a[88:91], v[84:87], v[204:207]
  s_add_u32 s75, s48, s78
  buffer_load_dwordx4 v[152:155], v1, s[44:47], s75 offen sc1
  v_mfma_f32_16x16x32_bf16 v[208:211], a[92:95], v[84:87], v[208:211]
  v_mfma_f32_16x16x32_bf16 v[212:215], a[96:99], v[84:87], v[212:215]
  buffer_load_dwordx4 a[48:51], v1, s[44:47], s71 offen offset:2048 sc1
  s_waitcnt vmcnt(24)
  v_mfma_f32_16x16x32_bf16 v[216:219], a[80:83], v[88:91], v[216:219]
  v_mfma_f32_16x16x32_bf16 v[220:223], a[84:87], v[88:91], v[220:223]
  s_add_u32 s75, s48, s79
  buffer_load_dwordx4 v[156:159], v1, s[44:47], s75 offen sc1
  s_add_u32 s48, s48, 4096
  s_cmp_eq_u32 s48, s59
  s_cselect_b32 s48, s58, s48
  v_mfma_f32_16x16x32_bf16 v[224:227], a[88:91], v[88:91], v[224:227]
  v_mfma_f32_16x16x32_bf16 v[228:231], a[92:95], v[88:91], v[228:231]
  buffer_load_dwordx4 a[52:55], v1, s[44:47], s71 offen offset:3072 sc1
  v_mfma_f32_16x16x32_bf16 v[232:235], a[96:99], v[88:91], v[232:235]
  s_waitcnt vmcnt(25)
  v_mfma_f32_16x16x32_bf16 v[236:239], a[80:83], v[92:95], v[236:239]
  s_add_u32 s75, s48, s76
  buffer_load_dwordx4 v[160:163], v1, s[44:47], s75 offen sc1
  v_mfma_f32_16x16x32_bf16 v[240:243], a[84:87], v[92:95], v[240:243]
  v_mfma_f32_16x16x32_bf16 v[244:247], a[88:91], v[92:95], v[244:247]
  s_add_u32 s74, s71, 4096
  s_add_u32 s71, s71, 5120
  buffer_load_dwordx4 a[56:59], v1, s[44:47], s74 offen sc1
  s_cmp_ge_u32 s71, s73
  s_cselect_b32 s74, 245760, 0
  s_sub_u32 s71, s71, s74
  v_mfma_f32_16x16x32_bf16 v[248:251], a[92:95], v[92:95], v[248:251]
  v_mfma_f32_16x16x32_bf16 v[252:255], a[96:99], v[92:95], v[252:255]
  s_add_u32 s75, s48, s77
  buffer_load_dwordx4 v[164:167], v1, s[44:47], s75 offen sc1
  s_waitcnt vmcnt(27)
  v_mfma_f32_16x16x32_bf16 v[176:179], a[100:103], v[96:99], v[176:179]
  v_mfma_f32_16x16x32_bf16 v[180:183], a[104:107], v[96:99], v[180:183]
  v_mfma_f32_16x16x32_bf16 v[184:187], a[108:111], v[96:99], v[184:187]
  v_mfma_f32_16x16x32_bf16 v[188:191], a[112:115], v[96:99], v[188:191]
  s_add_u32 s75, s48, s78
  buffer_load_dwordx4 v[168:171], v1, s[44:47], s75 offen sc1
  v_mfma_f32_16x16x32_bf16 v[192:195], a[116:119], v[96:99], v[192:195]
  s_waitcnt vmcnt(27)
  v_mfma_f32_16x16x32_bf16 v[196:199], a[100:103], v[100:103], v[196:199]
  v_mfma_f32_16x16x32_bf16 v[200:203], a[104:107], v[100:103], v[200:203]
  v_mfma_f32_16x16x32_bf16 v[204:207], a[108:111], v[100:103], v[204:207]
  s_add_u32 s75, s48, s79
  buffer_load_dwordx4 v[172:175], v1, s[44:47], s75 offen sc1
  s_add_u32 s48, s48, 4096
  s_cmp_eq_u32 s48, s59
  s_cselect_b32 s48, s58, s48
  v_mfma_f32_16x16x32_bf16 v[208:211], a[112:115], v[100:103], v[208:211]
  v_mfma_f32_16x16x32_bf16 v[212:215], a[116:119], v[100:103], v[212:215]
  s_waitcnt vmcnt(27)
  v_mfma_f32_16x16x32_bf16 v[216:219], a[100:103], v[104:107], v[216:219]
  v_mfma_f32_16x16x32_bf16 v[220:223], a[104:107], v[104:107], v[220:223]
  s_add_u32 s75, s48, s76
  buffer_load_dwordx4 v[16:19], v1, s[44:47], s75 offen sc1
  v_mfma_f32_16x16x32_bf16 v[224:227], a[108:111], v[104:107], v[224:227]
  v_mfma_f32_16x16x32_bf16 v[228:231], a[112:115], v[104:107], v[228:231]
  v_mfma_f32_16x16x32_bf16 v[232:235], a[116:119], v[104:107], v[232:235]
  s_waitcnt vmcnt(27)
  v_mfma_f32_16x16x32_bf16 v[236:239], a[100:103], v[108:111], v[236:239]
  s_add_u32 s75, s48, s77
  buffer_load_dwordx4 v[20:23], v1, s[44:47], s75 offen sc1
  v_mfma_f32_16x16x32_bf16 v[240:243], a[104:107], v[108:111], v[240:243]
  v_mfma_f32_16x16x32_bf16 v[244:247], a[108:111], v[108:111], v[244:247]
  v_mfma_f32_16x16x32_bf16 v[248:251], a[112:115], v[108:111], v[248:251]
  v_mfma_f32_16x16x32_bf16 v[252:255], a[116:119], v[108:111], v[252:255]
  s_add_u32 s75, s48, s78
  buffer_load_dwordx4 v[24:27], v1, s[44:47], s75 offen sc1
  s_waitcnt vmcnt(28)
  v_mfma_f32_16x16x32_bf16 v[176:179], a[120:123], v[112:115], v[176:179]
  v_mfma_f32_16x16x32_bf16 v[180:183], a[124:127], v[112:115], v[180:183]
  v_mfma_f32_16x16x32_bf16 v[184:187], a[128:131], v[112:115], v[184:187]
  v_mfma_f32_16x16x32_bf16 v[188:191], a[132:135], v[112:115], v[188:191]
  s_add_u32 s75, s48, s79
  buffer_load_dwordx4 v[28:31], v1, s[44:47], s75 offen sc1
  s_add_u32 s48, s48, 4096
  s_cmp_eq_u32 s48, s59
  s_cselect_b32 s48, s58, s48
  v_mfma_f32_16x16x32_bf16 v[192:195], a[136:139], v[112:115], v[192:195]
  s_waitcnt vmcnt(28)
  v_mfma_f32_16x16x32_bf16 v[196:199], a[120:123], v[116:119], v[196:199]
  v_mfma_f32_16x16x32_bf16 v[200:203], a[124:127], v[116:119], v[200:203]
  v_mfma_f32_16x16x32_bf16 v[204:207], a[128:131], v[116:119], v[204:207]
  s_add_u32 s75, s48, s76
  buffer_load_dwordx4 v[32:35], v1, s[44:47], s75 offen sc1
  v_mfma_f32_16x16x32_bf16 v[208:211], a[132:135], v[116:119], v[208:211]
  v_mfma_f32_16x16x32_bf16 v[212:215], a[136:139], v[116:119], v[212:215]
  s_waitcnt vmcnt(28)
  v_mfma_f32_16x16x32_bf16 v[216:219], a[120:123], v[120:123], v[216:219]
  v_mfma_f32_16x16x32_bf16 v[220:223], a[124:127], v[120:123], v[220:223]
  s_add_u32 s75, s48, s77
  buffer_load_dwordx4 v[36:39], v1, s[44:47], s75 offen sc1
  v_mfma_f32_16x16x32_bf16 v[224:227], a[128:131], v[120:123], v[224:227]
  v_mfma_f32_16x16x32_bf16 v[228:231], a[132:135], v[120:123], v[228:231]
  v_mfma_f32_16x16x32_bf16 v[232:235], a[136:139], v[120:123], v[232:235]
  s_waitcnt vmcnt(28)
  v_mfma_f32_16x16x32_bf16 v[236:239], a[120:123], v[124:127], v[236:239]
  s_add_u32 s75, s48, s78
  buffer_load_dwordx4 v[40:43], v1, s[44:47], s75 offen sc1
  v_mfma_f32_16x16x32_bf16 v[240:243], a[124:127], v[124:127], v[240:243]
  v_mfma_f32_16x16x32_bf16 v[244:247], a[128:131], v[124:127], v[244:247]
  v_mfma_f32_16x16x32_bf16 v[248:251], a[132:135], v[124:127], v[248:251]
  v_mfma_f32_16x16x32_bf16 v[252:255], a[136:139], v[124:127], v[252:255]
  s_add_u32 s75, s48, s79
  buffer_load_dwordx4 v[44:47], v1, s[44:47], s75 offen sc1
  s_add_u32 s48, s48, 4096
  s_cmp_eq_u32 s48, s59
  s_cselect_b32 s48, s58, s48
  s_waitcnt vmcnt(28)
  v_mfma_f32_16x16x32_bf16 v[176:179], a[140:143], v[128:131], v[176:179]
  v_mfma_f32_16x16x32_bf16 v[180:183], a[144:147], v[128:131], v[180:183]
  v_mfma_f32_16x16x32_bf16 v[184:187], a[148:151], v[128:131], v[184:187]
  v_mfma_f32_16x16x32_bf16 v[188:191], a[152:155], v[128:131], v[188:191]
  s_add_u32 s75, s48, s76
  buffer_load_dwordx4 v[48:51], v1, s[44:47], s75 offen sc1
  v_mfma_f32_16x16x32_bf16 v[192:195], a[156:159], v[128:131], v[192:195]
  s_waitcnt vmcnt(27)
  v_mfma_f32_16x16x32_bf16 v[196:199], a[140:143], v[132:135], v[196:199]
  v_mfma_f32_16x16x32_bf16 v[200:203], a[144:147], v[132:135], v[200:203]
  v_mfma_f32_16x16x32_bf16 v[204:207], a[148:151], v[132:135], v[204:207]
  s_add_u32 s75, s48, s77
  buffer_load_dwordx4 v[52:55], v1, s[44:47], s75 offen sc1
  v_mfma_f32_16x16x32_bf16 v[208:211], a[152:155], v[132:135], v[208:211]
  v_mfma_f32_16x16x32_bf16 v[212:215], a[156:159], v[132:135], v[212:215]
  s_waitcnt vmcnt(26)
  v_mfma_f32_16x16x32_bf16 v[216:219], a[140:143], v[136:139], v[216:219]
  v_mfma_f32_16x16x32_bf16 v[220:223], a[144:147], v[136:139], v[220:223]
  s_add_u32 s75, s48, s78
  buffer_load_dwordx4 v[56:59], v1, s[44:47], s75 offen sc1
  v_mfma_f32_16x16x32_bf16 v[224:227], a[148:151], v[136:139], v[224:227]
  v_mfma_f32_16x16x32_bf16 v[228:231], a[152:155], v[136:139], v[228:231]
  v_mfma_f32_16x16x32_bf16 v[232:235], a[156:159], v[136:139], v[232:235]
  s_waitcnt vmcnt(25)
  v_mfma_f32_16x16x32_bf16 v[236:239], a[140:143], v[140:143], v[236:239]
  s_add_u32 s75, s48, s79
  buffer_load_dwordx4 v[60:63], v1, s[44:47], s75 offen sc1
  s_add_u32 s48, s48, 4096
  s_cmp_eq_u32 s48, s59
  s_cselect_b32 s48, s58, s48
  v_mfma_f32_16x16x32_bf16 v[240:243], a[144:147], v[140:143], v[240:243]
  v_mfma_f32_16x16x32_bf16 v[244:247], a[148:151], v[140:143], v[244:247]
  v_mfma_f32_16x16x32_bf16 v[248:251], a[152:155], v[140:143], v[248:251]
  v_mfma_f32_16x16x32_bf16 v[252:255], a[156:159], v[140:143], v[252:255]
  s_add_u32 s75, s48, s76
  buffer_load_dwordx4 v[64:67], v1, s[44:47], s75 offen sc1
  s_waitcnt vmcnt(25)
  v_mfma_f32_16x16x32_bf16 v[176:179], a[160:163], v[144:147], v[176:179]
  v_mfma_f32_16x16x32_bf16 v[180:183], a[164:167], v[144:147], v[180:183]
  v_mfma_f32_16x16x32_bf16 v[184:187], a[168:171], v[144:147], v[184:187]
  v_mfma_f32_16x16x32_bf16 v[188:191], a[172:175], v[144:147], v[188:191]
  s_add_u32 s75, s48, s77
  buffer_load_dwordx4 v[68:71], v1, s[44:47], s75 offen sc1
  v_mfma_f32_16x16x32_bf16 v[192:195], a[176:179], v[144:147], v[192:195]
  s_waitcnt vmcnt(24)
  v_mfma_f32_16x16x32_bf16 v[196:199], a[160:163], v[148:151], v[196:199]
  v_mfma_f32_16x16x32_bf16 v[200:203], a[164:167], v[148:151], v[200:203]
  v_mfma_f32_16x16x32_bf16 v[204:207], a[168:171], v[148:151], v[204:207]
  s_add_u32 s75, s48, s78
  buffer_load_dwordx4 v[72:75], v1, s[44:47], s75 offen sc1
  v_mfma_f32_16x16x32_bf16 v[208:211], a[172:175], v[148:151], v[208:211]
  v_mfma_f32_16x16x32_bf16 v[212:215], a[176:179], v[148:151], v[212:215]
  s_waitcnt vmcnt(23)
  v_mfma_f32_16x16x32_bf16 v[216:219], a[160:163], v[152:155], v[216:219]
  v_mfma_f32_16x16x32_bf16 v[220:223], a[164:167], v[152:155], v[220:223]
  s_add_u32 s75, s48, s79
  buffer_load_dwordx4 v[76:79], v1, s[44:47], s75 offen sc1
  s_add_u32 s48, s48, 4096
  s_cmp_eq_u32 s48, s59
  s_cselect_b32 s48, s58, s48
  v_mfma_f32_16x16x32_bf16 v[224:227], a[168:171], v[152:155], v[224:227]
  v_mfma_f32_16x16x32_bf16 v[228:231], a[172:175], v[152:155], v[228:231]
  v_mfma_f32_16x16x32_bf16 v[232:235], a[176:179], v[152:155], v[232:235]
  s_waitcnt vmcnt(22)
  v_mfma_f32_16x16x32_bf16 v[236:239], a[160:163], v[156:159], v[236:239]
  s_add_u32 s75, s48, s76
  buffer_load_dwordx4 v[80:83], v1, s[44:47], s75 offen sc1
  v_mfma_f32_16x16x32_bf16 v[240:243], a[164:167], v[156:159], v[240:243]
  v_mfma_f32_16x16x32_bf16 v[244:247], a[168:171], v[156:159], v[244:247]
  v_mfma_f32_16x16x32_bf16 v[248:251], a[172:175], v[156:159], v[248:251]
  v_mfma_f32_16x16x32_bf16 v[252:255], a[176:179], v[156:159], v[252:255]
  s_add_u32 s75, s48, s77
  buffer_load_dwordx4 v[84:87], v1, s[44:47], s75 offen sc1
  s_waitcnt vmcnt(22)
  v_mfma_f32_16x16x32_bf16 v[176:179], a[180:183], v[160:163], v[176:179]
  v_mfma_f32_16x16x32_bf16 v[180:183], a[184:187], v[160:163], v[180:183]
  v_mfma_f32_16x16x32_bf16 v[184:187], a[188:191], v[160:163], v[184:187]
  v_mfma_f32_16x16x32_bf16 v[188:191], a[192:195], v[160:163], v[188:191]
  s_add_u32 s75, s48, s78
  buffer_load_dwordx4 v[88:91], v1, s[44:47], s75 offen sc1
  v_mfma_f32_16x16x32_bf16 v[192:195], a[196:199], v[160:163], v[192:195]
  s_waitcnt vmcnt(21)
  v_mfma_f32_16x16x32_bf16 v[196:199], a[180:183], v[164:167], v[196:199]
  v_mfma_f32_16x16x32_bf16 v[200:203], a[184:187], v[164:167], v[200:203]
  v_mfma_f32_16x16x32_bf16 v[204:207], a[188:191], v[164:167], v[204:207]
  s_add_u32 s75, s48, s79
  buffer_load_dwordx4 v[92:95], v1, s[44:47], s75 offen sc1
  s_add_u32 s48, s48, 4096
  s_cmp_eq_u32 s48, s59
  s_cselect_b32 s48, s58, s48
  v_mfma_f32_16x16x32_bf16 v[208:211], a[192:195], v[164:167], v[208:211]
  v_mfma_f32_16x16x32_bf16 v[212:215], a[196:199], v[164:167], v[212:215]
  s_waitcnt vmcnt(21)
  v_mfma_f32_16x16x32_bf16 v[216:219], a[180:183], v[168:171], v[216:219]
  v_mfma_f32_16x16x32_bf16 v[220:223], a[184:187], v[168:171], v[220:223]
  v_mfma_f32_16x16x32_bf16 v[224:227], a[188:191], v[168:171], v[224:227]
  v_mfma_f32_16x16x32_bf16 v[228:231], a[192:195], v[168:171], v[228:231]
  v_mfma_f32_16x16x32_bf16 v[232:235], a[196:199], v[168:171], v[232:235]
  s_waitcnt vmcnt(20)
  v_mfma_f32_16x16x32_bf16 v[236:239], a[180:183], v[172:175], v[236:239]
  v_mfma_f32_16x16x32_bf16 v[240:243], a[184:187], v[172:175], v[240:243]
  v_mfma_f32_16x16x32_bf16 v[244:247], a[188:191], v[172:175], v[244:247]
  v_mfma_f32_16x16x32_bf16 v[248:251], a[192:195], v[172:175], v[248:251]
  v_mfma_f32_16x16x32_bf16 v[252:255], a[196:199], v[172:175], v[252:255]
  s_waitcnt vmcnt(19)
  v_mfma_f32_16x16x32_bf16 v[176:179], a[200:203], v[16:19], v[176:179]
  v_mfma_f32_16x16x32_bf16 v[180:183], a[204:207], v[16:19], v[180:183]
  v_mfma_f32_16x16x32_bf16 v[184:187], a[208:211], v[16:19], v[184:187]
  v_mfma_f32_16x16x32_bf16 v[188:191], a[212:215], v[16:19], v[188:191]
  v_mfma_f32_16x16x32_bf16 v[192:195], a[216:219], v[16:19], v[192:195]
  s_waitcnt vmcnt(18)
  v_mfma_f32_16x16x32_bf16 v[196:199], a[200:203], v[20:23], v[196:199]
  v_mfma_f32_16x16x32_bf16 v[200:203], a[204:207], v[20:23], v[200:203]
  v_mfma_f32_16x16x32_bf16 v[204:207], a[208:211], v[20:23], v[204:207]
  v_mfma_f32_16x16x32_bf16 v[208:211], a[212:215], v[20:23], v[208:211]
  v_mfma_f32_16x16x32_bf16 v[212:215], a[216:219], v[20:23], v[212:215]
  s_waitcnt vmcnt(17)
  v_mfma_f32_16x16x32_bf16 v[216:219], a[200:203], v[24:27], v[216:219]
  v_mfma_f32_16x16x32_bf16 v[220:223], a[204:207], v[24:27], v[220:223]
  v_mfma_f32_16x16x32_bf16 v[224:227], a[208:211], v[24:27], v[224:227]
  v_mfma_f32_16x16x32_bf16 v[228:231], a[212:215], v[24:27], v[228:231]
  v_mfma_f32_16x16x32_bf16 v[232:235], a[216:219], v[24:27], v[232:235]
  s_waitcnt vmcnt(16)
  v_mfma_f32_16x16x32_bf16 v[236:239], a[200:203], v[28:31], v[236:239]
  v_mfma_f32_16x16x32_bf16 v[240:243], a[204:207], v[28:31], v[240:243]
  v_mfma_f32_16x16x32_bf16 v[244:247], a[208:211], v[28:31], v[244:247]
  v_mfma_f32_16x16x32_bf16 v[248:251], a[212:215], v[28:31], v[248:251]
  v_mfma_f32_16x16x32_bf16 v[252:255], a[216:219], v[28:31], v[252:255]
  s_waitcnt vmcnt(15)
  v_mfma_f32_16x16x32_bf16 v[176:179], a[220:223], v[32:35], v[176:179]
  v_mfma_f32_16x16x32_bf16 v[180:183], a[224:227], v[32:35], v[180:183]
  v_mfma_f32_16x16x32_bf16 v[184:187], a[228:231], v[32:35], v[184:187]
  v_mfma_f32_16x16x32_bf16 v[188:191], a[232:235], v[32:35], v[188:191]
  v_mfma_f32_16x16x32_bf16 v[192:195], a[236:239], v[32:35], v[192:195]
  s_waitcnt vmcnt(14)
  v_mfma_f32_16x16x32_bf16 v[196:199], a[220:223], v[36:39], v[196:199]
  v_mfma_f32_16x16x32_bf16 v[200:203], a[224:227], v[36:39], v[200:203]
  v_mfma_f32_16x16x32_bf16 v[204:207], a[228:231], v[36:39], v[204:207]
  v_mfma_f32_16x16x32_bf16 v[208:211], a[232:235], v[36:39], v[208:211]
  v_mfma_f32_16x16x32_bf16 v[212:215], a[236:239], v[36:39], v[212:215]
  s_waitcnt vmcnt(13)
  v_mfma_f32_16x16x32_bf16 v[216:219], a[220:223], v[40:43], v[216:219]
  v_mfma_f32_16x16x32_bf16 v[220:223], a[224:227], v[40:43], v[220:223]
  v_mfma_f32_16x16x32_bf16 v[224:227], a[228:231], v[40:43], v[224:227]
  v_mfma_f32_16x16x32_bf16 v[228:231], a[232:235], v[40:43], v[228:231]
  v_mfma_f32_16x16x32_bf16 v[232:235], a[236:239], v[40:43], v[232:235]
  s_waitcnt vmcnt(12)
  v_mfma_f32_16x16x32_bf16 v[236:239], a[220:223], v[44:47], v[236:239]
  v_mfma_f32_16x16x32_bf16 v[240:243], a[224:227], v[44:47], v[240:243]
  v_mfma_f32_16x16x32_bf16 v[244:247], a[228:231], v[44:47], v[244:247]
  v_mfma_f32_16x16x32_bf16 v[248:251], a[232:235], v[44:47], v[248:251]
  v_mfma_f32_16x16x32_bf16 v[252:255], a[236:239], v[44:47], v[252:255]
  s_waitcnt vmcnt(11)
  v_mfma_f32_16x16x32_bf16 v[176:179], a[0:3], v[48:51], v[176:179]
  v_mfma_f32_16x16x32_bf16 v[180:183], a[4:7], v[48:51], v[180:183]
  v_mfma_f32_16x16x32_bf16 v[184:187], a[8:11], v[48:51], v[184:187]
  v_mfma_f32_16x16x32_bf16 v[188:191], a[12:15], v[48:51], v[188:191]
  v_mfma_f32_16x16x32_bf16 v[192:195], a[16:19], v[48:51], v[192:195]
  s_waitcnt vmcnt(10)
  v_mfma_f32_16x16x32_bf16 v[196:199], a[0:3], v[52:55], v[196:199]
  v_mfma_f32_16x16x32_bf16 v[200:203], a[4:7], v[52:55], v[200:203]
  v_mfma_f32_16x16x32_bf16 v[204:207], a[8:11], v[52:55], v[204:207]
  v_mfma_f32_16x16x32_bf16 v[208:211], a[12:15], v[52:55], v[208:211]
  v_mfma_f32_16x16x32_bf16 v[212:215], a[16:19], v[52:55], v[212:215]
  s_waitcnt vmcnt(9)
  v_mfma_f32_16x16x32_bf16 v[216:219], a[0:3], v[56:59], v[216:219]
  v_mfma_f32_16x16x32_bf16 v[220:223], a[4:7], v[56:59], v[220:223]
  v_mfma_f32_16x16x32_bf16 v[224:227], a[8:11], v[56:59], v[224:227]
  v_mfma_f32_16x16x32_bf16 v[228:231], a[12:15], v[56:59], v[228:231]
  v_mfma_f32_16x16x32_bf16 v[232:235], a[16:19], v[56:59], v[232:235]
  s_waitcnt vmcnt(8)
  v_mfma_f32_16x16x32_bf16 v[236:239], a[0:3], v[60:63], v[236:239]
  v_mfma_f32_16x16x32_bf16 v[240:243], a[4:7], v[60:63], v[240:243]
  v_mfma_f32_16x16x32_bf16 v[244:247], a[8:11], v[60:63], v[244:247]
  v_mfma_f32_16x16x32_bf16 v[248:251], a[12:15], v[60:63], v[248:251]
  v_mfma_f32_16x16x32_bf16 v[252:255], a[16:19], v[60:63], v[252:255]
  s_waitcnt vmcnt(7)
  v_mfma_f32_16x16x32_bf16 v[176:179], a[20:23], v[64:67], v[176:179]
  v_mfma_f32_16x16x32_bf16 v[180:183], a[24:27], v[64:67], v[180:183]
  v_mfma_f32_16x16x32_bf16 v[184:187], a[28:31], v[64:67], v[184:187]
  v_mfma_f32_16x16x32_bf16 v[188:191], a[32:35], v[64:67], v[188:191]
  v_mfma_f32_16x16x32_bf16 v[192:195], a[36:39], v[64:67], v[192:195]
  s_waitcnt vmcnt(6)
  v_mfma_f32_16x16x32_bf16 v[196:199], a[20:23], v[68:71], v[196:199]
  v_mfma_f32_16x16x32_bf16 v[200:203], a[24:27], v[68:71], v[200:203]
  v_mfma_f32_16x16x32_bf16 v[204:207], a[28:31], v[68:71], v[204:207]
  v_mfma_f32_16x16x32_bf16 v[208:211], a[32:35], v[68:71], v[208:211]
  v_mfma_f32_16x16x32_bf16 v[212:215], a[36:39], v[68:71], v[212:215]
  s_waitcnt vmcnt(5)
  v_mfma_f32_16x16x32_bf16 v[216:219], a[20:23], v[72:75], v[216:219]
  v_mfma_f32_16x16x32_bf16 v[220:223], a[24:27], v[72:75], v[220:223]
  v_mfma_f32_16x16x32_bf16 v[224:227], a[28:31], v[72:75], v[224:227]
  v_mfma_f32_16x16x32_bf16 v[228:231], a[32:35], v[72:75], v[228:231]
  v_mfma_f32_16x16x32_bf16 v[232:235], a[36:39], v[72:75], v[232:235]
  s_waitcnt vmcnt(4)
  v_mfma_f32_16x16x32_bf16 v[236:239], a[20:23], v[76:79], v[236:239]
  v_mfma_f32_16x16x32_bf16 v[240:243], a[24:27], v[76:79], v[240:243]
  v_mfma_f32_16x16x32_bf16 v[244:247], a[28:31], v[76:79], v[244:247]
  v_mfma_f32_16x16x32_bf16 v[248:251], a[32:35], v[76:79], v[248:251]
  v_mfma_f32_16x16x32_bf16 v[252:255], a[36:39], v[76:79], v[252:255]
  s_waitcnt vmcnt(3)
  v_mfma_f32_16x16x32_bf16 v[176:179], a[40:43], v[80:83], v[176:179]
  v_mfma_f32_16x16x32_bf16 v[180:183], a[44:47], v[80:83], v[180:183]
  v_mfma_f32_16x16x32_bf16 v[184:187], a[48:51], v[80:83], v[184:187]
  v_mfma_f32_16x16x32_bf16 v[188:191], a[52:55], v[80:83], v[188:191]
  v_mfma_f32_16x16x32_bf16 v[192:195], a[56:59], v[80:83], v[192:195]
  s_waitcnt vmcnt(2)
  v_mfma_f32_16x16x32_bf16 v[196:199], a[40:43], v[84:87], v[196:199]
  s_mul_i32 s84, s76, 15
  s_add_u32 s84, s84, 0
  v_add_u32 v8, s84, v1
  v_mfma_f32_16x16x32_bf16 v[200:203], a[44:47], v[84:87], v[200:203]
  ds_write_b128 v8, v[176:179] offset:0
  ds_write_b128 v8, v[180:183] offset:1024
  v_mfma_f32_16x16x32_bf16 v[204:207], a[48:51], v[84:87], v[204:207]
  ds_write_b128 v8, v[184:187] offset:2048
  ds_write_b128 v8, v[188:191] offset:3072
  v_mfma_f32_16x16x32_bf16 v[208:211], a[52:55], v[84:87], v[208:211]
  ds_write_b128 v8, v[192:195] offset:4096
  v_mfma_f32_16x16x32_bf16 v[212:215], a[56:59], v[84:87], v[212:215]
  s_waitcnt vmcnt(1)
  v_mfma_f32_16x16x32_bf16 v[216:219], a[40:43], v[88:91], v[216:219]
  s_mul_i32 s84, s77, 15
  s_add_u32 s84, s84, 5120
  v_add_u32 v8, s84, v1
  v_mfma_f32_16x16x32_bf16 v[220:223], a[44:47], v[88:91], v[220:223]
  ds_write_b128 v8, v[196:199] offset:0
  ds_write_b128 v8, v[200:203] offset:1024
  v_mfma_f32_16x16x32_bf16 v[224:227], a[48:51], v[88:91], v[224:227]
  ds_write_b128 v8, v[204:207] offset:2048
  ds_write_b128 v8, v[208:211] offset:3072
  v_mfma_f32_16x16x32_bf16 v[228:231], a[52:55], v[88:91], v[228:231]
  ds_write_b128 v8, v[212:215] offset:4096
  v_mfma_f32_16x16x32_bf16 v[232:235], a[56:59], v[88:91], v[232:235]
  s_waitcnt vmcnt(0)
  v_mfma_f32_16x16x32_bf16 v[236:239], a[40:43], v[92:95], v[236:239]
  s_mul_i32 s84, s78, 15
  s_add_u32 s84, s84, 10240
  v_add_u32 v8, s84, v1
  v_mfma_f32_16x16x32_bf16 v[240:243], a[44:47], v[92:95], v[240:243]
  ds_write_b128 v8, v[216:219] offset:0
  ds_write_b128 v8, v[220:223] offset:1024
  v_mfma_f32_16x16x32_bf16 v[244:247], a[48:51], v[92:95], v[244:247]
  ds_write_b128 v8, v[224:227] offset:2048
  ds_write_b128 v8, v[228:231] offset:3072
  v_mfma_f32_16x16x32_bf16 v[248:251], a[52:55], v[92:95], v[248:251]
  ds_write_b128 v8, v[232:235] offset:4096
  v_mfma_f32_16x16x32_bf16 v[252:255], a[56:59], v[92:95], v[252:255]
  s_waitcnt vmcnt(63)
  ds_read_b64 v[96:97], v11 offset:0
  ds_read_b64 v[98:99], v11 offset:32
  ds_read_b64 v[100:101], v11 offset:64
  ds_read_b64 v[102:103], v11 offset:96
  ds_read_b64 v[104:105], v11 offset:128
  v_lshrrev_b32 v3, 2, v0
  v_lshlrev_b32 v3, 13, v3
  v_and_b32 v4, 3, v0
  v_lshl_add_u32 v3, v4, 4, v3
  s_mul_i32 s80, s5, 655360
  s_lshl_b32 s81, s4, 8
  s_add_u32 s80, s80, s81
  s_lshl_b32 s81, s6, 6
  s_add_u32 s80, s80, s81
  s_add_u32 s80, s80, 16932864
  s_add_u32 s81, s80, 131072
  s_add_u32 s82, s81, 131072
  s_add_u32 s83, s82, 131072
  s_add_u32 s85, s83, 131072
  s_mul_i32 s84, s6, 15360
  s_waitcnt lgkmcnt(0)
  v_add_u32 v109, s84, v1
  s_barrier
  buffer_load_dwordx4 v[16:19], v3, s[44:47], s80 offen sc1
  buffer_load_dwordx4 v[20:23], v3, s[44:47], s81 offen sc1
  buffer_load_dwordx4 v[24:27], v3, s[44:47], s82 offen sc1
  buffer_load_dwordx4 v[28:31], v3, s[44:47], s83 offen sc1
  buffer_load_dwordx4 v[32:35], v3, s[44:47], s85 offen sc1
  ds_read_b128 v[176:179], v109 offset:0
  ds_read_b128 v[180:183], v109 offset:1024
  ds_read_b128 v[184:187], v109 offset:2048
  ds_read_b128 v[188:191], v109 offset:3072
  ds_read_b128 v[192:195], v109 offset:4096
  ds_read_b128 v[196:199], v109 offset:5120
  ds_read_b128 v[200:203], v109 offset:6144
  ds_read_b128 v[204:207], v109 offset:7168
  ds_read_b128 v[208:211], v109 offset:8192
  ds_read_b128 v[212:215], v109 offset:9216
  ds_read_b128 v[216:219], v109 offset:10240
  ds_read_b128 v[220:223], v109 offset:11264
  ds_read_b128 v[224:227], v109 offset:12288
  ds_read_b128 v[228:231], v109 offset:13312
  ds_read_b128 v[232:235], v109 offset:14336
  v_lshlrev_b32 v112, 16, v96
  v_and_b32 v113, 0xffff0000, v96
  v_mul_f32 v112, v12, v112
  v_mul_f32 v113, v12, v113
  v_lshlrev_b32 v114, 16, v97
  v_and_b32 v115, 0xffff0000, v97
  v_mul_f32 v114, v12, v114
  v_mul_f32 v115, v12, v115
  v_lshlrev_b32 v116, 16, v98
  v_and_b32 v117, 0xffff0000, v98
  v_mul_f32 v116, v12, v116
  v_mul_f32 v117, v12, v117
  v_lshlrev_b32 v118, 16, v99
  v_and_b32 v119, 0xffff0000, v99
  v_mul_f32 v118, v12, v118
  v_mul_f32 v119, v12, v119
  v_lshlrev_b32 v120, 16, v100
  v_and_b32 v121, 0xffff0000, v100
  v_mul_f32 v120, v12, v120
  v_mul_f32 v121, v12, v121
  v_lshlrev_b32 v122, 16, v101
  v_and_b32 v123, 0xffff0000, v101
  v_mul_f32 v122, v12, v122
  v_mul_f32 v123, v12, v123
  v_lshlrev_b32 v124, 16, v102
  v_and_b32 v125, 0xffff0000, v102
  v_mul_f32 v124, v12, v124
  v_mul_f32 v125, v12, v125
  v_lshlrev_b32 v126, 16, v103
  v_and_b32 v127, 0xffff0000, v103
L_st12:
  s_cbranch_execz L_st10
  v_mul_f32 v126, v12, v126
  v_mul_f32 v127, v12, v127
  v_lshlrev_b32 v128, 16, v104
  v_and_b32 v129, 0xffff0000, v104
  v_mul_f32 v128, v12, v128
  v_mul_f32 v129, v12, v129
  v_lshlrev_b32 v130, 16, v105
  v_and_b32 v131, 0xffff0000, v105
  v_mul_f32 v130, v12, v130
  v_mul_f32 v131, v12, v131
  s_waitcnt lgkmcnt(14)
  v_pk_mul_f32 v[176:177], v[176:177], v[14:15]
  v_pk_mul_f32 v[178:179], v[178:179], v[14:15]
  s_waitcnt lgkmcnt(13)
  v_pk_mul_f32 v[180:181], v[180:181], v[14:15]
  v_pk_mul_f32 v[182:183], v[182:183], v[14:15]
  s_waitcnt lgkmcnt(12)
  v_pk_mul_f32 v[184:185], v[184:185], v[14:15]
  v_pk_mul_f32 v[186:187], v[186:187], v[14:15]
  s_waitcnt lgkmcnt(11)
  v_pk_mul_f32 v[188:189], v[188:189], v[14:15]
  v_pk_mul_f32 v[190:191], v[190:191], v[14:15]
  s_waitcnt lgkmcnt(10)
  v_pk_mul_f32 v[192:193], v[192:193], v[14:15]
  v_pk_mul_f32 v[194:195], v[194:195], v[14:15]
  s_waitcnt lgkmcnt(9)
  v_pk_fma_f32 v[176:177], v[196:197], v[14:15], v[176:177]
  v_pk_fma_f32 v[178:179], v[198:199], v[14:15], v[178:179]
  s_waitcnt lgkmcnt(8)
  v_pk_fma_f32 v[180:181], v[200:201], v[14:15], v[180:181]
  v_pk_fma_f32 v[182:183], v[202:203], v[14:15], v[182:183]
  s_waitcnt lgkmcnt(7)
  v_pk_fma_f32 v[184:185], v[204:205], v[14:15], v[184:185]
  v_pk_fma_f32 v[186:187], v[206:207], v[14:15], v[186:187]
  s_waitcnt lgkmcnt(6)
  v_pk_fma_f32 v[188:189], v[208:209], v[14:15], v[188:189]
  v_pk_fma_f32 v[190:191], v[210:211], v[14:15], v[190:191]
  s_waitcnt lgkmcnt(5)
  v_pk_fma_f32 v[192:193], v[212:213], v[14:15], v[192:193]
  v_pk_fma_f32 v[194:195], v[214:215], v[14:15], v[194:195]
  s_waitcnt lgkmcnt(4)
  v_pk_fma_f32 v[176:177], v[216:217], v[14:15], v[176:177]
  v_pk_fma_f32 v[178:179], v[218:219], v[14:15], v[178:179]
  s_waitcnt lgkmcnt(3)
  v_pk_fma_f32 v[180:181], v[220:221], v[14:15], v[180:181]
  v_pk_fma_f32 v[182:183], v[222:223], v[14:15], v[182:183]
  s_waitcnt lgkmcnt(2)
  v_pk_fma_f32 v[184:185], v[224:225], v[14:15], v[184:185]
  v_pk_fma_f32 v[186:187], v[226:227], v[14:15], v[186:187]
  s_waitcnt lgkmcnt(1)
  v_pk_fma_f32 v[188:189], v[228:229], v[14:15], v[188:189]
  v_pk_fma_f32 v[190:191], v[230:231], v[14:15], v[190:191]
  s_waitcnt lgkmcnt(0)
  v_pk_fma_f32 v[192:193], v[232:233], v[14:15], v[192:193]
  v_pk_fma_f32 v[194:195], v[234:235], v[14:15], v[194:195]
  s_waitcnt vmcnt(0)
  v_bitop3_b32 v19, v17, v19, v6 bitop3:0x7e
  v_bitop3_b32 v23, v21, v23, v6 bitop3:0x7e
  v_bitop3_b32 v27, v25, v27, v6 bitop3:0x7e
  v_bitop3_b32 v31, v29, v31, v6 bitop3:0x7e
  v_bitop3_b32 v35, v33, v35, v6 bitop3:0x7e
  v_or3_b32 v4, v19, v23, v27
  v_or3_b32 v4, v4, v31, v35
  v_cmp_ne_u32 vcc, 0, v4
  s_cbranch_vccnz L_spin_Yi2
L_ret_Yi2:
  v_mov_b32 v17, v18
  ds_write_b64 v10, v[16:17] offset:0
  v_mov_b32 v21, v22
  ds_write_b64 v10, v[20:21] offset:512
  v_mov_b32 v25, v26
  ds_write_b64 v10, v[24:25] offset:1024
  v_mov_b32 v29, v30
  ds_write_b64 v10, v[28:29] offset:1536
  v_mov_b32 v33, v34
  ds_write_b64 v10, v[32:33] offset:2048
  ds_read_b64_tr_b16 v[96:97], v10 offset:0
  ds_read_b64_tr_b16 v[98:99], v10 offset:512
  ds_read_b64_tr_b16 v[100:101], v10 offset:1024
  ds_read_b64_tr_b16 v[102:103], v10 offset:1536
  ds_read_b64_tr_b16 v[104:105], v10 offset:2048
  v_pk_fma_f32 v[176:177], v[236:237], v[14:15], v[176:177]
  v_pk_fma_f32 v[178:179], v[238:239], v[14:15], v[178:179]
  v_pk_fma_f32 v[180:181], v[240:241], v[14:15], v[180:181]
  v_pk_fma_f32 v[182:183], v[242:243], v[14:15], v[182:183]
  v_pk_fma_f32 v[184:185], v[244:245], v[14:15], v[184:185]
  v_pk_fma_f32 v[186:187], v[246:247], v[14:15], v[186:187]
  v_pk_fma_f32 v[188:189], v[248:249], v[14:15], v[188:189]
  v_pk_fma_f32 v[190:191], v[250:251], v[14:15], v[190:191]
  v_pk_fma_f32 v[192:193], v[252:253], v[14:15], v[192:193]
  v_pk_fma_f32 v[194:195], v[254:255], v[14:15], v[194:195]
  s_waitcnt lgkmcnt(4)
  v_lshlrev_b32 v16, 16, v96
  v_and_b32 v17, 0xffff0000, v96
  v_fma_f32 v176, v16, v112, v176
  v_fma_f32 v177, v17, v113, v177
  v_lshlrev_b32 v18, 16, v97
  v_and_b32 v19, 0xffff0000, v97
  v_fma_f32 v178, v18, v114, v178
  v_fma_f32 v179, v19, v115, v179
  s_waitcnt lgkmcnt(3)
  v_lshlrev_b32 v20, 16, v98
  v_and_b32 v21, 0xffff0000, v98
  v_fma_f32 v180, v20, v116, v180
  v_fma_f32 v181, v21, v117, v181
  v_lshlrev_b32 v22, 16, v99
  v_and_b32 v23, 0xffff0000, v99
  v_fma_f32 v182, v22, v118, v182
  v_fma_f32 v183, v23, v119, v183
  s_waitcnt lgkmcnt(2)
  v_lshlrev_b32 v24, 16, v100
  v_and_b32 v25, 0xffff0000, v100
  v_fma_f32 v184, v24, v120, v184
  v_fma_f32 v185, v25, v121, v185
  v_lshlrev_b32 v26, 16, v101
  v_and_b32 v27, 0xffff0000, v101
  v_fma_f32 v186, v26, v122, v186
  v_fma_f32 v187, v27, v123, v187
  s_waitcnt lgkmcnt(1)
  v_lshlrev_b32 v28, 16, v102
  v_and_b32 v29, 0xffff0000, v102
  v_fma_f32 v188, v28, v124, v188
  v_fma_f32 v189, v29, v125, v189
  v_lshlrev_b32 v30, 16, v103
  v_and_b32 v31, 0xffff0000, v103
  v_fma_f32 v190, v30, v126, v190
  v_fma_f32 v191, v31, v127, v191
  s_waitcnt lgkmcnt(0)
  v_lshlrev_b32 v32, 16, v104
  v_and_b32 v33, 0xffff0000, v104
  v_fma_f32 v192, v32, v128, v192
  v_fma_f32 v193, v33, v129, v193
  v_lshlrev_b32 v34, 16, v105
  v_and_b32 v35, 0xffff0000, v105
  v_fma_f32 v194, v34, v130, v194
  v_fma_f32 v195, v35, v131, v195
  v_cvt_pk_bf16_f32 v96, v176, v177
  v_cvt_pk_bf16_f32 v97, v178, v179
  ds_write_b64 v11, v[96:97] offset:0
  v_cvt_pk_bf16_f32 v98, v180, v181
  v_cvt_pk_bf16_f32 v99, v182, v183
  ds_write_b64 v11, v[98:99] offset:32
  v_cvt_pk_bf16_f32 v100, v184, v185
  v_cvt_pk_bf16_f32 v101, v186, v187
  ds_write_b64 v11, v[100:101] offset:64
  v_cvt_pk_bf16_f32 v102, v188, v189
  v_cvt_pk_bf16_f32 v103, v190, v191
  ds_write_b64 v11, v[102:103] offset:96
  v_cvt_pk_bf16_f32 v104, v192, v193
  v_cvt_pk_bf16_f32 v105, v194, v195
  ds_write_b64 v11, v[104:105] offset:128
  v_add_u32 v8, s87, v1
  ds_read_b128 v[116:119], v8 offset:0
  ds_read_b128 v[120:123], v8 offset:640
  ds_read_b128 v[124:127], v8 offset:5120
  ds_read_b128 v[128:131], v8 offset:5760
  s_mov_b32 exec_lo, -1
  s_mov_b32 exec_hi, 0xff
  s_waitcnt lgkmcnt(3)
  s_mov_b32 s82, 0
  buffer_store_dwordx4 v[116:119], v2, s[40:43], s82 offen sc1
  s_waitcnt lgkmcnt(2)
  s_mov_b32 s82, 5120
  buffer_store_dwordx4 v[120:123], v2, s[40:43], s82 offen sc1
  s_waitcnt lgkmcnt(1)
  s_mov_b32 s82, 40960
  buffer_store_dwordx4 v[124:127], v2, s[40:43], s82 offen sc1
  s_waitcnt lgkmcnt(0)
  s_mov_b32 s82, 46080
  buffer_store_dwordx4 v[128:131], v2, s[40:43], s82 offen sc1
  s_endpgm
L_spin_Ab3:
  s_mov_b32 s90, 0x40000
L_spinl_Ab3:
  buffer_load_dword v5, v2, s[44:47], 0 offen sc1
  s_waitcnt vmcnt(0)
  v_cmp_ne_u32 vcc, s60, v5
  s_cbranch_vccz L_ret_Ab3
  s_sub_u32 s90, s90, 1
  s_cmp_lg_u32 s90, 0
  s_cbranch_scc1 L_spinl_Ab3
  s_branch L_ret_Ab3
L_spin_Bb3:
  s_mov_b32 s90, 0x40000
L_spinl_Bb3:
  buffer_load_dword v5, v3, s[44:47], 0 offen sc1
  s_waitcnt vmcnt(0)
  v_cmp_ne_u32 vcc, s61, v5
  s_cbranch_vccz L_ret_Bb3
  s_sub_u32 s90, s90, 1
  s_cmp_lg_u32 s90, 0
  s_cbranch_scc1 L_spinl_Bb3
  s_branch L_ret_Bb3
L_spin_Yb3:
  s_mov_b32 s90, 0x40000
L_spinl_Yb3:
  buffer_load_dwordx4 v[176:179], v3, s[44:47], s80 offen sc1
  buffer_load_dwordx4 v[180:183], v3, s[44:47], s81 offen sc1
  buffer_load_dwordx4 v[184:187], v3, s[44:47], s82 offen sc1
  buffer_load_dwordx4 v[188:191], v3, s[44:47], s83 offen sc1
  buffer_load_dwordx4 v[192:195], v3, s[44:47], s85 offen sc1
  s_waitcnt vmcnt(0)
  v_bitop3_b32 v179, v177, v179, v6 bitop3:0x7e
  v_bitop3_b32 v183, v181, v183, v6 bitop3:0x7e
  v_bitop3_b32 v187, v185, v187, v6 bitop3:0x7e
  v_bitop3_b32 v191, v189, v191, v6 bitop3:0x7e
  v_bitop3_b32 v195, v193, v195, v6 bitop3:0x7e
  v_or3_b32 v4, v179, v183, v187
  v_or3_b32 v4, v4, v191, v195
  v_cmp_ne_u32 vcc, 0, v4
  s_cbranch_vccz L_ret_Yb3
  s_sub_u32 s90, s90, 1
  s_cmp_lg_u32 s90, 0
  s_cbranch_scc1 L_spinl_Yb3
  s_branch L_ret_Yb3
L_spin_Ab2:
  s_mov_b32 s90, 0x40000
L_spinl_Ab2:
  buffer_load_dword v5, v2, s[44:47], 0 offen sc1
  s_waitcnt vmcnt(0)
  v_cmp_ne_u32 vcc, s60, v5
  s_cbranch_vccz L_ret_Ab2
  s_sub_u32 s90, s90, 1
  s_cmp_lg_u32 s90, 0
  s_cbranch_scc1 L_spinl_Ab2
  s_branch L_ret_Ab2
L_spin_Bb2:
  s_mov_b32 s90, 0x40000
L_spinl_Bb2:
  buffer_load_dword v5, v3, s[44:47], 0 offen sc1
  s_waitcnt vmcnt(0)
  v_cmp_ne_u32 vcc, s61, v5
  s_cbranch_vccz L_ret_Bb2
  s_sub_u32 s90, s90, 1
  s_cmp_lg_u32 s90, 0
  s_cbranch_scc1 L_spinl_Bb2
  s_branch L_ret_Bb2
L_spin_Yb2:
  s_mov_b32 s90, 0x40000
L_spinl_Yb2:
  buffer_load_dwordx4 v[176:179], v3, s[44:47], s80 offen sc1
  buffer_load_dwordx4 v[180:183], v3, s[44:47], s81 offen sc1
  buffer_load_dwordx4 v[184:187], v3, s[44:47], s82 offen sc1
  buffer_load_dwordx4 v[188:191], v3, s[44:47], s83 offen sc1
  buffer_load_dwordx4 v[192:195], v3, s[44:47], s85 offen sc1
  s_waitcnt vmcnt(0)
  v_bitop3_b32 v179, v177, v179, v6 bitop3:0x7e
  v_bitop3_b32 v183, v181, v183, v6 bitop3:0x7e
  v_bitop3_b32 v187, v185, v187, v6 bitop3:0x7e
  v_bitop3_b32 v191, v189, v191, v6 bitop3:0x7e
  v_bitop3_b32 v195, v193, v195, v6 bitop3:0x7e
  v_or3_b32 v4, v179, v183, v187
  v_or3_b32 v4, v4, v191, v195
  v_cmp_ne_u32 vcc, 0, v4
  s_cbranch_vccz L_ret_Yb2
  s_sub_u32 s90, s90, 1
  s_cmp_lg_u32 s90, 0
  s_cbranch_scc1 L_spinl_Yb2
  s_branch L_ret_Yb2
L_spin_Ai3:
  s_mov_b32 s90, 0x40000
L_spinl_Ai3:
  buffer_load_dword v5, v2, s[44:47], 0 offen sc1
  s_waitcnt vmcnt(0)
  v_cmp_ne_u32 vcc, s60, v5
  s_cbranch_vccz L_ret_Ai3
  s_sub_u32 s90, s90, 1
  s_cmp_lg_u32 s90, 0
  s_cbranch_scc1 L_spinl_Ai3
  s_branch L_ret_Ai3
L_spin_Bi3:
  s_mov_b32 s90, 0x40000
L_spinl_Bi3:
  buffer_load_dword v5, v3, s[44:47], 0 offen sc1
  s_waitcnt vmcnt(0)
  v_cmp_ne_u32 vcc, s61, v5
  s_cbranch_vccz L_ret_Bi3
  s_sub_u32 s90, s90, 1
  s_cmp_lg_u32 s90, 0
  s_cbranch_scc1 L_spinl_Bi3
  s_branch L_ret_Bi3
L_spin_Yi3:
  s_mov_b32 s90, 0x40000
L_spinl_Yi3:
  buffer_load_dwordx4 v[16:19], v3, s[44:47], s80 offen sc1
  buffer_load_dwordx4 v[20:23], v3, s[44:47], s81 offen sc1
  buffer_load_dwordx4 v[24:27], v3, s[44:47], s82 offen sc1
  buffer_load_dwordx4 v[28:31], v3, s[44:47], s83 offen sc1
  buffer_load_dwordx4 v[32:35], v3, s[44:47], s85 offen sc1
  s_waitcnt vmcnt(0)
  v_bitop3_b32 v19, v17, v19, v6 bitop3:0x7e
  v_bitop3_b32 v23, v21, v23, v6 bitop3:0x7e
  v_bitop3_b32 v27, v25, v27, v6 bitop3:0x7e
  v_bitop3_b32 v31, v29, v31, v6 bitop3:0x7e
  v_bitop3_b32 v35, v33, v35, v6 bitop3:0x7e
  v_or3_b32 v4, v19, v23, v27
  v_or3_b32 v4, v4, v31, v35
  v_cmp_ne_u32 vcc, 0, v4
  s_cbranch_vccz L_ret_Yi3
  s_sub_u32 s90, s90, 1
  s_cmp_lg_u32 s90, 0
  s_cbranch_scc1 L_spinl_Yi3
  s_branch L_ret_Yi3
L_spin_Ai2:
  s_mov_b32 s90, 0x40000
L_spinl_Ai2:
  buffer_load_dword v5, v2, s[44:47], 0 offen sc1
  s_waitcnt vmcnt(0)
  v_cmp_ne_u32 vcc, s60, v5
  s_cbranch_vccz L_ret_Ai2
  s_sub_u32 s90, s90, 1
  s_cmp_lg_u32 s90, 0
  s_cbranch_scc1 L_spinl_Ai2
  s_branch L_ret_Ai2
L_spin_Bi2:
  s_mov_b32 s90, 0x40000
L_spinl_Bi2:
  buffer_load_dword v5, v3, s[44:47], 0 offen sc1
  s_waitcnt vmcnt(0)
  v_cmp_ne_u32 vcc, s61, v5
  s_cbranch_vccz L_ret_Bi2
  s_sub_u32 s90, s90, 1
  s_cmp_lg_u32 s90, 0
  s_cbranch_scc1 L_spinl_Bi2
  s_branch L_ret_Bi2
L_spin_Yi2:
  s_mov_b32 s90, 0x40000
L_spinl_Yi2:
  buffer_load_dwordx4 v[16:19], v3, s[44:47], s80 offen sc1
  buffer_load_dwordx4 v[20:23], v3, s[44:47], s81 offen sc1
  buffer_load_dwordx4 v[24:27], v3, s[44:47], s82 offen sc1
  buffer_load_dwordx4 v[28:31], v3, s[44:47], s83 offen sc1
  buffer_load_dwordx4 v[32:35], v3, s[44:47], s85 offen sc1
  s_waitcnt vmcnt(0)
  v_bitop3_b32 v19, v17, v19, v6 bitop3:0x7e
  v_bitop3_b32 v23, v21, v23, v6 bitop3:0x7e
  v_bitop3_b32 v27, v25, v27, v6 bitop3:0x7e
  v_bitop3_b32 v31, v29, v31, v6 bitop3:0x7e
  v_bitop3_b32 v35, v33, v35, v6 bitop3:0x7e
  v_or3_b32 v4, v19, v23, v27
  v_or3_b32 v4, v4, v31, v35
  v_cmp_ne_u32 vcc, 0, v4
  s_cbranch_vccz L_ret_Yi2
  s_sub_u32 s90, s90, 1
  s_cmp_lg_u32 s90, 0
  s_cbranch_scc1 L_spinl_Yi2
  s_branch L_ret_Yi2
L_end:
  s_endpgm
.section .rodata,"a"
.p2align 6
.amdhsa_kernel gated_mix__ssm_conv_h3__dense_activation_silu__prompt_kernel
  .amdhsa_next_free_vgpr 512
  .amdhsa_next_free_sgpr 102
  .amdhsa_accum_offset 256
  .amdhsa_group_segment_fixed_size 0
  .amdhsa_kernarg_size 104
  .amdhsa_user_sgpr_count 2
  .amdhsa_user_sgpr_kernarg_segment_ptr 1
  .amdhsa_system_sgpr_workgroup_id_x 1
.end_amdhsa_kernel
```
